```python
import torch

def _softmax(x, axis=-1):
    return torch.softmax(x, dim=axis)

def _gelu(x):
    return torch.nn.functional.gelu(x, approximate='tanh')

def _silu(x):
    return torch.nn.functional.silu(x)

def _sigmoid(x):
    return torch.sigmoid(x)

def _layernorm(x, axis=-1, eps=1e-05):
    m = x.mean(dim=axis, keepdim=True)
    v = x.var(dim=axis, keepdim=True, unbiased=False)
    return (x - m) / torch.sqrt(v + eps)

def _scatter_add(tgt, idx, src, axis=0):
    return tgt.clone().index_add_(axis, idx, src)

def _segment_sum(src, seg, n):
    out = torch.zeros((n,) + src.shape[1:], dtype=src.dtype)
    return out.index_add_(0, seg, src)

def _pad(x, pw):
    flat = tuple((v for pair in reversed(pw) for v in pair))
    return torch.nn.functional.pad(x, flat)
kernel_name = 'sequential_preLN__memory_aug_recurrent_mem_tr__swiglu_ffn__prompt'

def setup_inputs():

    _w = lambda a: (lambda t: t.to(torch.bfloat16) if t.is_floating_point() else t)(torch.as_tensor(a))

    def _A_setup():
        B, S, Dm = (1, 2048, 640)
        H, Dh = (32, 192)
        M, seg = (8, 32)
        seg = min(seg, S)
        S = S // seg * seg
        return {'x': _w((lambda *s: torch.randn(*s, dtype=torch.bfloat16) * 0.05)(B, S, Dm)), 'mem0': _w((lambda *s: torch.randn(*s, dtype=torch.bfloat16) * 0.2)(B, M, Dm)), 'Wq': _w((lambda *s: torch.randn(*s, dtype=torch.bfloat16) * 1.6)(Dm, H, Dh) * Dm ** (-0.5)), 'Wk': _w((lambda *s: torch.randn(*s, dtype=torch.bfloat16) * 1.6)(Dm, H, Dh) * Dm ** (-0.5)), 'Wv': _w((lambda *s: torch.randn(*s, dtype=torch.bfloat16) * 0.2)(Dm, H, Dh) * Dm ** (-0.5)), 'Wo': _w((lambda *s: torch.randn(*s, dtype=torch.bfloat16) * 0.2)(H, Dh, Dm) * (H * Dh) ** (-0.5)), 'seg_len': seg}
    _A_in = _A_setup()

    def _B_setup():
        B, S, D, F = (1, 2048, 640, 1536)
        return {'x': _w((lambda *s: torch.randn(*s, dtype=torch.bfloat16) * 0.05)(B, S, D)), 'w_gate': _w((lambda *s: torch.randn(*s, dtype=torch.bfloat16) * 0.05)(D, F)), 'w_up': _w((lambda *s: torch.randn(*s, dtype=torch.bfloat16) * 0.05)(D, F)), 'w_down': _w((lambda *s: torch.randn(*s, dtype=torch.bfloat16) * 0.05)(F, D))}
    _B_in = _B_setup()
    return {'A_x': _A_in['x'], 'A_mem0': _A_in['mem0'], 'A_Wq': _A_in['Wq'], 'A_Wk': _A_in['Wk'], 'A_Wv': _A_in['Wv'], 'A_Wo': _A_in['Wo'], 'A_seg_len': _A_in['seg_len'], 'B_x': _B_in['x'], 'B_w_gate': _B_in['w_gate'], 'B_w_up': _B_in['w_up'], 'B_w_down': _B_in['w_down']}

def reference(A_x, A_mem0, A_Wq, A_Wk, A_Wv, A_Wo, A_seg_len, B_x, B_w_gate, B_w_up, B_w_down):

    def _A_ref(x, mem0, Wq, Wk, Wv, Wo, seg_len):
        B, S, Dm = x.shape
        H, Dh = (Wq.shape[1], Wq.shape[2])
        M = mem0.shape[1]
        scale = Dh ** (-0.5)
        n_seg = S // seg_len
        L = M + seg_len
        idx = torch.arange(L)
        mask = (idx[:, None] < M) | (idx[:, None] >= idx[None, :])
        mem = mem0
        outs = []
        for s in range(n_seg):
            xs = x[:, s * seg_len:(s + 1) * seg_len, :].clone()
            h = torch.concatenate([mem, xs], axis=1)
            q = torch.einsum('btd,dhe->bhte', h, Wq)
            k = torch.einsum('btd,dhe->bhte', h, Wk)
            v = torch.einsum('btd,dhe->bhte', h, Wv)
            scores = torch.einsum('bhqe,bhke->bhqk', q, k) * scale
            scores = torch.where(mask[None, None], scores, -1000000000.0)
            p = _softmax(scores, axis=-1)
            o = torch.einsum('bhqk,bhke->bhqe', p, v)
            o = torch.einsum('bhte,hed->btd', o, Wo)
            mem = o[:, :M, :].clone()
            outs.append(o[:, M:, :])
        return torch.concatenate(outs, axis=1)

    def _B_ref(x, w_gate, w_up, w_down):
        g = _silu(x @ w_gate)
        u = x @ w_up
        return g * u @ w_down
    x = A_x
    h = x + _A_ref(_layernorm(x, axis=-1), A_mem0, A_Wq, A_Wk, A_Wv, A_Wo, A_seg_len)
    h2 = h + _B_ref(_layernorm(h, axis=-1), B_w_gate, B_w_up, B_w_down)
    return h2
```

```asm
; @launch grid=(256,1,1) block=(256,1,1) lds=163840
.amdgcn_target "amdgcn-amd-amdhsa--gfx950"
.text
.globl sequential_preLN__memory_aug_recurrent_mem_tr__swiglu_ffn__prompt_kernel
.p2align 8
.type sequential_preLN__memory_aug_recurrent_mem_tr__swiglu_ffn__prompt_kernel,@function
sequential_preLN__memory_aug_recurrent_mem_tr__swiglu_ffn__prompt_kernel:
    s_load_dwordx2 s[4:5], s[0:1], 104
    s_load_dwordx2 s[88:89], s[0:1], 96
    v_and_b32 v1, 63, v0
    v_lshrrev_b32 v3, 6, v0
    v_lshlrev_b32 v2, 4, v1
    v_readfirstlane_b32 s20, v3
    s_mov_b32 s101, 0x100000
    s_cmp_ge_u32 s2, 256
    s_cbranch_scc1 L_exit
    s_getreg_b32 s22, hwreg(HW_REG_XCC_ID)
    s_and_b32 s22, s22, 7
    s_waitcnt lgkmcnt(0)
    s_mov_b32 s6, 0x10000000
    s_mov_b32 s7, 0x20000
    s_mov_b32 s90, 0x100
    s_mov_b32 s91, 0x20000
    s_cmp_lg_u32 s20, 0
    s_cbranch_scc1 Ld_wait
    s_lshl_b32 s26, s22, 5
    v_mov_b32 v4, s26
    v_mov_b32 v5, 1
    s_mov_b64 exec, 1
    buffer_atomic_add v5, v4, s[88:91], 0 offen sc0 sc1
    s_waitcnt vmcnt(0)
    v_mov_b32 v4, 0
    ds_write_b32 v4, v5
    s_mov_b64 exec, -1
    s_waitcnt lgkmcnt(0)
Ld_wait:
    s_barrier
    v_mov_b32 v4, 0
    ds_read_b32 v6, v4
    s_waitcnt lgkmcnt(0)
    v_readfirstlane_b32 s40, v6
    s_barrier
    s_cmp_ge_u32 s40, 32
    s_cbranch_scc1 Ld_overflow
    s_cmp_lt_u32 s22, 4
    s_cbranch_scc0 Ld_w
    s_cmp_lt_u32 s40, 28
    s_cbranch_scc1 Ld_chain
    s_lshl_b32 s48, s22, 2
    s_add_u32 s48, s48, s40
    s_add_u32 s48, s48, 100
    s_branch Ld_worker
Ld_w:
    s_sub_u32 s48, s22, 4
    s_lshl_b32 s48, s48, 5
    s_add_u32 s48, s48, s40
    s_branch Ld_worker
Ld_overflow:
    v_and_b32 v4, 7, v1
    v_lshlrev_b32 v4, 5, v4
Lac_1:
    buffer_load_dword v6, v4, s[88:91], 0 offen sc1
    s_waitcnt vmcnt(0)
    v_readlane_b32 s32, v6, 0
    v_readlane_b32 s33, v6, 1
    v_readlane_b32 s34, v6, 2
    v_readlane_b32 s35, v6, 3
    v_readlane_b32 s36, v6, 4
    v_readlane_b32 s37, v6, 5
    v_readlane_b32 s38, v6, 6
    v_readlane_b32 s39, v6, 7
    s_add_u32 s26, s32, s33
    s_add_u32 s26, s26, s34
    s_add_u32 s26, s26, s35
    s_add_u32 s26, s26, s36
    s_add_u32 s26, s26, s37
    s_add_u32 s26, s26, s38
    s_add_u32 s26, s26, s39
    s_cmp_ge_u32 s26, 256
    s_cbranch_scc1 Lacd_2
    s_sub_u32 s101, s101, 1
    s_cbranch_scc1 L_abort
    s_sleep 8
    s_branch Lac_1
Lacd_2:
    s_mov_b32 s42, 0
    s_cmp_le_u32 s22, 0
    s_cbranch_scc1 Ld_y_3
    s_max_u32 s26, s32, 32
    s_sub_u32 s26, s26, 32
    s_add_u32 s42, s42, s26
Ld_y_3:
    s_cmp_le_u32 s22, 1
    s_cbranch_scc1 Ld_y_4
    s_max_u32 s26, s33, 32
    s_sub_u32 s26, s26, 32
    s_add_u32 s42, s42, s26
Ld_y_4:
    s_cmp_le_u32 s22, 2
    s_cbranch_scc1 Ld_y_5
    s_max_u32 s26, s34, 32
    s_sub_u32 s26, s26, 32
    s_add_u32 s42, s42, s26
Ld_y_5:
    s_cmp_le_u32 s22, 3
    s_cbranch_scc1 Ld_y_6
    s_max_u32 s26, s35, 32
    s_sub_u32 s26, s26, 32
    s_add_u32 s42, s42, s26
Ld_y_6:
    s_cmp_le_u32 s22, 4
    s_cbranch_scc1 Ld_y_7
    s_max_u32 s26, s36, 32
    s_sub_u32 s26, s26, 32
    s_add_u32 s42, s42, s26
Ld_y_7:
    s_cmp_le_u32 s22, 5
    s_cbranch_scc1 Ld_y_8
    s_max_u32 s26, s37, 32
    s_sub_u32 s26, s26, 32
    s_add_u32 s42, s42, s26
Ld_y_8:
    s_cmp_le_u32 s22, 6
    s_cbranch_scc1 Ld_y_9
    s_max_u32 s26, s38, 32
    s_sub_u32 s26, s26, 32
    s_add_u32 s42, s42, s26
Ld_y_9:
    s_cmp_le_u32 s22, 7
    s_cbranch_scc1 Ld_y_10
    s_max_u32 s26, s39, 32
    s_sub_u32 s26, s26, 32
    s_add_u32 s42, s42, s26
Ld_y_10:
    s_sub_u32 s26, s40, 32
    s_add_u32 s42, s42, s26
    s_min_u32 s26, s32, 32
    s_sub_u32 s27, 32, s26
    s_cmp_lt_u32 s42, s27
    s_cbranch_scc0 Ld_f_11
    s_mov_b32 s22, 0
    s_add_u32 s40, s26, s42
    s_branch Ld_slot
Ld_f_11:
    s_sub_u32 s42, s42, s27
    s_min_u32 s26, s33, 32
    s_sub_u32 s27, 32, s26
    s_cmp_lt_u32 s42, s27
    s_cbranch_scc0 Ld_f_12
    s_mov_b32 s22, 1
    s_add_u32 s40, s26, s42
    s_branch Ld_slot
Ld_f_12:
    s_sub_u32 s42, s42, s27
    s_min_u32 s26, s34, 32
    s_sub_u32 s27, 32, s26
    s_cmp_lt_u32 s42, s27
    s_cbranch_scc0 Ld_f_13
    s_mov_b32 s22, 2
    s_add_u32 s40, s26, s42
    s_branch Ld_slot
Ld_f_13:
    s_sub_u32 s42, s42, s27
    s_min_u32 s26, s35, 32
    s_sub_u32 s27, 32, s26
    s_cmp_lt_u32 s42, s27
    s_cbranch_scc0 Ld_f_14
    s_mov_b32 s22, 3
    s_add_u32 s40, s26, s42
    s_branch Ld_slot
Ld_f_14:
    s_sub_u32 s42, s42, s27
    s_min_u32 s26, s36, 32
    s_sub_u32 s27, 32, s26
    s_cmp_lt_u32 s42, s27
    s_cbranch_scc0 Ld_f_15
    s_mov_b32 s22, 4
    s_add_u32 s40, s26, s42
    s_branch Ld_slot
Ld_f_15:
    s_sub_u32 s42, s42, s27
    s_min_u32 s26, s37, 32
    s_sub_u32 s27, 32, s26
    s_cmp_lt_u32 s42, s27
    s_cbranch_scc0 Ld_f_16
    s_mov_b32 s22, 5
    s_add_u32 s40, s26, s42
    s_branch Ld_slot
Ld_f_16:
    s_sub_u32 s42, s42, s27
    s_min_u32 s26, s38, 32
    s_sub_u32 s27, 32, s26
    s_cmp_lt_u32 s42, s27
    s_cbranch_scc0 Ld_f_17
    s_mov_b32 s22, 6
    s_add_u32 s40, s26, s42
    s_branch Ld_slot
Ld_f_17:
    s_sub_u32 s42, s42, s27
    s_min_u32 s26, s39, 32
    s_sub_u32 s27, 32, s26
    s_cmp_lt_u32 s42, s27
    s_cbranch_scc0 Ld_f_18
    s_mov_b32 s22, 7
    s_add_u32 s40, s26, s42
    s_branch Ld_slot
Ld_f_18:
    s_sub_u32 s42, s42, s27
    s_branch L_exit
Ld_slot:
    s_cmp_lt_u32 s22, 4
    s_cbranch_scc0 Ld_w
    s_cmp_lt_u32 s40, 28
    s_cbranch_scc1 Ld_chain
    s_lshl_b32 s48, s22, 2
    s_add_u32 s48, s48, s40
    s_add_u32 s48, s48, 100
Ld_worker:
    s_mov_b32 s94, -1
    s_mov_b32 s95, -1
    s_cmp_ge_u32 s48, 128
    s_cbranch_scc1 Ld_spare
    s_lshr_b32 s26, s48, 5
    s_lshl_b32 s26, s26, 3
    s_and_b32 s21, s48, 7
    s_add_u32 s21, s21, s26
    s_bfe_u32 s92, s48, 0x20003
    s_add_u32 s92, s92, 3
    s_lshl_b32 s26, s21, 3
    s_cmp_eq_u32 s92, 3
    s_cbranch_scc0 Ld_t_19
    s_add_u32 s94, s26, 0
    s_branch Ld_start
Ld_t_19:
    s_cmp_eq_u32 s92, 4
    s_cbranch_scc0 Ld_t_20
    s_add_u32 s94, s26, 1
    s_branch Ld_start
Ld_t_20:
    s_cmp_eq_u32 s92, 5
    s_cbranch_scc0 Ld_t_21
    s_add_u32 s94, s26, 2
    s_branch Ld_start
Ld_t_21:
    s_cmp_eq_u32 s92, 6
    s_cbranch_scc0 Ld_t_22
    s_add_u32 s94, s26, 3
    s_add_u32 s95, s26, 4
    s_branch Ld_start
Ld_t_22:
Ld_spare:
    s_sub_u32 s21, s48, 128
    s_mov_b32 s92, 7
    s_add_u32 s96, s21, 80
    s_lshr_b32 s29, s21, 2
    s_and_b32 s28, s21, 3
    s_add_u32 s28, s28, 20
    s_and_b32 s26, s28, 7
    s_lshl_b32 s26, s26, 3
    s_lshr_b32 s27, s28, 3
    s_add_u32 s26, s26, s27
    s_lshl_b32 s27, s29, 6
    s_add_u32 s26, s26, s27
    s_add_u32 s94, s26, 5
    s_branch Ld_start
Ld_chain:
    s_cmp_lt_u32 s40, 8
    s_cbranch_scc1 Ld_qk
    s_sub_u32 s21, s40, 8
    s_mov_b32 s92, 2
    s_mov_b32 s94, -1
    s_mov_b32 s95, -1
    s_mul_i32 s96, s22, 20
    s_add_u32 s96, s96, s21
    s_and_b32 s26, s21, 7
    s_lshl_b32 s26, s26, 3
    s_lshr_b32 s27, s21, 3
    s_add_u32 s26, s26, s27
    s_lshl_b32 s27, s22, 6
    s_add_u32 s26, s26, s27
    s_add_u32 s94, s26, 5
Ld_start:
    s_mov_b32 s97, 0
    s_mov_b32 s93, 0
    s_load_dwordx2 s[24:25], s[0:1], 32
    s_load_dwordx2 s[28:29], s[0:1], 40
    s_waitcnt lgkmcnt(0)
    s_mov_b32 s26, 0x780000
    s_mov_b32 s27, 0x20000
    s_mov_b32 s30, 0x780000
    s_mov_b32 s31, 0x20000
    v_add_u32 v3, 0, v0
    v_mul_u32_u24 v4, 0xaab, v3
    v_lshrrev_b32 v4, 16, v4
    v_mul_u32_u24 v5, 24, v4
    v_sub_u32 v5, v3, v5
    v_mul_u32_u24 v200, 0x3000, v4
    v_lshl_add_u32 v200, v5, 4, v200
    v_mul_u32_u24 v100, 0x190, v4
    v_lshl_add_u32 v100, v5, 4, v100
    v_add_u32 v3, 256, v0
    v_mul_u32_u24 v4, 0xaab, v3
    v_lshrrev_b32 v4, 16, v4
    v_mul_u32_u24 v5, 24, v4
    v_sub_u32 v5, v3, v5
    v_mul_u32_u24 v201, 0x3000, v4
    v_lshl_add_u32 v201, v5, 4, v201
    v_mul_u32_u24 v101, 0x190, v4
    v_lshl_add_u32 v101, v5, 4, v101
    v_add_u32 v3, 512, v0
    v_mul_u32_u24 v4, 0xaab, v3
    v_lshrrev_b32 v4, 16, v4
    v_mul_u32_u24 v5, 24, v4
    v_sub_u32 v5, v3, v5
    v_mul_u32_u24 v202, 0x3000, v4
    v_lshl_add_u32 v202, v5, 4, v202
    v_mul_u32_u24 v102, 0x190, v4
    v_lshl_add_u32 v102, v5, 4, v102
    v_add_u32 v3, 768, v0
    v_mul_u32_u24 v4, 0xaab, v3
    v_lshrrev_b32 v4, 16, v4
    v_mul_u32_u24 v5, 24, v4
    v_sub_u32 v5, v3, v5
    v_mul_u32_u24 v203, 0x3000, v4
    v_lshl_add_u32 v203, v5, 4, v203
    v_mul_u32_u24 v103, 0x190, v4
    v_lshl_add_u32 v103, v5, 4, v103
    v_add_u32 v3, 1024, v0
    v_mul_u32_u24 v4, 0xaab, v3
    v_lshrrev_b32 v4, 16, v4
    v_mul_u32_u24 v5, 24, v4
    v_sub_u32 v5, v3, v5
    v_mul_u32_u24 v204, 0x3000, v4
    v_lshl_add_u32 v204, v5, 4, v204
    v_mul_u32_u24 v104, 0x190, v4
    v_lshl_add_u32 v104, v5, 4, v104
    v_add_u32 v3, 1280, v0
    v_mul_u32_u24 v4, 0xaab, v3
    v_lshrrev_b32 v4, 16, v4
    v_mul_u32_u24 v5, 24, v4
    v_sub_u32 v5, v3, v5
    v_mul_u32_u24 v205, 0x3000, v4
    v_lshl_add_u32 v205, v5, 4, v205
    v_mul_u32_u24 v105, 0x190, v4
    v_lshl_add_u32 v105, v5, 4, v105
    v_add_u32 v3, 1536, v0
    v_mul_u32_u24 v4, 0xaab, v3
    v_lshrrev_b32 v4, 16, v4
    v_mul_u32_u24 v5, 24, v4
    v_sub_u32 v5, v3, v5
    v_mul_u32_u24 v206, 0x3000, v4
    v_lshl_add_u32 v206, v5, 4, v206
    v_mul_u32_u24 v106, 0x190, v4
    v_lshl_add_u32 v106, v5, 4, v106
    v_add_u32 v3, 1792, v0
    v_mul_u32_u24 v4, 0xaab, v3
    v_lshrrev_b32 v4, 16, v4
    v_mul_u32_u24 v5, 24, v4
    v_sub_u32 v5, v3, v5
    v_mul_u32_u24 v207, 0x3000, v4
    v_lshl_add_u32 v207, v5, 4, v207
    v_mul_u32_u24 v107, 0x190, v4
    v_lshl_add_u32 v107, v5, 4, v107
    v_add_u32 v3, 2048, v0
    v_mul_u32_u24 v4, 0xaab, v3
    v_lshrrev_b32 v4, 16, v4
    v_mul_u32_u24 v5, 24, v4
    v_sub_u32 v5, v3, v5
    v_mul_u32_u24 v208, 0x3000, v4
    v_lshl_add_u32 v208, v5, 4, v208
    v_mul_u32_u24 v108, 0x190, v4
    v_lshl_add_u32 v108, v5, 4, v108
    v_add_u32 v3, 2304, v0
    v_mul_u32_u24 v4, 0xaab, v3
    v_lshrrev_b32 v4, 16, v4
    v_mul_u32_u24 v5, 24, v4
    v_sub_u32 v5, v3, v5
    v_mul_u32_u24 v209, 0x3000, v4
    v_lshl_add_u32 v209, v5, 4, v209
    v_mul_u32_u24 v109, 0x190, v4
    v_lshl_add_u32 v109, v5, 4, v109
    v_add_u32 v3, 2560, v0
    v_mul_u32_u24 v4, 0xaab, v3
    v_lshrrev_b32 v4, 16, v4
    v_mul_u32_u24 v5, 24, v4
    v_sub_u32 v5, v3, v5
    v_mul_u32_u24 v210, 0x3000, v4
    v_lshl_add_u32 v210, v5, 4, v210
    v_mul_u32_u24 v110, 0x190, v4
    v_lshl_add_u32 v110, v5, 4, v110
    v_add_u32 v3, 2816, v0
    v_mul_u32_u24 v4, 0xaab, v3
    v_lshrrev_b32 v4, 16, v4
    v_mul_u32_u24 v5, 24, v4
    v_sub_u32 v5, v3, v5
    v_mul_u32_u24 v211, 0x3000, v4
    v_lshl_add_u32 v211, v5, 4, v211
    v_mul_u32_u24 v111, 0x190, v4
    v_lshl_add_u32 v111, v5, 4, v111
    v_add_u32 v3, 3072, v0
    v_mul_u32_u24 v4, 0xaab, v3
    v_lshrrev_b32 v4, 16, v4
    v_mul_u32_u24 v5, 24, v4
    v_sub_u32 v5, v3, v5
    v_mul_u32_u24 v212, 0x3000, v4
    v_lshl_add_u32 v212, v5, 4, v212
    v_mul_u32_u24 v112, 0x190, v4
    v_lshl_add_u32 v112, v5, 4, v112
    v_add_u32 v3, 3328, v0
    v_mul_u32_u24 v4, 0xaab, v3
    v_lshrrev_b32 v4, 16, v4
    v_mul_u32_u24 v5, 24, v4
    v_sub_u32 v5, v3, v5
    v_mul_u32_u24 v213, 0x3000, v4
    v_lshl_add_u32 v213, v5, 4, v213
    v_mul_u32_u24 v113, 0x190, v4
    v_lshl_add_u32 v113, v5, 4, v113
    v_add_u32 v3, 3584, v0
    v_mul_u32_u24 v4, 0xaab, v3
    v_lshrrev_b32 v4, 16, v4
    v_mul_u32_u24 v5, 24, v4
    v_sub_u32 v5, v3, v5
    v_mul_u32_u24 v214, 0x3000, v4
    v_lshl_add_u32 v214, v5, 4, v214
    v_mul_u32_u24 v114, 0x190, v4
    v_lshl_add_u32 v114, v5, 4, v114
    v_add_u32 v3, 0, v0
    v_mul_u32_u24 v4, 0x667, v3
    v_lshrrev_b32 v4, 16, v4
    v_mul_u32_u24 v5, 40, v4
    v_sub_u32 v5, v3, v5
    v_mul_u32_u24 v248, 0x500, v4
    v_lshl_add_u32 v248, v5, 4, v248
    v_mul_u32_u24 v115, 0x2a0, v4
    v_lshl_add_u32 v115, v5, 4, v115
    v_add_u32 v115, 64000, v115
    v_add_u32 v3, 256, v0
    v_mul_u32_u24 v4, 0x667, v3
    v_lshrrev_b32 v4, 16, v4
    v_mul_u32_u24 v5, 40, v4
    v_sub_u32 v5, v3, v5
    v_mul_u32_u24 v249, 0x500, v4
    v_lshl_add_u32 v249, v5, 4, v249
    v_mul_u32_u24 v116, 0x2a0, v4
    v_lshl_add_u32 v116, v5, 4, v116
    v_add_u32 v116, 64000, v116
    v_add_u32 v3, 512, v0
    v_mul_u32_u24 v4, 0x667, v3
    v_lshrrev_b32 v4, 16, v4
    v_mul_u32_u24 v5, 40, v4
    v_sub_u32 v5, v3, v5
    v_mul_u32_u24 v250, 0x500, v4
    v_lshl_add_u32 v250, v5, 4, v250
    v_mul_u32_u24 v117, 0x2a0, v4
    v_lshl_add_u32 v117, v5, 4, v117
    v_add_u32 v117, 64000, v117
    v_add_u32 v3, 768, v0
    v_mul_u32_u24 v4, 0x667, v3
    v_lshrrev_b32 v4, 16, v4
    v_mul_u32_u24 v5, 40, v4
    v_sub_u32 v5, v3, v5
    v_mul_u32_u24 v251, 0x500, v4
    v_lshl_add_u32 v251, v5, 4, v251
    v_mul_u32_u24 v118, 0x2a0, v4
    v_lshl_add_u32 v118, v5, 4, v118
    v_add_u32 v118, 64000, v118
    v_add_u32 v3, 1024, v0
    v_mul_u32_u24 v4, 0x667, v3
    v_lshrrev_b32 v4, 16, v4
    v_mul_u32_u24 v5, 40, v4
    v_sub_u32 v5, v3, v5
    v_mul_u32_u24 v252, 0x500, v4
    v_lshl_add_u32 v252, v5, 4, v252
    v_mul_u32_u24 v119, 0x2a0, v4
    v_lshl_add_u32 v119, v5, 4, v119
    v_add_u32 v119, 64000, v119
Li_top:
    s_cmp_eq_u32 s94, -1
    s_cbranch_scc1 Li_noissue
    s_cmp_lg_u32 s93, 0
    s_cbranch_scc1 Li_noissue
    s_lshr_b32 s34, s94, 3
    s_bfe_u32 s35, s94, 0x20001
    s_and_b32 s36, s94, 1
    s_mul_i32 s37, s35, 1966080
    s_mul_i32 s38, s34, 384
    s_add_u32 s37, s37, s38
    buffer_load_dwordx4 a[120:123], v200, s[24:27], s37 offen
    buffer_load_dwordx4 a[124:127], v201, s[24:27], s37 offen
    buffer_load_dwordx4 a[128:131], v202, s[24:27], s37 offen
    buffer_load_dwordx4 a[132:135], v203, s[24:27], s37 offen
    buffer_load_dwordx4 a[136:139], v204, s[24:27], s37 offen
    buffer_load_dwordx4 a[140:143], v205, s[24:27], s37 offen
    buffer_load_dwordx4 a[144:147], v206, s[24:27], s37 offen
    buffer_load_dwordx4 a[148:151], v207, s[24:27], s37 offen
    buffer_load_dwordx4 a[152:155], v208, s[24:27], s37 offen
    buffer_load_dwordx4 a[156:159], v209, s[24:27], s37 offen
    buffer_load_dwordx4 a[160:163], v210, s[24:27], s37 offen
    buffer_load_dwordx4 a[164:167], v211, s[24:27], s37 offen
    buffer_load_dwordx4 a[168:171], v212, s[24:27], s37 offen
    buffer_load_dwordx4 a[172:175], v213, s[24:27], s37 offen
    buffer_load_dwordx4 a[176:179], v214, s[24:27], s37 offen
    s_mul_i32 s39, s34, 245760
    s_mul_i32 s38, s36, 640
    s_add_u32 s39, s39, s38
    buffer_load_dwordx4 a[180:183], v248, s[28:31], s39 offen
    buffer_load_dwordx4 a[184:187], v249, s[28:31], s39 offen
    buffer_load_dwordx4 a[188:191], v250, s[28:31], s39 offen
    buffer_load_dwordx4 a[192:195], v251, s[28:31], s39 offen
    buffer_load_dwordx4 a[196:199], v252, s[28:31], s39 offen
    s_add_u32 s39, s39, 40960
    buffer_load_dwordx4 a[200:203], v248, s[28:31], s39 offen
    buffer_load_dwordx4 a[204:207], v249, s[28:31], s39 offen
    buffer_load_dwordx4 a[208:211], v250, s[28:31], s39 offen
    buffer_load_dwordx4 a[212:215], v251, s[28:31], s39 offen
    buffer_load_dwordx4 a[216:219], v252, s[28:31], s39 offen
    s_add_u32 s39, s39, 40960
    buffer_load_dwordx4 a[220:223], v248, s[28:31], s39 offen
    buffer_load_dwordx4 a[224:227], v249, s[28:31], s39 offen
    buffer_load_dwordx4 a[228:231], v250, s[28:31], s39 offen
    buffer_load_dwordx4 a[232:235], v251, s[28:31], s39 offen
    buffer_load_dwordx4 a[236:239], v252, s[28:31], s39 offen
    s_add_u32 s39, s39, 40960
Li_noissue:
    s_cmp_lg_u32 s97, 0
    s_cbranch_scc1 Li_jobdone
    s_mov_b32 s97, 1
    s_cmp_ge_u32 s92, 7
    s_cbranch_scc1 Li_poison
    s_cmp_eq_u32 s92, 2
    s_cbranch_scc1 Li_poison
    s_load_dwordx2 s[8:9], s[0:1], 0
    s_waitcnt lgkmcnt(0)
    s_mov_b32 s10, 0x280000
    s_mov_b32 s11, 0x20000
    s_lshl_b32 s52, s48, 4
    v_lshrrev_b32 v3, 4, v0
    v_add_u32 v3, s52, v3
    v_and_b32 v4, 15, v0
    v_mul_u32_u24 v5, 0x500, v3
    v_lshl_add_u32 v5, v4, 4, v5
    buffer_load_dwordx4 v[8:11], v5, s[8:11], 0 offen offset:0
    buffer_load_dwordx4 v[12:15], v5, s[8:11], 0 offen offset:256
    buffer_load_dwordx4 v[16:19], v5, s[8:11], 0 offen offset:512
    buffer_load_dwordx4 v[20:23], v5, s[8:11], 0 offen offset:768
    buffer_load_dwordx4 v[24:27], v5, s[8:11], 0 offen offset:1024
    v_lshrrev_b32 v6, 4, v3
    v_mul_u32_u24 v6, 0x5000, v6
    v_and_b32 v7, 15, v3
    v_lshl_add_u32 v6, v7, 4, v6
    v_lshl_add_u32 v6, v4, 8, v6
    s_waitcnt vmcnt(0)
    v_lshlrev_b32 v32, 16, v8
    v_and_b32 v33, 0xffff0000, v8
    v_lshlrev_b32 v34, 16, v9
    v_and_b32 v35, 0xffff0000, v9
    v_lshlrev_b32 v36, 16, v10
    v_and_b32 v37, 0xffff0000, v10
    v_lshlrev_b32 v38, 16, v11
    v_and_b32 v39, 0xffff0000, v11
    v_lshlrev_b32 v40, 16, v12
    v_and_b32 v41, 0xffff0000, v12
    v_lshlrev_b32 v42, 16, v13
    v_and_b32 v43, 0xffff0000, v13
    v_lshlrev_b32 v44, 16, v14
    v_and_b32 v45, 0xffff0000, v14
    v_lshlrev_b32 v46, 16, v15
    v_and_b32 v47, 0xffff0000, v15
    v_lshlrev_b32 v48, 16, v16
    v_and_b32 v49, 0xffff0000, v16
    v_lshlrev_b32 v50, 16, v17
    v_and_b32 v51, 0xffff0000, v17
    v_lshlrev_b32 v52, 16, v18
    v_and_b32 v53, 0xffff0000, v18
    v_lshlrev_b32 v54, 16, v19
    v_and_b32 v55, 0xffff0000, v19
    v_lshlrev_b32 v56, 16, v20
    v_and_b32 v57, 0xffff0000, v20
    v_lshlrev_b32 v58, 16, v21
    v_and_b32 v59, 0xffff0000, v21
    v_lshlrev_b32 v60, 16, v22
    v_and_b32 v61, 0xffff0000, v22
    v_lshlrev_b32 v62, 16, v23
    v_and_b32 v63, 0xffff0000, v23
    v_lshlrev_b32 v64, 16, v24
    v_and_b32 v65, 0xffff0000, v24
    v_lshlrev_b32 v66, 16, v25
    v_and_b32 v67, 0xffff0000, v25
    v_lshlrev_b32 v68, 16, v26
    v_and_b32 v69, 0xffff0000, v26
    v_lshlrev_b32 v70, 16, v27
    v_and_b32 v71, 0xffff0000, v27
    v_pk_add_f32 v[72:73], v[32:33], v[34:35]
    v_pk_add_f32 v[72:73], v[72:73], v[36:37]
    v_pk_add_f32 v[72:73], v[72:73], v[38:39]
    v_pk_add_f32 v[72:73], v[72:73], v[40:41]
    v_pk_add_f32 v[72:73], v[72:73], v[42:43]
    v_pk_add_f32 v[72:73], v[72:73], v[44:45]
    v_pk_add_f32 v[72:73], v[72:73], v[46:47]
    v_pk_add_f32 v[72:73], v[72:73], v[48:49]
    v_pk_add_f32 v[72:73], v[72:73], v[50:51]
    v_pk_add_f32 v[72:73], v[72:73], v[52:53]
    v_pk_add_f32 v[72:73], v[72:73], v[54:55]
    v_pk_add_f32 v[72:73], v[72:73], v[56:57]
    v_pk_add_f32 v[72:73], v[72:73], v[58:59]
    v_pk_add_f32 v[72:73], v[72:73], v[60:61]
    v_pk_add_f32 v[72:73], v[72:73], v[62:63]
    v_pk_add_f32 v[72:73], v[72:73], v[64:65]
    v_pk_add_f32 v[72:73], v[72:73], v[66:67]
    v_pk_add_f32 v[72:73], v[72:73], v[68:69]
    v_pk_add_f32 v[72:73], v[72:73], v[70:71]
    v_add_f32 v72, v72, v73
    s_nop 1
    v_add_f32_dpp v72, v72, v72 row_ror:8 row_mask:0xf bank_mask:0xf
    s_nop 1
    v_add_f32_dpp v72, v72, v72 row_ror:4 row_mask:0xf bank_mask:0xf
    s_nop 1
    v_add_f32_dpp v72, v72, v72 row_ror:2 row_mask:0xf bank_mask:0xf
    s_nop 1
    v_add_f32_dpp v72, v72, v72 row_ror:1 row_mask:0xf bank_mask:0xf
    v_mul_f32 v72, 0x3acccccd, v72
    v_pk_add_f32 v[32:33], v[32:33], v[72:73] op_sel_hi:[1,0] neg_lo:[0,1] neg_hi:[0,1]
    v_pk_add_f32 v[34:35], v[34:35], v[72:73] op_sel_hi:[1,0] neg_lo:[0,1] neg_hi:[0,1]
    v_pk_add_f32 v[36:37], v[36:37], v[72:73] op_sel_hi:[1,0] neg_lo:[0,1] neg_hi:[0,1]
    v_pk_add_f32 v[38:39], v[38:39], v[72:73] op_sel_hi:[1,0] neg_lo:[0,1] neg_hi:[0,1]
    v_pk_add_f32 v[40:41], v[40:41], v[72:73] op_sel_hi:[1,0] neg_lo:[0,1] neg_hi:[0,1]
    v_pk_add_f32 v[42:43], v[42:43], v[72:73] op_sel_hi:[1,0] neg_lo:[0,1] neg_hi:[0,1]
    v_pk_add_f32 v[44:45], v[44:45], v[72:73] op_sel_hi:[1,0] neg_lo:[0,1] neg_hi:[0,1]
    v_pk_add_f32 v[46:47], v[46:47], v[72:73] op_sel_hi:[1,0] neg_lo:[0,1] neg_hi:[0,1]
    v_pk_add_f32 v[48:49], v[48:49], v[72:73] op_sel_hi:[1,0] neg_lo:[0,1] neg_hi:[0,1]
    v_pk_add_f32 v[50:51], v[50:51], v[72:73] op_sel_hi:[1,0] neg_lo:[0,1] neg_hi:[0,1]
    v_pk_add_f32 v[52:53], v[52:53], v[72:73] op_sel_hi:[1,0] neg_lo:[0,1] neg_hi:[0,1]
    v_pk_add_f32 v[54:55], v[54:55], v[72:73] op_sel_hi:[1,0] neg_lo:[0,1] neg_hi:[0,1]
    v_pk_add_f32 v[56:57], v[56:57], v[72:73] op_sel_hi:[1,0] neg_lo:[0,1] neg_hi:[0,1]
    v_pk_add_f32 v[58:59], v[58:59], v[72:73] op_sel_hi:[1,0] neg_lo:[0,1] neg_hi:[0,1]
    v_pk_add_f32 v[60:61], v[60:61], v[72:73] op_sel_hi:[1,0] neg_lo:[0,1] neg_hi:[0,1]
    v_pk_add_f32 v[62:63], v[62:63], v[72:73] op_sel_hi:[1,0] neg_lo:[0,1] neg_hi:[0,1]
    v_pk_add_f32 v[64:65], v[64:65], v[72:73] op_sel_hi:[1,0] neg_lo:[0,1] neg_hi:[0,1]
    v_pk_add_f32 v[66:67], v[66:67], v[72:73] op_sel_hi:[1,0] neg_lo:[0,1] neg_hi:[0,1]
    v_pk_add_f32 v[68:69], v[68:69], v[72:73] op_sel_hi:[1,0] neg_lo:[0,1] neg_hi:[0,1]
    v_pk_add_f32 v[70:71], v[70:71], v[72:73] op_sel_hi:[1,0] neg_lo:[0,1] neg_hi:[0,1]
    v_pk_mul_f32 v[74:75], v[32:33], v[32:33]
    v_pk_fma_f32 v[74:75], v[34:35], v[34:35], v[74:75]
    v_pk_fma_f32 v[74:75], v[36:37], v[36:37], v[74:75]
    v_pk_fma_f32 v[74:75], v[38:39], v[38:39], v[74:75]
    v_pk_fma_f32 v[74:75], v[40:41], v[40:41], v[74:75]
    v_pk_fma_f32 v[74:75], v[42:43], v[42:43], v[74:75]
    v_pk_fma_f32 v[74:75], v[44:45], v[44:45], v[74:75]
    v_pk_fma_f32 v[74:75], v[46:47], v[46:47], v[74:75]
    v_pk_fma_f32 v[74:75], v[48:49], v[48:49], v[74:75]
    v_pk_fma_f32 v[74:75], v[50:51], v[50:51], v[74:75]
    v_pk_fma_f32 v[74:75], v[52:53], v[52:53], v[74:75]
    v_pk_fma_f32 v[74:75], v[54:55], v[54:55], v[74:75]
    v_pk_fma_f32 v[74:75], v[56:57], v[56:57], v[74:75]
    v_pk_fma_f32 v[74:75], v[58:59], v[58:59], v[74:75]
    v_pk_fma_f32 v[74:75], v[60:61], v[60:61], v[74:75]
    v_pk_fma_f32 v[74:75], v[62:63], v[62:63], v[74:75]
    v_pk_fma_f32 v[74:75], v[64:65], v[64:65], v[74:75]
    v_pk_fma_f32 v[74:75], v[66:67], v[66:67], v[74:75]
    v_pk_fma_f32 v[74:75], v[68:69], v[68:69], v[74:75]
    v_pk_fma_f32 v[74:75], v[70:71], v[70:71], v[74:75]
    v_add_f32 v74, v74, v75
    s_nop 1
    v_add_f32_dpp v74, v74, v74 row_ror:8 row_mask:0xf bank_mask:0xf
    s_nop 1
    v_add_f32_dpp v74, v74, v74 row_ror:4 row_mask:0xf bank_mask:0xf
    s_nop 1
    v_add_f32_dpp v74, v74, v74 row_ror:2 row_mask:0xf bank_mask:0xf
    s_nop 1
    v_add_f32_dpp v74, v74, v74 row_ror:1 row_mask:0xf bank_mask:0xf
    v_mov_b32 v76, 0x3727c5ac
    v_fmac_f32 v76, 0x3acccccd, v74
    v_rsq_f32 v76, v76
    s_nop 0
    v_pk_mul_f32 v[32:33], v[32:33], v[76:77] op_sel_hi:[1,0]
    v_pk_mul_f32 v[34:35], v[34:35], v[76:77] op_sel_hi:[1,0]
    v_pk_mul_f32 v[36:37], v[36:37], v[76:77] op_sel_hi:[1,0]
    v_pk_mul_f32 v[38:39], v[38:39], v[76:77] op_sel_hi:[1,0]
    v_pk_mul_f32 v[40:41], v[40:41], v[76:77] op_sel_hi:[1,0]
    v_pk_mul_f32 v[42:43], v[42:43], v[76:77] op_sel_hi:[1,0]
    v_pk_mul_f32 v[44:45], v[44:45], v[76:77] op_sel_hi:[1,0]
    v_pk_mul_f32 v[46:47], v[46:47], v[76:77] op_sel_hi:[1,0]
    v_pk_mul_f32 v[48:49], v[48:49], v[76:77] op_sel_hi:[1,0]
    v_pk_mul_f32 v[50:51], v[50:51], v[76:77] op_sel_hi:[1,0]
    v_pk_mul_f32 v[52:53], v[52:53], v[76:77] op_sel_hi:[1,0]
    v_pk_mul_f32 v[54:55], v[54:55], v[76:77] op_sel_hi:[1,0]
    v_pk_mul_f32 v[56:57], v[56:57], v[76:77] op_sel_hi:[1,0]
    v_pk_mul_f32 v[58:59], v[58:59], v[76:77] op_sel_hi:[1,0]
    v_pk_mul_f32 v[60:61], v[60:61], v[76:77] op_sel_hi:[1,0]
    v_pk_mul_f32 v[62:63], v[62:63], v[76:77] op_sel_hi:[1,0]
    v_pk_mul_f32 v[64:65], v[64:65], v[76:77] op_sel_hi:[1,0]
    v_pk_mul_f32 v[66:67], v[66:67], v[76:77] op_sel_hi:[1,0]
    v_pk_mul_f32 v[68:69], v[68:69], v[76:77] op_sel_hi:[1,0]
    v_pk_mul_f32 v[70:71], v[70:71], v[76:77] op_sel_hi:[1,0]
    v_cvt_pk_bf16_f32 v8, v32, v33
    v_cvt_pk_bf16_f32 v9, v34, v35
    v_cvt_pk_bf16_f32 v10, v36, v37
    v_cvt_pk_bf16_f32 v11, v38, v39
    v_cvt_pk_bf16_f32 v12, v40, v41
    v_cvt_pk_bf16_f32 v13, v42, v43
    v_cvt_pk_bf16_f32 v14, v44, v45
    v_cvt_pk_bf16_f32 v15, v46, v47
    v_cvt_pk_bf16_f32 v16, v48, v49
    v_cvt_pk_bf16_f32 v17, v50, v51
    v_cvt_pk_bf16_f32 v18, v52, v53
    v_cvt_pk_bf16_f32 v19, v54, v55
    v_cvt_pk_bf16_f32 v20, v56, v57
    v_cvt_pk_bf16_f32 v21, v58, v59
    v_cvt_pk_bf16_f32 v22, v60, v61
    v_cvt_pk_bf16_f32 v23, v62, v63
    v_cvt_pk_bf16_f32 v24, v64, v65
    v_cvt_pk_bf16_f32 v25, v66, v67
    v_cvt_pk_bf16_f32 v26, v68, v69
    v_cvt_pk_bf16_f32 v27, v70, v71
    s_mov_b32 s52, 0xc00000
    buffer_store_dwordx4 v[8:11], v6, s[4:7], s52 offen sc1
    s_add_u32 s52, s52, 4096
    buffer_store_dwordx4 v[12:15], v6, s[4:7], s52 offen sc1
    s_add_u32 s52, s52, 4096
    buffer_store_dwordx4 v[16:19], v6, s[4:7], s52 offen sc1
    s_add_u32 s52, s52, 4096
    buffer_store_dwordx4 v[20:23], v6, s[4:7], s52 offen sc1
    s_add_u32 s52, s52, 4096
    buffer_store_dwordx4 v[24:27], v6, s[4:7], s52 offen sc1
    s_branch Li_arrive
Li_poison:
    s_lshl_b32 s52, s96, 12
    s_add_u32 s52, s52, 0x10a000
    v_lshlrev_b32 v12, 4, v0
    v_mov_b32 v8, -1
    v_mov_b32 v9, -1
    v_mov_b32 v10, -1
    v_mov_b32 v11, -1
    s_cmp_ge_u32 s52, 0x9c0000
    s_cbranch_scc1 Lpo_23
    buffer_store_dwordx4 v[8:11], v12, s[4:7], s52 offen sc1
    s_add_u32 s52, s52, 0x60000
    s_cmp_ge_u32 s52, 0x9c0000
    s_cbranch_scc1 Lpo_23
    buffer_store_dwordx4 v[8:11], v12, s[4:7], s52 offen sc1
    s_add_u32 s52, s52, 0x60000
    s_cmp_ge_u32 s52, 0x9c0000
    s_cbranch_scc1 Lpo_23
    buffer_store_dwordx4 v[8:11], v12, s[4:7], s52 offen sc1
    s_add_u32 s52, s52, 0x60000
    s_cmp_ge_u32 s52, 0x9c0000
    s_cbranch_scc1 Lpo_23
    buffer_store_dwordx4 v[8:11], v12, s[4:7], s52 offen sc1
    s_add_u32 s52, s52, 0x60000
    s_cmp_ge_u32 s52, 0x9c0000
    s_cbranch_scc1 Lpo_23
    buffer_store_dwordx4 v[8:11], v12, s[4:7], s52 offen sc1
    s_add_u32 s52, s52, 0x60000
    s_cmp_ge_u32 s52, 0x9c0000
    s_cbranch_scc1 Lpo_23
    buffer_store_dwordx4 v[8:11], v12, s[4:7], s52 offen sc1
    s_add_u32 s52, s52, 0x60000
    s_cmp_ge_u32 s52, 0x9c0000
    s_cbranch_scc1 Lpo_23
    buffer_store_dwordx4 v[8:11], v12, s[4:7], s52 offen sc1
    s_add_u32 s52, s52, 0x60000
    s_cmp_ge_u32 s52, 0x9c0000
    s_cbranch_scc1 Lpo_23
    buffer_store_dwordx4 v[8:11], v12, s[4:7], s52 offen sc1
    s_add_u32 s52, s52, 0x60000
    s_cmp_ge_u32 s52, 0x9c0000
    s_cbranch_scc1 Lpo_23
    buffer_store_dwordx4 v[8:11], v12, s[4:7], s52 offen sc1
    s_add_u32 s52, s52, 0x60000
    s_cmp_ge_u32 s52, 0x9c0000
    s_cbranch_scc1 Lpo_23
    buffer_store_dwordx4 v[8:11], v12, s[4:7], s52 offen sc1
    s_add_u32 s52, s52, 0x60000
    s_cmp_ge_u32 s52, 0x9c0000
    s_cbranch_scc1 Lpo_23
    buffer_store_dwordx4 v[8:11], v12, s[4:7], s52 offen sc1
    s_add_u32 s52, s52, 0x60000
    s_cmp_ge_u32 s52, 0x9c0000
    s_cbranch_scc1 Lpo_23
    buffer_store_dwordx4 v[8:11], v12, s[4:7], s52 offen sc1
    s_add_u32 s52, s52, 0x60000
    s_cmp_ge_u32 s52, 0x9c0000
    s_cbranch_scc1 Lpo_23
    buffer_store_dwordx4 v[8:11], v12, s[4:7], s52 offen sc1
    s_add_u32 s52, s52, 0x60000
    s_cmp_ge_u32 s52, 0x9c0000
    s_cbranch_scc1 Lpo_23
    buffer_store_dwordx4 v[8:11], v12, s[4:7], s52 offen sc1
    s_add_u32 s52, s52, 0x60000
    s_cmp_ge_u32 s52, 0x9c0000
    s_cbranch_scc1 Lpo_23
    buffer_store_dwordx4 v[8:11], v12, s[4:7], s52 offen sc1
    s_add_u32 s52, s52, 0x60000
    s_cmp_ge_u32 s52, 0x9c0000
    s_cbranch_scc1 Lpo_23
    buffer_store_dwordx4 v[8:11], v12, s[4:7], s52 offen sc1
    s_add_u32 s52, s52, 0x60000
    s_cmp_ge_u32 s52, 0x9c0000
    s_cbranch_scc1 Lpo_23
    buffer_store_dwordx4 v[8:11], v12, s[4:7], s52 offen sc1
    s_add_u32 s52, s52, 0x60000
    s_cmp_ge_u32 s52, 0x9c0000
    s_cbranch_scc1 Lpo_23
    buffer_store_dwordx4 v[8:11], v12, s[4:7], s52 offen sc1
    s_add_u32 s52, s52, 0x60000
    s_cmp_ge_u32 s52, 0x9c0000
    s_cbranch_scc1 Lpo_23
    buffer_store_dwordx4 v[8:11], v12, s[4:7], s52 offen sc1
    s_add_u32 s52, s52, 0x60000
    s_cmp_ge_u32 s52, 0x9c0000
    s_cbranch_scc1 Lpo_23
    buffer_store_dwordx4 v[8:11], v12, s[4:7], s52 offen sc1
    s_add_u32 s52, s52, 0x60000
    s_cmp_ge_u32 s52, 0x9c0000
    s_cbranch_scc1 Lpo_23
    buffer_store_dwordx4 v[8:11], v12, s[4:7], s52 offen sc1
    s_add_u32 s52, s52, 0x60000
    s_cmp_ge_u32 s52, 0x9c0000
    s_cbranch_scc1 Lpo_23
    buffer_store_dwordx4 v[8:11], v12, s[4:7], s52 offen sc1
    s_add_u32 s52, s52, 0x60000
    s_cmp_ge_u32 s52, 0x9c0000
    s_cbranch_scc1 Lpo_23
    buffer_store_dwordx4 v[8:11], v12, s[4:7], s52 offen sc1
    s_add_u32 s52, s52, 0x60000
    s_cmp_ge_u32 s52, 0x9c0000
    s_cbranch_scc1 Lpo_23
    buffer_store_dwordx4 v[8:11], v12, s[4:7], s52 offen sc1
    s_add_u32 s52, s52, 0x60000
Lpo_23:
    s_cmp_lg_u32 s96, 95
    s_cbranch_scc1 Lpm_24
    s_load_dwordx2 s[12:13], s[0:1], 8
    s_waitcnt lgkmcnt(0)
    s_mov_b32 s14, 0x2800
    s_mov_b32 s15, 0x20000
    v_add_u32 v3, 0, v0
    v_and_b32 v4, 7, v3
    v_lshrrev_b32 v5, 3, v3
    v_mul_u32_u24 v6, 0x500, v4
    v_lshrrev_b32 v7, 3, v5
    v_lshl_add_u32 v6, v7, 7, v6
    v_bfe_u32 v7, v5, 2, 1
    v_lshl_add_u32 v6, v7, 6, v6
    v_bfe_u32 v7, v5, 1, 1
    v_lshl_add_u32 v6, v7, 4, v6
    v_and_b32 v7, 1, v5
    v_lshl_add_u32 v6, v7, 2, v6
    buffer_load_dword v16, v6, s[12:15], 0 offen offset:0
    buffer_load_dword v17, v6, s[12:15], 0 offen offset:32
    buffer_load_dword v18, v6, s[12:15], 0 offen offset:8
    buffer_load_dword v19, v6, s[12:15], 0 offen offset:40
    v_lshlrev_b32 v13, 4, v3
    v_cmp_gt_u32 vcc, 640, v3
    s_and_saveexec_b64 s[54:55], vcc
    s_waitcnt vmcnt(0)
    s_mov_b32 s52, 0x100000
    buffer_store_dwordx4 v[16:19], v13, s[4:7], s52 offen sc1
    s_mov_b32 s52, 0x102800
    buffer_store_dwordx4 v[16:19], v13, s[4:7], s52 offen sc1
    s_mov_b32 s52, 0x105000
    buffer_store_dwordx4 v[16:19], v13, s[4:7], s52 offen sc1
    s_mov_b32 s52, 0x107800
    buffer_store_dwordx4 v[16:19], v13, s[4:7], s52 offen sc1
    s_mov_b64 exec, s[54:55]
    s_waitcnt vmcnt(0)
    v_add_u32 v3, 256, v0
    v_and_b32 v4, 7, v3
    v_lshrrev_b32 v5, 3, v3
    v_mul_u32_u24 v6, 0x500, v4
    v_lshrrev_b32 v7, 3, v5
    v_lshl_add_u32 v6, v7, 7, v6
    v_bfe_u32 v7, v5, 2, 1
    v_lshl_add_u32 v6, v7, 6, v6
    v_bfe_u32 v7, v5, 1, 1
    v_lshl_add_u32 v6, v7, 4, v6
    v_and_b32 v7, 1, v5
    v_lshl_add_u32 v6, v7, 2, v6
    buffer_load_dword v16, v6, s[12:15], 0 offen offset:0
    buffer_load_dword v17, v6, s[12:15], 0 offen offset:32
    buffer_load_dword v18, v6, s[12:15], 0 offen offset:8
    buffer_load_dword v19, v6, s[12:15], 0 offen offset:40
    v_lshlrev_b32 v13, 4, v3
    v_cmp_gt_u32 vcc, 640, v3
    s_and_saveexec_b64 s[54:55], vcc
    s_waitcnt vmcnt(0)
    s_mov_b32 s52, 0x100000
    buffer_store_dwordx4 v[16:19], v13, s[4:7], s52 offen sc1
    s_mov_b32 s52, 0x102800
    buffer_store_dwordx4 v[16:19], v13, s[4:7], s52 offen sc1
    s_mov_b32 s52, 0x105000
    buffer_store_dwordx4 v[16:19], v13, s[4:7], s52 offen sc1
    s_mov_b32 s52, 0x107800
    buffer_store_dwordx4 v[16:19], v13, s[4:7], s52 offen sc1
    s_mov_b64 exec, s[54:55]
    s_waitcnt vmcnt(0)
    v_add_u32 v3, 512, v0
    v_and_b32 v4, 7, v3
    v_lshrrev_b32 v5, 3, v3
    v_mul_u32_u24 v6, 0x500, v4
    v_lshrrev_b32 v7, 3, v5
    v_lshl_add_u32 v6, v7, 7, v6
    v_bfe_u32 v7, v5, 2, 1
    v_lshl_add_u32 v6, v7, 6, v6
    v_bfe_u32 v7, v5, 1, 1
    v_lshl_add_u32 v6, v7, 4, v6
    v_and_b32 v7, 1, v5
    v_lshl_add_u32 v6, v7, 2, v6
    buffer_load_dword v16, v6, s[12:15], 0 offen offset:0
    buffer_load_dword v17, v6, s[12:15], 0 offen offset:32
    buffer_load_dword v18, v6, s[12:15], 0 offen offset:8
    buffer_load_dword v19, v6, s[12:15], 0 offen offset:40
    v_lshlrev_b32 v13, 4, v3
    v_cmp_gt_u32 vcc, 640, v3
    s_and_saveexec_b64 s[54:55], vcc
    s_waitcnt vmcnt(0)
    s_mov_b32 s52, 0x100000
    buffer_store_dwordx4 v[16:19], v13, s[4:7], s52 offen sc1
    s_mov_b32 s52, 0x102800
    buffer_store_dwordx4 v[16:19], v13, s[4:7], s52 offen sc1
    s_mov_b32 s52, 0x105000
    buffer_store_dwordx4 v[16:19], v13, s[4:7], s52 offen sc1
    s_mov_b32 s52, 0x107800
    buffer_store_dwordx4 v[16:19], v13, s[4:7], s52 offen sc1
    s_mov_b64 exec, s[54:55]
    s_waitcnt vmcnt(0)
    v_mov_b32 v8, 0
    v_mov_b32 v9, 0
    v_mov_b32 v10, 0
    v_mov_b32 v11, 0
    s_mov_b32 s52, 0
    buffer_store_dwordx4 v[8:11], v12, s[4:7], s52 offen sc1
    s_mov_b32 s52, 4096
    buffer_store_dwordx4 v[8:11], v12, s[4:7], s52 offen sc1
    s_mov_b32 s52, 8192
    buffer_store_dwordx4 v[8:11], v12, s[4:7], s52 offen sc1
    s_mov_b32 s52, 12288
    buffer_store_dwordx4 v[8:11], v12, s[4:7], s52 offen sc1
    s_mov_b32 s52, 16384
    buffer_store_dwordx4 v[8:11], v12, s[4:7], s52 offen sc1
    s_mov_b32 s52, 20480
    buffer_store_dwordx4 v[8:11], v12, s[4:7], s52 offen sc1
    s_mov_b32 s52, 24576
    buffer_store_dwordx4 v[8:11], v12, s[4:7], s52 offen sc1
    s_mov_b32 s52, 28672
    buffer_store_dwordx4 v[8:11], v12, s[4:7], s52 offen sc1
    s_mov_b32 s52, 32768
    buffer_store_dwordx4 v[8:11], v12, s[4:7], s52 offen sc1
    s_mov_b32 s52, 36864
    buffer_store_dwordx4 v[8:11], v12, s[4:7], s52 offen sc1
    s_mov_b32 s52, 40960
    buffer_store_dwordx4 v[8:11], v12, s[4:7], s52 offen sc1
    s_mov_b32 s52, 45056
    buffer_store_dwordx4 v[8:11], v12, s[4:7], s52 offen sc1
Lpm_24:
Li_arrive:
    s_waitcnt vmcnt(0)
    s_barrier
    s_cmp_lg_u32 s20, 0
    s_cbranch_scc1 Lar_25
    v_mov_b32 v4, 4
    v_mov_b32 v5, 1
    s_mov_b64 exec, 1
    buffer_atomic_add v5, v4, s[88:91], 0 offen sc1
    s_mov_b64 exec, -1
Lar_25:
Li_jobdone:
    s_cmp_eq_u32 s94, -1
    s_cbranch_scc1 Li_done
    v_and_b32 v1, 63, v0
    v_lshrrev_b32 v3, 6, v0
    v_lshlrev_b32 v2, 4, v1
    v_readfirstlane_b32 s20, v3
    s_waitcnt vmcnt(0)
    ds_write_b128 v100, a[120:123]
    ds_write_b128 v101, a[124:127]
    ds_write_b128 v102, a[128:131]
    ds_write_b128 v103, a[132:135]
    ds_write_b128 v104, a[136:139]
    ds_write_b128 v105, a[140:143]
    ds_write_b128 v106, a[144:147]
    ds_write_b128 v107, a[148:151]
    ds_write_b128 v108, a[152:155]
    ds_write_b128 v109, a[156:159]
    ds_write_b128 v110, a[160:163]
    ds_write_b128 v111, a[164:167]
    ds_write_b128 v112, a[168:171]
    ds_write_b128 v113, a[172:175]
    ds_write_b128 v114, a[176:179]
    v_and_b32 v3, 15, v1
    v_lshrrev_b32 v4, 4, v1
    v_lshrrev_b32 v5, 2, v3
    v_lshl_add_u32 v5, v4, 3, v5
    v_mul_u32_u24 v124, 0x2a0, v5
    v_and_b32 v5, 3, v3
    v_lshl_add_u32 v124, v5, 3, v124
    s_mul_i32 s40, s20, 160
    s_add_u32 s40, s40, 64000
    v_add_u32 v124, s40, v124
    ds_write_b128 v115, a[180:183] offset:0
    ds_write_b128 v116, a[184:187] offset:0
    ds_write_b128 v117, a[188:191] offset:0
    ds_write_b128 v118, a[192:195] offset:0
    ds_write_b128 v119, a[196:199] offset:0
    s_waitcnt lgkmcnt(0)
    buffer_load_dwordx4 a[180:183], v248, s[28:31], s39 offen
    buffer_load_dwordx4 a[184:187], v249, s[28:31], s39 offen
    buffer_load_dwordx4 a[188:191], v250, s[28:31], s39 offen
    buffer_load_dwordx4 a[192:195], v251, s[28:31], s39 offen
    buffer_load_dwordx4 a[196:199], v252, s[28:31], s39 offen
    s_add_u32 s39, s39, 40960
    s_barrier
    ds_read_b64_tr_b16 a[0:1], v124 offset:0
    ds_read_b64_tr_b16 a[2:3], v124 offset:2688
    ds_read_b64_tr_b16 a[24:25], v124 offset:32
    ds_read_b64_tr_b16 a[26:27], v124 offset:2720
    ds_read_b64_tr_b16 a[48:49], v124 offset:64
    ds_read_b64_tr_b16 a[50:51], v124 offset:2752
    ds_read_b64_tr_b16 a[72:73], v124 offset:96
    ds_read_b64_tr_b16 a[74:75], v124 offset:2784
    ds_read_b64_tr_b16 a[96:97], v124 offset:128
    ds_read_b64_tr_b16 a[98:99], v124 offset:2816
    ds_write_b128 v115, a[200:203] offset:21504
    ds_write_b128 v116, a[204:207] offset:21504
    ds_write_b128 v117, a[208:211] offset:21504
    ds_write_b128 v118, a[212:215] offset:21504
    ds_write_b128 v119, a[216:219] offset:21504
    s_waitcnt lgkmcnt(0)
    buffer_load_dwordx4 a[200:203], v248, s[28:31], s39 offen
    buffer_load_dwordx4 a[204:207], v249, s[28:31], s39 offen
    buffer_load_dwordx4 a[208:211], v250, s[28:31], s39 offen
    buffer_load_dwordx4 a[212:215], v251, s[28:31], s39 offen
    buffer_load_dwordx4 a[216:219], v252, s[28:31], s39 offen
    s_add_u32 s39, s39, 40960
    s_barrier
    ds_read_b64_tr_b16 a[4:5], v124 offset:21504
    ds_read_b64_tr_b16 a[6:7], v124 offset:24192
    ds_read_b64_tr_b16 a[28:29], v124 offset:21536
    ds_read_b64_tr_b16 a[30:31], v124 offset:24224
    ds_read_b64_tr_b16 a[52:53], v124 offset:21568
    ds_read_b64_tr_b16 a[54:55], v124 offset:24256
    ds_read_b64_tr_b16 a[76:77], v124 offset:21600
    ds_read_b64_tr_b16 a[78:79], v124 offset:24288
    ds_read_b64_tr_b16 a[100:101], v124 offset:21632
    ds_read_b64_tr_b16 a[102:103], v124 offset:24320
    ds_write_b128 v115, a[220:223] offset:0
    ds_write_b128 v116, a[224:227] offset:0
    ds_write_b128 v117, a[228:231] offset:0
    ds_write_b128 v118, a[232:235] offset:0
    ds_write_b128 v119, a[236:239] offset:0
    s_waitcnt lgkmcnt(0)
    buffer_load_dwordx4 a[220:223], v248, s[28:31], s39 offen
    buffer_load_dwordx4 a[224:227], v249, s[28:31], s39 offen
    buffer_load_dwordx4 a[228:231], v250, s[28:31], s39 offen
    buffer_load_dwordx4 a[232:235], v251, s[28:31], s39 offen
    buffer_load_dwordx4 a[236:239], v252, s[28:31], s39 offen
    s_add_u32 s39, s39, 40960
    s_barrier
    ds_read_b64_tr_b16 a[8:9], v124 offset:0
    ds_read_b64_tr_b16 a[10:11], v124 offset:2688
    ds_read_b64_tr_b16 a[32:33], v124 offset:32
    ds_read_b64_tr_b16 a[34:35], v124 offset:2720
    ds_read_b64_tr_b16 a[56:57], v124 offset:64
    ds_read_b64_tr_b16 a[58:59], v124 offset:2752
    ds_read_b64_tr_b16 a[80:81], v124 offset:96
    ds_read_b64_tr_b16 a[82:83], v124 offset:2784
    ds_read_b64_tr_b16 a[104:105], v124 offset:128
    ds_read_b64_tr_b16 a[106:107], v124 offset:2816
    s_waitcnt vmcnt(10)
    ds_write_b128 v115, a[180:183] offset:21504
    ds_write_b128 v116, a[184:187] offset:21504
    ds_write_b128 v117, a[188:191] offset:21504
    ds_write_b128 v118, a[192:195] offset:21504
    ds_write_b128 v119, a[196:199] offset:21504
    s_waitcnt lgkmcnt(0)
    s_barrier
    ds_read_b64_tr_b16 a[12:13], v124 offset:21504
    ds_read_b64_tr_b16 a[14:15], v124 offset:24192
    ds_read_b64_tr_b16 a[36:37], v124 offset:21536
    ds_read_b64_tr_b16 a[38:39], v124 offset:24224
    ds_read_b64_tr_b16 a[60:61], v124 offset:21568
    ds_read_b64_tr_b16 a[62:63], v124 offset:24256
    ds_read_b64_tr_b16 a[84:85], v124 offset:21600
    ds_read_b64_tr_b16 a[86:87], v124 offset:24288
    ds_read_b64_tr_b16 a[108:109], v124 offset:21632
    ds_read_b64_tr_b16 a[110:111], v124 offset:24320
    s_waitcnt vmcnt(5)
    ds_write_b128 v115, a[200:203] offset:0
    ds_write_b128 v116, a[204:207] offset:0
    ds_write_b128 v117, a[208:211] offset:0
    ds_write_b128 v118, a[212:215] offset:0
    ds_write_b128 v119, a[216:219] offset:0
    s_waitcnt lgkmcnt(0)
    s_barrier
    ds_read_b64_tr_b16 a[16:17], v124 offset:0
    ds_read_b64_tr_b16 a[18:19], v124 offset:2688
    ds_read_b64_tr_b16 a[40:41], v124 offset:32
    ds_read_b64_tr_b16 a[42:43], v124 offset:2720
    ds_read_b64_tr_b16 a[64:65], v124 offset:64
    ds_read_b64_tr_b16 a[66:67], v124 offset:2752
    ds_read_b64_tr_b16 a[88:89], v124 offset:96
    ds_read_b64_tr_b16 a[90:91], v124 offset:2784
    ds_read_b64_tr_b16 a[112:113], v124 offset:128
    ds_read_b64_tr_b16 a[114:115], v124 offset:2816
    s_waitcnt vmcnt(0)
    ds_write_b128 v115, a[220:223] offset:21504
    ds_write_b128 v116, a[224:227] offset:21504
    ds_write_b128 v117, a[228:231] offset:21504
    ds_write_b128 v118, a[232:235] offset:21504
    ds_write_b128 v119, a[236:239] offset:21504
    s_waitcnt lgkmcnt(0)
    s_barrier
    ds_read_b64_tr_b16 a[20:21], v124 offset:21504
    ds_read_b64_tr_b16 a[22:23], v124 offset:24192
    ds_read_b64_tr_b16 a[44:45], v124 offset:21536
    ds_read_b64_tr_b16 a[46:47], v124 offset:24224
    ds_read_b64_tr_b16 a[68:69], v124 offset:21568
    ds_read_b64_tr_b16 a[70:71], v124 offset:24256
    ds_read_b64_tr_b16 a[92:93], v124 offset:21600
    ds_read_b64_tr_b16 a[94:95], v124 offset:24288
    ds_read_b64_tr_b16 a[116:117], v124 offset:21632
    ds_read_b64_tr_b16 a[118:119], v124 offset:24320
    s_waitcnt lgkmcnt(0)
    v_mul_u32_u24 v125, 0x190, v3
    v_lshl_add_u32 v125, v4, 4, v125
    s_lshr_b32 s40, s34, 3
    s_mul_i32 s40, s40, 80
    s_bfe_u32 s41, s34, 0x20001
    s_add_u32 s40, s40, s41
    s_mul_i32 s40, s40, 81920
    s_and_b32 s41, s34, 1
    s_lshl_b32 s41, s41, 12
    s_add_u32 s40, s40, s41
    s_add_u32 s40, s40, 0xc500000
    s_mul_i32 s42, s36, 20
    s_mul_i32 s41, s20, 5
    s_add_u32 s42, s42, s41
    s_add_u32 s41, s42, 0
    s_lshr_b32 s43, s41, 1
    s_mul_i32 s43, s43, 327680
    s_and_b32 s41, s41, 1
    s_lshl_b32 s41, s41, 11
    s_add_u32 s43, s43, s41
    s_add_u32 s44, s43, s40
    s_add_u32 s41, s42, 1
    s_lshr_b32 s43, s41, 1
    s_mul_i32 s43, s43, 327680
    s_and_b32 s41, s41, 1
    s_lshl_b32 s41, s41, 11
    s_add_u32 s43, s43, s41
    s_add_u32 s45, s43, s40
    s_add_u32 s41, s42, 2
    s_lshr_b32 s43, s41, 1
    s_mul_i32 s43, s43, 327680
    s_and_b32 s41, s41, 1
    s_lshl_b32 s41, s41, 11
    s_add_u32 s43, s43, s41
    s_add_u32 s46, s43, s40
    s_add_u32 s41, s42, 3
    s_lshr_b32 s43, s41, 1
    s_mul_i32 s43, s43, 327680
    s_and_b32 s41, s41, 1
    s_lshl_b32 s41, s41, 11
    s_add_u32 s43, s43, s41
    s_add_u32 s47, s43, s40
    s_add_u32 s41, s42, 4
    s_lshr_b32 s43, s41, 1
    s_mul_i32 s43, s43, 327680
    s_and_b32 s41, s41, 1
    s_lshl_b32 s41, s41, 11
    s_add_u32 s43, s43, s41
    s_add_u32 s48, s43, s40
    s_mul_i32 s49, s35, 5
    s_cmp_eq_u32 s95, -1
    s_cbranch_scc1 Li_pf_26
    s_mov_b32 s93, 1
    s_lshr_b32 s34, s95, 3
    s_bfe_u32 s35, s95, 0x20001
    s_and_b32 s36, s95, 1
    s_mul_i32 s37, s35, 1966080
    s_mul_i32 s38, s34, 384
    s_add_u32 s37, s37, s38
    buffer_load_dwordx4 a[120:123], v200, s[24:27], s37 offen
    buffer_load_dwordx4 a[124:127], v201, s[24:27], s37 offen
    buffer_load_dwordx4 a[128:131], v202, s[24:27], s37 offen
    buffer_load_dwordx4 a[132:135], v203, s[24:27], s37 offen
    buffer_load_dwordx4 a[136:139], v204, s[24:27], s37 offen
    buffer_load_dwordx4 a[140:143], v205, s[24:27], s37 offen
    buffer_load_dwordx4 a[144:147], v206, s[24:27], s37 offen
    buffer_load_dwordx4 a[148:151], v207, s[24:27], s37 offen
    buffer_load_dwordx4 a[152:155], v208, s[24:27], s37 offen
    buffer_load_dwordx4 a[156:159], v209, s[24:27], s37 offen
    buffer_load_dwordx4 a[160:163], v210, s[24:27], s37 offen
    buffer_load_dwordx4 a[164:167], v211, s[24:27], s37 offen
    buffer_load_dwordx4 a[168:171], v212, s[24:27], s37 offen
    buffer_load_dwordx4 a[172:175], v213, s[24:27], s37 offen
    buffer_load_dwordx4 a[176:179], v214, s[24:27], s37 offen
    s_mul_i32 s39, s34, 245760
    s_mul_i32 s38, s36, 640
    s_add_u32 s39, s39, s38
    buffer_load_dwordx4 a[180:183], v248, s[28:31], s39 offen
    buffer_load_dwordx4 a[184:187], v249, s[28:31], s39 offen
    buffer_load_dwordx4 a[188:191], v250, s[28:31], s39 offen
    buffer_load_dwordx4 a[192:195], v251, s[28:31], s39 offen
    buffer_load_dwordx4 a[196:199], v252, s[28:31], s39 offen
    s_add_u32 s39, s39, 40960
    buffer_load_dwordx4 a[200:203], v248, s[28:31], s39 offen
    buffer_load_dwordx4 a[204:207], v249, s[28:31], s39 offen
    buffer_load_dwordx4 a[208:211], v250, s[28:31], s39 offen
    buffer_load_dwordx4 a[212:215], v251, s[28:31], s39 offen
    buffer_load_dwordx4 a[216:219], v252, s[28:31], s39 offen
    s_add_u32 s39, s39, 40960
    buffer_load_dwordx4 a[220:223], v248, s[28:31], s39 offen
    buffer_load_dwordx4 a[224:227], v249, s[28:31], s39 offen
    buffer_load_dwordx4 a[228:231], v250, s[28:31], s39 offen
    buffer_load_dwordx4 a[232:235], v251, s[28:31], s39 offen
    buffer_load_dwordx4 a[236:239], v252, s[28:31], s39 offen
    s_add_u32 s39, s39, 40960
Li_pf_26:
    ds_read_b128 v[8:11], v125 offset:0
    ds_read_b128 v[12:15], v125 offset:64
    ds_read_b128 v[16:19], v125 offset:128
    ds_read_b128 v[20:23], v125 offset:192
    ds_read_b128 v[24:27], v125 offset:256
    ds_read_b128 v[28:31], v125 offset:320
    ds_read_b128 v[32:35], v125 offset:6400
    ds_read_b128 v[36:39], v125 offset:6464
    ds_read_b128 v[40:43], v125 offset:6528
    ds_read_b128 v[44:47], v125 offset:6592
    ds_read_b128 v[48:51], v125 offset:6656
    ds_read_b128 v[52:55], v125 offset:6720
    s_waitcnt lgkmcnt(6)
    v_mfma_f32_16x16x32_bf16 v[56:59], v[8:11], a[0:3], 0
    v_mfma_f32_16x16x32_bf16 v[60:63], v[8:11], a[24:27], 0
    v_mfma_f32_16x16x32_bf16 v[64:67], v[8:11], a[48:51], 0
    v_mfma_f32_16x16x32_bf16 v[68:71], v[8:11], a[72:75], 0
    v_mfma_f32_16x16x32_bf16 v[72:75], v[8:11], a[96:99], 0
    v_mfma_f32_16x16x32_bf16 v[56:59], v[12:15], a[4:7], v[56:59]
    v_mfma_f32_16x16x32_bf16 v[60:63], v[12:15], a[28:31], v[60:63]
    v_mfma_f32_16x16x32_bf16 v[64:67], v[12:15], a[52:55], v[64:67]
    v_mfma_f32_16x16x32_bf16 v[68:71], v[12:15], a[76:79], v[68:71]
    v_mfma_f32_16x16x32_bf16 v[72:75], v[12:15], a[100:103], v[72:75]
    v_mfma_f32_16x16x32_bf16 v[56:59], v[16:19], a[8:11], v[56:59]
    v_mfma_f32_16x16x32_bf16 v[60:63], v[16:19], a[32:35], v[60:63]
    v_mfma_f32_16x16x32_bf16 v[64:67], v[16:19], a[56:59], v[64:67]
    v_mfma_f32_16x16x32_bf16 v[68:71], v[16:19], a[80:83], v[68:71]
    v_mfma_f32_16x16x32_bf16 v[72:75], v[16:19], a[104:107], v[72:75]
    v_mfma_f32_16x16x32_bf16 v[56:59], v[20:23], a[12:15], v[56:59]
    v_mfma_f32_16x16x32_bf16 v[60:63], v[20:23], a[36:39], v[60:63]
    v_mfma_f32_16x16x32_bf16 v[64:67], v[20:23], a[60:63], v[64:67]
    v_mfma_f32_16x16x32_bf16 v[68:71], v[20:23], a[84:87], v[68:71]
    v_mfma_f32_16x16x32_bf16 v[72:75], v[20:23], a[108:111], v[72:75]
    v_mfma_f32_16x16x32_bf16 v[56:59], v[24:27], a[16:19], v[56:59]
    v_mfma_f32_16x16x32_bf16 v[60:63], v[24:27], a[40:43], v[60:63]
    v_mfma_f32_16x16x32_bf16 v[64:67], v[24:27], a[64:67], v[64:67]
    v_mfma_f32_16x16x32_bf16 v[68:71], v[24:27], a[88:91], v[68:71]
    v_mfma_f32_16x16x32_bf16 v[72:75], v[24:27], a[112:115], v[72:75]
    v_mfma_f32_16x16x32_bf16 v[56:59], v[28:31], a[20:23], v[56:59]
    v_mfma_f32_16x16x32_bf16 v[60:63], v[28:31], a[44:47], v[60:63]
    v_mfma_f32_16x16x32_bf16 v[64:67], v[28:31], a[68:71], v[64:67]
    v_mfma_f32_16x16x32_bf16 v[68:71], v[28:31], a[92:95], v[68:71]
    v_mfma_f32_16x16x32_bf16 v[72:75], v[28:31], a[116:119], v[72:75]
    ds_read_b128 v[8:11], v125 offset:12800
    ds_read_b128 v[12:15], v125 offset:12864
    ds_read_b128 v[16:19], v125 offset:12928
    ds_read_b128 v[20:23], v125 offset:12992
    ds_read_b128 v[24:27], v125 offset:13056
    ds_read_b128 v[28:31], v125 offset:13120
    s_waitcnt lgkmcnt(6)
    v_mfma_f32_16x16x32_bf16 v[76:79], v[32:35], a[0:3], 0
    v_mfma_f32_16x16x32_bf16 v[80:83], v[32:35], a[24:27], 0
    v_mfma_f32_16x16x32_bf16 v[84:87], v[32:35], a[48:51], 0
    v_mfma_f32_16x16x32_bf16 v[88:91], v[32:35], a[72:75], 0
    v_mfma_f32_16x16x32_bf16 v[92:95], v[32:35], a[96:99], 0
    v_mfma_f32_16x16x32_bf16 v[76:79], v[36:39], a[4:7], v[76:79]
    v_mfma_f32_16x16x32_bf16 v[80:83], v[36:39], a[28:31], v[80:83]
    v_mfma_f32_16x16x32_bf16 v[84:87], v[36:39], a[52:55], v[84:87]
    v_mfma_f32_16x16x32_bf16 v[88:91], v[36:39], a[76:79], v[88:91]
    v_mfma_f32_16x16x32_bf16 v[92:95], v[36:39], a[100:103], v[92:95]
    v_cvt_pk_bf16_f32 v128, v56, v57
    v_cvt_pk_bf16_f32 v129, v58, v59
    v_cvt_pk_bf16_f32 v132, v60, v61
    v_cvt_pk_bf16_f32 v133, v62, v63
    v_cvt_pk_bf16_f32 v136, v64, v65
    v_cvt_pk_bf16_f32 v137, v66, v67
    v_cvt_pk_bf16_f32 v140, v68, v69
    v_cvt_pk_bf16_f32 v141, v70, v71
    v_cvt_pk_bf16_f32 v144, v72, v73
    v_cvt_pk_bf16_f32 v145, v74, v75
    v_mfma_f32_16x16x32_bf16 v[76:79], v[40:43], a[8:11], v[76:79]
    v_mfma_f32_16x16x32_bf16 v[80:83], v[40:43], a[32:35], v[80:83]
    v_mfma_f32_16x16x32_bf16 v[84:87], v[40:43], a[56:59], v[84:87]
    v_mfma_f32_16x16x32_bf16 v[88:91], v[40:43], a[80:83], v[88:91]
    v_mfma_f32_16x16x32_bf16 v[92:95], v[40:43], a[104:107], v[92:95]
    v_mfma_f32_16x16x32_bf16 v[76:79], v[44:47], a[12:15], v[76:79]
    v_mfma_f32_16x16x32_bf16 v[80:83], v[44:47], a[36:39], v[80:83]
    v_mfma_f32_16x16x32_bf16 v[84:87], v[44:47], a[60:63], v[84:87]
    v_mfma_f32_16x16x32_bf16 v[88:91], v[44:47], a[84:87], v[88:91]
    v_mfma_f32_16x16x32_bf16 v[92:95], v[44:47], a[108:111], v[92:95]
    v_mfma_f32_16x16x32_bf16 v[76:79], v[48:51], a[16:19], v[76:79]
    v_mfma_f32_16x16x32_bf16 v[80:83], v[48:51], a[40:43], v[80:83]
    v_mfma_f32_16x16x32_bf16 v[84:87], v[48:51], a[64:67], v[84:87]
    v_mfma_f32_16x16x32_bf16 v[88:91], v[48:51], a[88:91], v[88:91]
    v_mfma_f32_16x16x32_bf16 v[92:95], v[48:51], a[112:115], v[92:95]
    v_mfma_f32_16x16x32_bf16 v[76:79], v[52:55], a[20:23], v[76:79]
    v_mfma_f32_16x16x32_bf16 v[80:83], v[52:55], a[44:47], v[80:83]
    v_mfma_f32_16x16x32_bf16 v[84:87], v[52:55], a[68:71], v[84:87]
    v_mfma_f32_16x16x32_bf16 v[88:91], v[52:55], a[92:95], v[88:91]
    v_mfma_f32_16x16x32_bf16 v[92:95], v[52:55], a[116:119], v[92:95]
    ds_read_b128 v[32:35], v125 offset:19200
    ds_read_b128 v[36:39], v125 offset:19264
    ds_read_b128 v[40:43], v125 offset:19328
    ds_read_b128 v[44:47], v125 offset:19392
    ds_read_b128 v[48:51], v125 offset:19456
    ds_read_b128 v[52:55], v125 offset:19520
    s_waitcnt lgkmcnt(6)
    v_mfma_f32_16x16x32_bf16 v[56:59], v[8:11], a[0:3], 0
    v_mfma_f32_16x16x32_bf16 v[60:63], v[8:11], a[24:27], 0
    v_mfma_f32_16x16x32_bf16 v[64:67], v[8:11], a[48:51], 0
    v_mfma_f32_16x16x32_bf16 v[68:71], v[8:11], a[72:75], 0
    v_mfma_f32_16x16x32_bf16 v[72:75], v[8:11], a[96:99], 0
    v_mfma_f32_16x16x32_bf16 v[56:59], v[12:15], a[4:7], v[56:59]
    v_mfma_f32_16x16x32_bf16 v[60:63], v[12:15], a[28:31], v[60:63]
    v_mfma_f32_16x16x32_bf16 v[64:67], v[12:15], a[52:55], v[64:67]
    v_mfma_f32_16x16x32_bf16 v[68:71], v[12:15], a[76:79], v[68:71]
    v_mfma_f32_16x16x32_bf16 v[72:75], v[12:15], a[100:103], v[72:75]
    v_cvt_pk_bf16_f32 v130, v76, v77
    v_cvt_pk_bf16_f32 v131, v78, v79
    v_cvt_pk_bf16_f32 v134, v80, v81
    v_cvt_pk_bf16_f32 v135, v82, v83
    v_cvt_pk_bf16_f32 v138, v84, v85
    v_cvt_pk_bf16_f32 v139, v86, v87
    v_cvt_pk_bf16_f32 v142, v88, v89
    v_cvt_pk_bf16_f32 v143, v90, v91
    v_cvt_pk_bf16_f32 v146, v92, v93
    v_cvt_pk_bf16_f32 v147, v94, v95
    s_add_u32 s50, s49, 0
    s_lshr_b32 s51, s50, 1
    s_lshl_b32 s51, s51, 13
    s_and_b32 s50, s50, 1
    s_lshl_b32 s50, s50, 10
    s_add_u32 s50, s50, s51
    s_add_u32 s51, s50, s44
    buffer_store_dwordx4 v[128:131], v2, s[4:7], s51 offen sc1
    s_add_u32 s51, s50, s45
    buffer_store_dwordx4 v[132:135], v2, s[4:7], s51 offen sc1
    s_add_u32 s51, s50, s46
    buffer_store_dwordx4 v[136:139], v2, s[4:7], s51 offen sc1
    s_add_u32 s51, s50, s47
    buffer_store_dwordx4 v[140:143], v2, s[4:7], s51 offen sc1
    s_add_u32 s51, s50, s48
    buffer_store_dwordx4 v[144:147], v2, s[4:7], s51 offen sc1
    v_mfma_f32_16x16x32_bf16 v[56:59], v[16:19], a[8:11], v[56:59]
    v_mfma_f32_16x16x32_bf16 v[60:63], v[16:19], a[32:35], v[60:63]
    v_mfma_f32_16x16x32_bf16 v[64:67], v[16:19], a[56:59], v[64:67]
    v_mfma_f32_16x16x32_bf16 v[68:71], v[16:19], a[80:83], v[68:71]
    v_mfma_f32_16x16x32_bf16 v[72:75], v[16:19], a[104:107], v[72:75]
    v_mfma_f32_16x16x32_bf16 v[56:59], v[20:23], a[12:15], v[56:59]
    v_mfma_f32_16x16x32_bf16 v[60:63], v[20:23], a[36:39], v[60:63]
    v_mfma_f32_16x16x32_bf16 v[64:67], v[20:23], a[60:63], v[64:67]
    v_mfma_f32_16x16x32_bf16 v[68:71], v[20:23], a[84:87], v[68:71]
    v_mfma_f32_16x16x32_bf16 v[72:75], v[20:23], a[108:111], v[72:75]
    v_mfma_f32_16x16x32_bf16 v[56:59], v[24:27], a[16:19], v[56:59]
    v_mfma_f32_16x16x32_bf16 v[60:63], v[24:27], a[40:43], v[60:63]
    v_mfma_f32_16x16x32_bf16 v[64:67], v[24:27], a[64:67], v[64:67]
    v_mfma_f32_16x16x32_bf16 v[68:71], v[24:27], a[88:91], v[68:71]
    v_mfma_f32_16x16x32_bf16 v[72:75], v[24:27], a[112:115], v[72:75]
    v_mfma_f32_16x16x32_bf16 v[56:59], v[28:31], a[20:23], v[56:59]
    v_mfma_f32_16x16x32_bf16 v[60:63], v[28:31], a[44:47], v[60:63]
    v_mfma_f32_16x16x32_bf16 v[64:67], v[28:31], a[68:71], v[64:67]
    v_mfma_f32_16x16x32_bf16 v[68:71], v[28:31], a[92:95], v[68:71]
    v_mfma_f32_16x16x32_bf16 v[72:75], v[28:31], a[116:119], v[72:75]
    ds_read_b128 v[8:11], v125 offset:25600
    ds_read_b128 v[12:15], v125 offset:25664
    ds_read_b128 v[16:19], v125 offset:25728
    ds_read_b128 v[20:23], v125 offset:25792
    ds_read_b128 v[24:27], v125 offset:25856
    ds_read_b128 v[28:31], v125 offset:25920
    s_waitcnt lgkmcnt(6)
    v_mfma_f32_16x16x32_bf16 v[76:79], v[32:35], a[0:3], 0
    v_mfma_f32_16x16x32_bf16 v[80:83], v[32:35], a[24:27], 0
    v_mfma_f32_16x16x32_bf16 v[84:87], v[32:35], a[48:51], 0
    v_mfma_f32_16x16x32_bf16 v[88:91], v[32:35], a[72:75], 0
    v_mfma_f32_16x16x32_bf16 v[92:95], v[32:35], a[96:99], 0
    v_mfma_f32_16x16x32_bf16 v[76:79], v[36:39], a[4:7], v[76:79]
    v_mfma_f32_16x16x32_bf16 v[80:83], v[36:39], a[28:31], v[80:83]
    v_mfma_f32_16x16x32_bf16 v[84:87], v[36:39], a[52:55], v[84:87]
    v_mfma_f32_16x16x32_bf16 v[88:91], v[36:39], a[76:79], v[88:91]
    v_mfma_f32_16x16x32_bf16 v[92:95], v[36:39], a[100:103], v[92:95]
    v_cvt_pk_bf16_f32 v148, v56, v57
    v_cvt_pk_bf16_f32 v149, v58, v59
    v_cvt_pk_bf16_f32 v152, v60, v61
    v_cvt_pk_bf16_f32 v153, v62, v63
    v_cvt_pk_bf16_f32 v156, v64, v65
    v_cvt_pk_bf16_f32 v157, v66, v67
    v_cvt_pk_bf16_f32 v160, v68, v69
    v_cvt_pk_bf16_f32 v161, v70, v71
    v_cvt_pk_bf16_f32 v164, v72, v73
    v_cvt_pk_bf16_f32 v165, v74, v75
    v_mfma_f32_16x16x32_bf16 v[76:79], v[40:43], a[8:11], v[76:79]
    v_mfma_f32_16x16x32_bf16 v[80:83], v[40:43], a[32:35], v[80:83]
    v_mfma_f32_16x16x32_bf16 v[84:87], v[40:43], a[56:59], v[84:87]
    v_mfma_f32_16x16x32_bf16 v[88:91], v[40:43], a[80:83], v[88:91]
    v_mfma_f32_16x16x32_bf16 v[92:95], v[40:43], a[104:107], v[92:95]
    v_mfma_f32_16x16x32_bf16 v[76:79], v[44:47], a[12:15], v[76:79]
    v_mfma_f32_16x16x32_bf16 v[80:83], v[44:47], a[36:39], v[80:83]
    v_mfma_f32_16x16x32_bf16 v[84:87], v[44:47], a[60:63], v[84:87]
    v_mfma_f32_16x16x32_bf16 v[88:91], v[44:47], a[84:87], v[88:91]
    v_mfma_f32_16x16x32_bf16 v[92:95], v[44:47], a[108:111], v[92:95]
    v_mfma_f32_16x16x32_bf16 v[76:79], v[48:51], a[16:19], v[76:79]
    v_mfma_f32_16x16x32_bf16 v[80:83], v[48:51], a[40:43], v[80:83]
    v_mfma_f32_16x16x32_bf16 v[84:87], v[48:51], a[64:67], v[84:87]
    v_mfma_f32_16x16x32_bf16 v[88:91], v[48:51], a[88:91], v[88:91]
    v_mfma_f32_16x16x32_bf16 v[92:95], v[48:51], a[112:115], v[92:95]
    v_mfma_f32_16x16x32_bf16 v[76:79], v[52:55], a[20:23], v[76:79]
    v_mfma_f32_16x16x32_bf16 v[80:83], v[52:55], a[44:47], v[80:83]
    v_mfma_f32_16x16x32_bf16 v[84:87], v[52:55], a[68:71], v[84:87]
    v_mfma_f32_16x16x32_bf16 v[88:91], v[52:55], a[92:95], v[88:91]
    v_mfma_f32_16x16x32_bf16 v[92:95], v[52:55], a[116:119], v[92:95]
    ds_read_b128 v[32:35], v125 offset:32000
    ds_read_b128 v[36:39], v125 offset:32064
    ds_read_b128 v[40:43], v125 offset:32128
    ds_read_b128 v[44:47], v125 offset:32192
    ds_read_b128 v[48:51], v125 offset:32256
    ds_read_b128 v[52:55], v125 offset:32320
    s_waitcnt lgkmcnt(6)
    v_mfma_f32_16x16x32_bf16 v[56:59], v[8:11], a[0:3], 0
    v_mfma_f32_16x16x32_bf16 v[60:63], v[8:11], a[24:27], 0
    v_mfma_f32_16x16x32_bf16 v[64:67], v[8:11], a[48:51], 0
    v_mfma_f32_16x16x32_bf16 v[68:71], v[8:11], a[72:75], 0
    v_mfma_f32_16x16x32_bf16 v[72:75], v[8:11], a[96:99], 0
    v_mfma_f32_16x16x32_bf16 v[56:59], v[12:15], a[4:7], v[56:59]
    v_mfma_f32_16x16x32_bf16 v[60:63], v[12:15], a[28:31], v[60:63]
    v_mfma_f32_16x16x32_bf16 v[64:67], v[12:15], a[52:55], v[64:67]
    v_mfma_f32_16x16x32_bf16 v[68:71], v[12:15], a[76:79], v[68:71]
    v_mfma_f32_16x16x32_bf16 v[72:75], v[12:15], a[100:103], v[72:75]
    v_cvt_pk_bf16_f32 v150, v76, v77
    v_cvt_pk_bf16_f32 v151, v78, v79
    v_cvt_pk_bf16_f32 v154, v80, v81
    v_cvt_pk_bf16_f32 v155, v82, v83
    v_cvt_pk_bf16_f32 v158, v84, v85
    v_cvt_pk_bf16_f32 v159, v86, v87
    v_cvt_pk_bf16_f32 v162, v88, v89
    v_cvt_pk_bf16_f32 v163, v90, v91
    v_cvt_pk_bf16_f32 v166, v92, v93
    v_cvt_pk_bf16_f32 v167, v94, v95
    s_add_u32 s50, s49, 1
    s_lshr_b32 s51, s50, 1
    s_lshl_b32 s51, s51, 13
    s_and_b32 s50, s50, 1
    s_lshl_b32 s50, s50, 10
    s_add_u32 s50, s50, s51
    s_add_u32 s51, s50, s44
    buffer_store_dwordx4 v[148:151], v2, s[4:7], s51 offen sc1
    s_add_u32 s51, s50, s45
    buffer_store_dwordx4 v[152:155], v2, s[4:7], s51 offen sc1
    s_add_u32 s51, s50, s46
    buffer_store_dwordx4 v[156:159], v2, s[4:7], s51 offen sc1
    s_add_u32 s51, s50, s47
    buffer_store_dwordx4 v[160:163], v2, s[4:7], s51 offen sc1
    s_add_u32 s51, s50, s48
    buffer_store_dwordx4 v[164:167], v2, s[4:7], s51 offen sc1
    v_mfma_f32_16x16x32_bf16 v[56:59], v[16:19], a[8:11], v[56:59]
    v_mfma_f32_16x16x32_bf16 v[60:63], v[16:19], a[32:35], v[60:63]
    v_mfma_f32_16x16x32_bf16 v[64:67], v[16:19], a[56:59], v[64:67]
    v_mfma_f32_16x16x32_bf16 v[68:71], v[16:19], a[80:83], v[68:71]
    v_mfma_f32_16x16x32_bf16 v[72:75], v[16:19], a[104:107], v[72:75]
    v_mfma_f32_16x16x32_bf16 v[56:59], v[20:23], a[12:15], v[56:59]
    v_mfma_f32_16x16x32_bf16 v[60:63], v[20:23], a[36:39], v[60:63]
    v_mfma_f32_16x16x32_bf16 v[64:67], v[20:23], a[60:63], v[64:67]
    v_mfma_f32_16x16x32_bf16 v[68:71], v[20:23], a[84:87], v[68:71]
    v_mfma_f32_16x16x32_bf16 v[72:75], v[20:23], a[108:111], v[72:75]
    v_mfma_f32_16x16x32_bf16 v[56:59], v[24:27], a[16:19], v[56:59]
    v_mfma_f32_16x16x32_bf16 v[60:63], v[24:27], a[40:43], v[60:63]
    v_mfma_f32_16x16x32_bf16 v[64:67], v[24:27], a[64:67], v[64:67]
    v_mfma_f32_16x16x32_bf16 v[68:71], v[24:27], a[88:91], v[68:71]
    v_mfma_f32_16x16x32_bf16 v[72:75], v[24:27], a[112:115], v[72:75]
    v_mfma_f32_16x16x32_bf16 v[56:59], v[28:31], a[20:23], v[56:59]
    v_mfma_f32_16x16x32_bf16 v[60:63], v[28:31], a[44:47], v[60:63]
    v_mfma_f32_16x16x32_bf16 v[64:67], v[28:31], a[68:71], v[64:67]
    v_mfma_f32_16x16x32_bf16 v[68:71], v[28:31], a[92:95], v[68:71]
    v_mfma_f32_16x16x32_bf16 v[72:75], v[28:31], a[116:119], v[72:75]
    ds_read_b128 v[8:11], v125 offset:38400
    ds_read_b128 v[12:15], v125 offset:38464
    ds_read_b128 v[16:19], v125 offset:38528
    ds_read_b128 v[20:23], v125 offset:38592
    ds_read_b128 v[24:27], v125 offset:38656
    ds_read_b128 v[28:31], v125 offset:38720
    s_waitcnt lgkmcnt(6)
    v_mfma_f32_16x16x32_bf16 v[76:79], v[32:35], a[0:3], 0
    v_mfma_f32_16x16x32_bf16 v[80:83], v[32:35], a[24:27], 0
    v_mfma_f32_16x16x32_bf16 v[84:87], v[32:35], a[48:51], 0
    v_mfma_f32_16x16x32_bf16 v[88:91], v[32:35], a[72:75], 0
    v_mfma_f32_16x16x32_bf16 v[92:95], v[32:35], a[96:99], 0
    v_mfma_f32_16x16x32_bf16 v[76:79], v[36:39], a[4:7], v[76:79]
    v_mfma_f32_16x16x32_bf16 v[80:83], v[36:39], a[28:31], v[80:83]
    v_mfma_f32_16x16x32_bf16 v[84:87], v[36:39], a[52:55], v[84:87]
    v_mfma_f32_16x16x32_bf16 v[88:91], v[36:39], a[76:79], v[88:91]
    v_mfma_f32_16x16x32_bf16 v[92:95], v[36:39], a[100:103], v[92:95]
    v_cvt_pk_bf16_f32 v128, v56, v57
    v_cvt_pk_bf16_f32 v129, v58, v59
    v_cvt_pk_bf16_f32 v132, v60, v61
    v_cvt_pk_bf16_f32 v133, v62, v63
    v_cvt_pk_bf16_f32 v136, v64, v65
    v_cvt_pk_bf16_f32 v137, v66, v67
    v_cvt_pk_bf16_f32 v140, v68, v69
    v_cvt_pk_bf16_f32 v141, v70, v71
    v_cvt_pk_bf16_f32 v144, v72, v73
    v_cvt_pk_bf16_f32 v145, v74, v75
    v_mfma_f32_16x16x32_bf16 v[76:79], v[40:43], a[8:11], v[76:79]
    v_mfma_f32_16x16x32_bf16 v[80:83], v[40:43], a[32:35], v[80:83]
    v_mfma_f32_16x16x32_bf16 v[84:87], v[40:43], a[56:59], v[84:87]
    v_mfma_f32_16x16x32_bf16 v[88:91], v[40:43], a[80:83], v[88:91]
    v_mfma_f32_16x16x32_bf16 v[92:95], v[40:43], a[104:107], v[92:95]
    v_mfma_f32_16x16x32_bf16 v[76:79], v[44:47], a[12:15], v[76:79]
    v_mfma_f32_16x16x32_bf16 v[80:83], v[44:47], a[36:39], v[80:83]
    v_mfma_f32_16x16x32_bf16 v[84:87], v[44:47], a[60:63], v[84:87]
    v_mfma_f32_16x16x32_bf16 v[88:91], v[44:47], a[84:87], v[88:91]
    v_mfma_f32_16x16x32_bf16 v[92:95], v[44:47], a[108:111], v[92:95]
    v_mfma_f32_16x16x32_bf16 v[76:79], v[48:51], a[16:19], v[76:79]
    v_mfma_f32_16x16x32_bf16 v[80:83], v[48:51], a[40:43], v[80:83]
    v_mfma_f32_16x16x32_bf16 v[84:87], v[48:51], a[64:67], v[84:87]
    v_mfma_f32_16x16x32_bf16 v[88:91], v[48:51], a[88:91], v[88:91]
    v_mfma_f32_16x16x32_bf16 v[92:95], v[48:51], a[112:115], v[92:95]
    v_mfma_f32_16x16x32_bf16 v[76:79], v[52:55], a[20:23], v[76:79]
    v_mfma_f32_16x16x32_bf16 v[80:83], v[52:55], a[44:47], v[80:83]
    v_mfma_f32_16x16x32_bf16 v[84:87], v[52:55], a[68:71], v[84:87]
    v_mfma_f32_16x16x32_bf16 v[88:91], v[52:55], a[92:95], v[88:91]
    v_mfma_f32_16x16x32_bf16 v[92:95], v[52:55], a[116:119], v[92:95]
    ds_read_b128 v[32:35], v125 offset:44800
    ds_read_b128 v[36:39], v125 offset:44864
    ds_read_b128 v[40:43], v125 offset:44928
    ds_read_b128 v[44:47], v125 offset:44992
    ds_read_b128 v[48:51], v125 offset:45056
    ds_read_b128 v[52:55], v125 offset:45120
    s_waitcnt lgkmcnt(6)
    v_mfma_f32_16x16x32_bf16 v[56:59], v[8:11], a[0:3], 0
    v_mfma_f32_16x16x32_bf16 v[60:63], v[8:11], a[24:27], 0
    v_mfma_f32_16x16x32_bf16 v[64:67], v[8:11], a[48:51], 0
    v_mfma_f32_16x16x32_bf16 v[68:71], v[8:11], a[72:75], 0
    v_mfma_f32_16x16x32_bf16 v[72:75], v[8:11], a[96:99], 0
    v_mfma_f32_16x16x32_bf16 v[56:59], v[12:15], a[4:7], v[56:59]
    v_mfma_f32_16x16x32_bf16 v[60:63], v[12:15], a[28:31], v[60:63]
    v_mfma_f32_16x16x32_bf16 v[64:67], v[12:15], a[52:55], v[64:67]
    v_mfma_f32_16x16x32_bf16 v[68:71], v[12:15], a[76:79], v[68:71]
    v_mfma_f32_16x16x32_bf16 v[72:75], v[12:15], a[100:103], v[72:75]
    v_cvt_pk_bf16_f32 v130, v76, v77
    v_cvt_pk_bf16_f32 v131, v78, v79
    v_cvt_pk_bf16_f32 v134, v80, v81
    v_cvt_pk_bf16_f32 v135, v82, v83
    v_cvt_pk_bf16_f32 v138, v84, v85
    v_cvt_pk_bf16_f32 v139, v86, v87
    v_cvt_pk_bf16_f32 v142, v88, v89
    v_cvt_pk_bf16_f32 v143, v90, v91
    v_cvt_pk_bf16_f32 v146, v92, v93
    v_cvt_pk_bf16_f32 v147, v94, v95
    s_add_u32 s50, s49, 2
    s_lshr_b32 s51, s50, 1
    s_lshl_b32 s51, s51, 13
    s_and_b32 s50, s50, 1
    s_lshl_b32 s50, s50, 10
    s_add_u32 s50, s50, s51
    s_add_u32 s51, s50, s44
    buffer_store_dwordx4 v[128:131], v2, s[4:7], s51 offen sc1
    s_add_u32 s51, s50, s45
    buffer_store_dwordx4 v[132:135], v2, s[4:7], s51 offen sc1
    s_add_u32 s51, s50, s46
    buffer_store_dwordx4 v[136:139], v2, s[4:7], s51 offen sc1
    s_add_u32 s51, s50, s47
    buffer_store_dwordx4 v[140:143], v2, s[4:7], s51 offen sc1
    s_add_u32 s51, s50, s48
    buffer_store_dwordx4 v[144:147], v2, s[4:7], s51 offen sc1
    v_mfma_f32_16x16x32_bf16 v[56:59], v[16:19], a[8:11], v[56:59]
    v_mfma_f32_16x16x32_bf16 v[60:63], v[16:19], a[32:35], v[60:63]
    v_mfma_f32_16x16x32_bf16 v[64:67], v[16:19], a[56:59], v[64:67]
    v_mfma_f32_16x16x32_bf16 v[68:71], v[16:19], a[80:83], v[68:71]
    v_mfma_f32_16x16x32_bf16 v[72:75], v[16:19], a[104:107], v[72:75]
    v_mfma_f32_16x16x32_bf16 v[56:59], v[20:23], a[12:15], v[56:59]
    v_mfma_f32_16x16x32_bf16 v[60:63], v[20:23], a[36:39], v[60:63]
    v_mfma_f32_16x16x32_bf16 v[64:67], v[20:23], a[60:63], v[64:67]
    v_mfma_f32_16x16x32_bf16 v[68:71], v[20:23], a[84:87], v[68:71]
    v_mfma_f32_16x16x32_bf16 v[72:75], v[20:23], a[108:111], v[72:75]
    v_mfma_f32_16x16x32_bf16 v[56:59], v[24:27], a[16:19], v[56:59]
    v_mfma_f32_16x16x32_bf16 v[60:63], v[24:27], a[40:43], v[60:63]
    v_mfma_f32_16x16x32_bf16 v[64:67], v[24:27], a[64:67], v[64:67]
    v_mfma_f32_16x16x32_bf16 v[68:71], v[24:27], a[88:91], v[68:71]
    v_mfma_f32_16x16x32_bf16 v[72:75], v[24:27], a[112:115], v[72:75]
    v_mfma_f32_16x16x32_bf16 v[56:59], v[28:31], a[20:23], v[56:59]
    v_mfma_f32_16x16x32_bf16 v[60:63], v[28:31], a[44:47], v[60:63]
    v_mfma_f32_16x16x32_bf16 v[64:67], v[28:31], a[68:71], v[64:67]
    v_mfma_f32_16x16x32_bf16 v[68:71], v[28:31], a[92:95], v[68:71]
    v_mfma_f32_16x16x32_bf16 v[72:75], v[28:31], a[116:119], v[72:75]
    ds_read_b128 v[8:11], v125 offset:51200
    ds_read_b128 v[12:15], v125 offset:51264
    ds_read_b128 v[16:19], v125 offset:51328
    ds_read_b128 v[20:23], v125 offset:51392
    ds_read_b128 v[24:27], v125 offset:51456
    ds_read_b128 v[28:31], v125 offset:51520
    s_waitcnt lgkmcnt(6)
    v_mfma_f32_16x16x32_bf16 v[76:79], v[32:35], a[0:3], 0
    v_mfma_f32_16x16x32_bf16 v[80:83], v[32:35], a[24:27], 0
    v_mfma_f32_16x16x32_bf16 v[84:87], v[32:35], a[48:51], 0
    v_mfma_f32_16x16x32_bf16 v[88:91], v[32:35], a[72:75], 0
    v_mfma_f32_16x16x32_bf16 v[92:95], v[32:35], a[96:99], 0
    v_mfma_f32_16x16x32_bf16 v[76:79], v[36:39], a[4:7], v[76:79]
    v_mfma_f32_16x16x32_bf16 v[80:83], v[36:39], a[28:31], v[80:83]
    v_mfma_f32_16x16x32_bf16 v[84:87], v[36:39], a[52:55], v[84:87]
    v_mfma_f32_16x16x32_bf16 v[88:91], v[36:39], a[76:79], v[88:91]
    v_mfma_f32_16x16x32_bf16 v[92:95], v[36:39], a[100:103], v[92:95]
    v_cvt_pk_bf16_f32 v148, v56, v57
    v_cvt_pk_bf16_f32 v149, v58, v59
    v_cvt_pk_bf16_f32 v152, v60, v61
    v_cvt_pk_bf16_f32 v153, v62, v63
    v_cvt_pk_bf16_f32 v156, v64, v65
    v_cvt_pk_bf16_f32 v157, v66, v67
    v_cvt_pk_bf16_f32 v160, v68, v69
    v_cvt_pk_bf16_f32 v161, v70, v71
    v_cvt_pk_bf16_f32 v164, v72, v73
    v_cvt_pk_bf16_f32 v165, v74, v75
    v_mfma_f32_16x16x32_bf16 v[76:79], v[40:43], a[8:11], v[76:79]
    v_mfma_f32_16x16x32_bf16 v[80:83], v[40:43], a[32:35], v[80:83]
    v_mfma_f32_16x16x32_bf16 v[84:87], v[40:43], a[56:59], v[84:87]
    v_mfma_f32_16x16x32_bf16 v[88:91], v[40:43], a[80:83], v[88:91]
    v_mfma_f32_16x16x32_bf16 v[92:95], v[40:43], a[104:107], v[92:95]
    v_mfma_f32_16x16x32_bf16 v[76:79], v[44:47], a[12:15], v[76:79]
    v_mfma_f32_16x16x32_bf16 v[80:83], v[44:47], a[36:39], v[80:83]
    v_mfma_f32_16x16x32_bf16 v[84:87], v[44:47], a[60:63], v[84:87]
    v_mfma_f32_16x16x32_bf16 v[88:91], v[44:47], a[84:87], v[88:91]
    v_mfma_f32_16x16x32_bf16 v[92:95], v[44:47], a[108:111], v[92:95]
    v_mfma_f32_16x16x32_bf16 v[76:79], v[48:51], a[16:19], v[76:79]
    v_mfma_f32_16x16x32_bf16 v[80:83], v[48:51], a[40:43], v[80:83]
    v_mfma_f32_16x16x32_bf16 v[84:87], v[48:51], a[64:67], v[84:87]
    v_mfma_f32_16x16x32_bf16 v[88:91], v[48:51], a[88:91], v[88:91]
    v_mfma_f32_16x16x32_bf16 v[92:95], v[48:51], a[112:115], v[92:95]
    v_mfma_f32_16x16x32_bf16 v[76:79], v[52:55], a[20:23], v[76:79]
    v_mfma_f32_16x16x32_bf16 v[80:83], v[52:55], a[44:47], v[80:83]
    v_mfma_f32_16x16x32_bf16 v[84:87], v[52:55], a[68:71], v[84:87]
    v_mfma_f32_16x16x32_bf16 v[88:91], v[52:55], a[92:95], v[88:91]
    v_mfma_f32_16x16x32_bf16 v[92:95], v[52:55], a[116:119], v[92:95]
    ds_read_b128 v[32:35], v125 offset:57600
    ds_read_b128 v[36:39], v125 offset:57664
    ds_read_b128 v[40:43], v125 offset:57728
    ds_read_b128 v[44:47], v125 offset:57792
    ds_read_b128 v[48:51], v125 offset:57856
    ds_read_b128 v[52:55], v125 offset:57920
    s_waitcnt lgkmcnt(6)
    v_mfma_f32_16x16x32_bf16 v[56:59], v[8:11], a[0:3], 0
    v_mfma_f32_16x16x32_bf16 v[60:63], v[8:11], a[24:27], 0
    v_mfma_f32_16x16x32_bf16 v[64:67], v[8:11], a[48:51], 0
    v_mfma_f32_16x16x32_bf16 v[68:71], v[8:11], a[72:75], 0
    v_mfma_f32_16x16x32_bf16 v[72:75], v[8:11], a[96:99], 0
    v_mfma_f32_16x16x32_bf16 v[56:59], v[12:15], a[4:7], v[56:59]
    v_mfma_f32_16x16x32_bf16 v[60:63], v[12:15], a[28:31], v[60:63]
    v_mfma_f32_16x16x32_bf16 v[64:67], v[12:15], a[52:55], v[64:67]
    v_mfma_f32_16x16x32_bf16 v[68:71], v[12:15], a[76:79], v[68:71]
    v_mfma_f32_16x16x32_bf16 v[72:75], v[12:15], a[100:103], v[72:75]
    v_cvt_pk_bf16_f32 v150, v76, v77
    v_cvt_pk_bf16_f32 v151, v78, v79
    v_cvt_pk_bf16_f32 v154, v80, v81
    v_cvt_pk_bf16_f32 v155, v82, v83
    v_cvt_pk_bf16_f32 v158, v84, v85
    v_cvt_pk_bf16_f32 v159, v86, v87
    v_cvt_pk_bf16_f32 v162, v88, v89
    v_cvt_pk_bf16_f32 v163, v90, v91
    v_cvt_pk_bf16_f32 v166, v92, v93
    v_cvt_pk_bf16_f32 v167, v94, v95
    s_add_u32 s50, s49, 3
    s_lshr_b32 s51, s50, 1
    s_lshl_b32 s51, s51, 13
    s_and_b32 s50, s50, 1
    s_lshl_b32 s50, s50, 10
    s_add_u32 s50, s50, s51
    s_add_u32 s51, s50, s44
    buffer_store_dwordx4 v[148:151], v2, s[4:7], s51 offen sc1
    s_add_u32 s51, s50, s45
    buffer_store_dwordx4 v[152:155], v2, s[4:7], s51 offen sc1
    s_add_u32 s51, s50, s46
    buffer_store_dwordx4 v[156:159], v2, s[4:7], s51 offen sc1
    s_add_u32 s51, s50, s47
    buffer_store_dwordx4 v[160:163], v2, s[4:7], s51 offen sc1
    s_add_u32 s51, s50, s48
    buffer_store_dwordx4 v[164:167], v2, s[4:7], s51 offen sc1
    v_mfma_f32_16x16x32_bf16 v[56:59], v[16:19], a[8:11], v[56:59]
    v_mfma_f32_16x16x32_bf16 v[60:63], v[16:19], a[32:35], v[60:63]
    v_mfma_f32_16x16x32_bf16 v[64:67], v[16:19], a[56:59], v[64:67]
    v_mfma_f32_16x16x32_bf16 v[68:71], v[16:19], a[80:83], v[68:71]
    v_mfma_f32_16x16x32_bf16 v[72:75], v[16:19], a[104:107], v[72:75]
    v_mfma_f32_16x16x32_bf16 v[56:59], v[20:23], a[12:15], v[56:59]
    v_mfma_f32_16x16x32_bf16 v[60:63], v[20:23], a[36:39], v[60:63]
    v_mfma_f32_16x16x32_bf16 v[64:67], v[20:23], a[60:63], v[64:67]
    v_mfma_f32_16x16x32_bf16 v[68:71], v[20:23], a[84:87], v[68:71]
    v_mfma_f32_16x16x32_bf16 v[72:75], v[20:23], a[108:111], v[72:75]
    v_mfma_f32_16x16x32_bf16 v[56:59], v[24:27], a[16:19], v[56:59]
    v_mfma_f32_16x16x32_bf16 v[60:63], v[24:27], a[40:43], v[60:63]
    v_mfma_f32_16x16x32_bf16 v[64:67], v[24:27], a[64:67], v[64:67]
    v_mfma_f32_16x16x32_bf16 v[68:71], v[24:27], a[88:91], v[68:71]
    v_mfma_f32_16x16x32_bf16 v[72:75], v[24:27], a[112:115], v[72:75]
    v_mfma_f32_16x16x32_bf16 v[56:59], v[28:31], a[20:23], v[56:59]
    v_mfma_f32_16x16x32_bf16 v[60:63], v[28:31], a[44:47], v[60:63]
    v_mfma_f32_16x16x32_bf16 v[64:67], v[28:31], a[68:71], v[64:67]
    v_mfma_f32_16x16x32_bf16 v[68:71], v[28:31], a[92:95], v[68:71]
    v_mfma_f32_16x16x32_bf16 v[72:75], v[28:31], a[116:119], v[72:75]
    s_waitcnt lgkmcnt(0)
    v_mfma_f32_16x16x32_bf16 v[76:79], v[32:35], a[0:3], 0
    v_mfma_f32_16x16x32_bf16 v[80:83], v[32:35], a[24:27], 0
    v_mfma_f32_16x16x32_bf16 v[84:87], v[32:35], a[48:51], 0
    v_mfma_f32_16x16x32_bf16 v[88:91], v[32:35], a[72:75], 0
    v_mfma_f32_16x16x32_bf16 v[92:95], v[32:35], a[96:99], 0
    v_mfma_f32_16x16x32_bf16 v[76:79], v[36:39], a[4:7], v[76:79]
    v_mfma_f32_16x16x32_bf16 v[80:83], v[36:39], a[28:31], v[80:83]
    v_mfma_f32_16x16x32_bf16 v[84:87], v[36:39], a[52:55], v[84:87]
    v_mfma_f32_16x16x32_bf16 v[88:91], v[36:39], a[76:79], v[88:91]
    v_mfma_f32_16x16x32_bf16 v[92:95], v[36:39], a[100:103], v[92:95]
    v_cvt_pk_bf16_f32 v128, v56, v57
    v_cvt_pk_bf16_f32 v129, v58, v59
    v_cvt_pk_bf16_f32 v132, v60, v61
    v_cvt_pk_bf16_f32 v133, v62, v63
    v_cvt_pk_bf16_f32 v136, v64, v65
    v_cvt_pk_bf16_f32 v137, v66, v67
    v_cvt_pk_bf16_f32 v140, v68, v69
    v_cvt_pk_bf16_f32 v141, v70, v71
    v_cvt_pk_bf16_f32 v144, v72, v73
    v_cvt_pk_bf16_f32 v145, v74, v75
    v_mfma_f32_16x16x32_bf16 v[76:79], v[40:43], a[8:11], v[76:79]
    v_mfma_f32_16x16x32_bf16 v[80:83], v[40:43], a[32:35], v[80:83]
    v_mfma_f32_16x16x32_bf16 v[84:87], v[40:43], a[56:59], v[84:87]
    v_mfma_f32_16x16x32_bf16 v[88:91], v[40:43], a[80:83], v[88:91]
    v_mfma_f32_16x16x32_bf16 v[92:95], v[40:43], a[104:107], v[92:95]
    v_mfma_f32_16x16x32_bf16 v[76:79], v[44:47], a[12:15], v[76:79]
    v_mfma_f32_16x16x32_bf16 v[80:83], v[44:47], a[36:39], v[80:83]
    v_mfma_f32_16x16x32_bf16 v[84:87], v[44:47], a[60:63], v[84:87]
    v_mfma_f32_16x16x32_bf16 v[88:91], v[44:47], a[84:87], v[88:91]
    v_mfma_f32_16x16x32_bf16 v[92:95], v[44:47], a[108:111], v[92:95]
    v_mfma_f32_16x16x32_bf16 v[76:79], v[48:51], a[16:19], v[76:79]
    v_mfma_f32_16x16x32_bf16 v[80:83], v[48:51], a[40:43], v[80:83]
    v_mfma_f32_16x16x32_bf16 v[84:87], v[48:51], a[64:67], v[84:87]
    v_mfma_f32_16x16x32_bf16 v[88:91], v[48:51], a[88:91], v[88:91]
    v_mfma_f32_16x16x32_bf16 v[92:95], v[48:51], a[112:115], v[92:95]
    v_mfma_f32_16x16x32_bf16 v[76:79], v[52:55], a[20:23], v[76:79]
    v_mfma_f32_16x16x32_bf16 v[80:83], v[52:55], a[44:47], v[80:83]
    v_mfma_f32_16x16x32_bf16 v[84:87], v[52:55], a[68:71], v[84:87]
    v_mfma_f32_16x16x32_bf16 v[88:91], v[52:55], a[92:95], v[88:91]
    v_mfma_f32_16x16x32_bf16 v[92:95], v[52:55], a[116:119], v[92:95]
    s_nop 3
    v_cvt_pk_bf16_f32 v130, v76, v77
    v_cvt_pk_bf16_f32 v131, v78, v79
    v_cvt_pk_bf16_f32 v134, v80, v81
    v_cvt_pk_bf16_f32 v135, v82, v83
    v_cvt_pk_bf16_f32 v138, v84, v85
    v_cvt_pk_bf16_f32 v139, v86, v87
    v_cvt_pk_bf16_f32 v142, v88, v89
    v_cvt_pk_bf16_f32 v143, v90, v91
    v_cvt_pk_bf16_f32 v146, v92, v93
    v_cvt_pk_bf16_f32 v147, v94, v95
    s_add_u32 s50, s49, 4
    s_lshr_b32 s51, s50, 1
    s_lshl_b32 s51, s51, 13
    s_and_b32 s50, s50, 1
    s_lshl_b32 s50, s50, 10
    s_add_u32 s50, s50, s51
    s_add_u32 s51, s50, s44
    buffer_store_dwordx4 v[128:131], v2, s[4:7], s51 offen sc1
    s_add_u32 s51, s50, s45
    buffer_store_dwordx4 v[132:135], v2, s[4:7], s51 offen sc1
    s_add_u32 s51, s50, s46
    buffer_store_dwordx4 v[136:139], v2, s[4:7], s51 offen sc1
    s_add_u32 s51, s50, s47
    buffer_store_dwordx4 v[140:143], v2, s[4:7], s51 offen sc1
    s_add_u32 s51, s50, s48
    buffer_store_dwordx4 v[144:147], v2, s[4:7], s51 offen sc1
    s_waitcnt vmcnt(0)
    v_mov_b32 v4, 4
Lwi_27:
    buffer_load_dword v5, v4, s[88:91], 0 offen sc1
    s_waitcnt vmcnt(0)
    v_cmp_gt_u32 vcc, 224, v5
    s_cbranch_vccz Lwid_28
    s_sub_u32 s101, s101, 1
    s_cbranch_scc1 L_abort
    s_sleep 8
    s_branch Lwi_27
Lwid_28:
    s_barrier
    s_cmp_lg_u32 s20, 0
    s_cbranch_scc1 Li_nf_29
    s_lshl_b32 s52, s94, 2
    s_add_u32 s52, s52, 45056
    v_mov_b32 v4, 0
    v_mov_b32 v5, 1
    s_mov_b64 exec, 1
    buffer_store_dword v5, v4, s[4:7], s52 offen sc1
    s_mov_b64 exec, -1
Li_nf_29:
    s_mov_b32 s94, s95
    s_mov_b32 s95, -1
    s_branch Li_top
Li_done:
    s_cmp_eq_u32 s92, 2
    s_cbranch_scc1 Ld_b
    s_cmp_eq_u32 s92, 3
    s_cbranch_scc1 Ld_k
    s_cmp_eq_u32 s92, 4
    s_cbranch_scc1 Ld_v
    s_cmp_eq_u32 s92, 5
    s_cbranch_scc1 Ld_u
    s_cmp_eq_u32 s92, 6
    s_cbranch_scc1 Ld_qa
    s_branch Ld_f1a
Ld_qk:
    s_lshl_b32 s21, s22, 3
    s_add_u32 s21, s21, s40
    s_load_dwordx2 s[8:9], s[0:1], 16
    s_waitcnt lgkmcnt(0)
    s_mov_b32 s10, 0x780000
    s_mov_b32 s11, 0x20000
    s_load_dwordx2 s[12:13], s[0:1], 24
    s_waitcnt lgkmcnt(0)
    s_mov_b32 s14, 0x780000
    s_mov_b32 s15, 0x20000
    v_add_u32 v3, 0, v0
    v_mul_u32_u24 v4, 0x2ab, v3
    v_lshrrev_b32 v4, 14, v4
    v_mul_u32_u24 v5, 24, v4
    v_sub_u32 v5, v3, v5
    v_mul_u32_u24 v108, 0x3000, v4
    v_lshl_add_u32 v108, v5, 4, v108
    v_mul_u32_u24 v111, 0x320, v4
    v_lshl_add_u32 v111, v5, 4, v111
    v_add_u32 v111, 98304, v111
    v_add_u32 v3, 256, v0
    v_mul_u32_u24 v4, 0x2ab, v3
    v_lshrrev_b32 v4, 14, v4
    v_mul_u32_u24 v5, 24, v4
    v_sub_u32 v5, v3, v5
    v_mul_u32_u24 v109, 0x3000, v4
    v_lshl_add_u32 v109, v5, 4, v109
    v_mul_u32_u24 v112, 0x320, v4
    v_lshl_add_u32 v112, v5, 4, v112
    v_add_u32 v112, 98304, v112
    v_add_u32 v3, 512, v0
    v_mul_u32_u24 v4, 0x2ab, v3
    v_lshrrev_b32 v4, 14, v4
    v_mul_u32_u24 v5, 24, v4
    v_sub_u32 v5, v3, v5
    v_mul_u32_u24 v110, 0x3000, v4
    v_lshl_add_u32 v110, v5, 4, v110
    v_mul_u32_u24 v113, 0x320, v4
    v_lshl_add_u32 v113, v5, 4, v113
    v_add_u32 v113, 98304, v113
    v_and_b32 v3, 15, v1
    v_lshrrev_b32 v4, 4, v1
    v_lshrrev_b32 v5, 2, v3
    v_lshl_add_u32 v5, v4, 2, v5
    v_mul_u32_u24 v114, 0x320, v5
    v_and_b32 v3, 3, v3
    v_lshl_add_u32 v114, v3, 3, v114
    s_mul_i32 s26, s20, 96
    s_add_u32 s26, s26, 98304
    v_add_u32 v114, s26, v114
    s_mul_i32 s26, s20, 24576
    v_add_u32 v115, s26, v2
    s_mul_i32 s25, s21, 384
    buffer_load_dwordx4 v[8:11], v108, s[8:11], s25 offen
    buffer_load_dwordx4 v[12:15], v109, s[8:11], s25 offen
    buffer_load_dwordx4 v[16:19], v110, s[8:11], s25 offen
    buffer_load_dwordx4 v[20:23], v108, s[12:15], s25 offen
    buffer_load_dwordx4 v[24:27], v109, s[12:15], s25 offen
    buffer_load_dwordx4 v[28:31], v110, s[12:15], s25 offen
    s_add_u32 s25, s25, 0x60000
    buffer_load_dwordx4 v[32:35], v108, s[8:11], s25 offen
    buffer_load_dwordx4 v[36:39], v109, s[8:11], s25 offen
    buffer_load_dwordx4 v[40:43], v110, s[8:11], s25 offen
    buffer_load_dwordx4 v[44:47], v108, s[12:15], s25 offen
    buffer_load_dwordx4 v[48:51], v109, s[12:15], s25 offen
    buffer_load_dwordx4 v[52:55], v110, s[12:15], s25 offen
    s_add_u32 s25, s25, 0x60000
    buffer_load_dwordx4 v[56:59], v108, s[8:11], s25 offen
    buffer_load_dwordx4 v[60:63], v109, s[8:11], s25 offen
    buffer_load_dwordx4 v[64:67], v110, s[8:11], s25 offen
    buffer_load_dwordx4 v[68:71], v108, s[12:15], s25 offen
    buffer_load_dwordx4 v[72:75], v109, s[12:15], s25 offen
    buffer_load_dwordx4 v[76:79], v110, s[12:15], s25 offen
    s_add_u32 s25, s25, 0x60000
    s_waitcnt vmcnt(12)
    ds_write_b128 v111, v[8:11] offset:0
    ds_write_b128 v112, v[12:15] offset:0
    ds_write_b128 v113, v[16:19] offset:0
    ds_write_b128 v111, v[20:23] offset:384
    ds_write_b128 v112, v[24:27] offset:384
    ds_write_b128 v113, v[28:31] offset:384
    s_waitcnt lgkmcnt(0)
    buffer_load_dwordx4 v[8:11], v108, s[8:11], s25 offen
    buffer_load_dwordx4 v[12:15], v109, s[8:11], s25 offen
    buffer_load_dwordx4 v[16:19], v110, s[8:11], s25 offen
    buffer_load_dwordx4 v[20:23], v108, s[12:15], s25 offen
    buffer_load_dwordx4 v[24:27], v109, s[12:15], s25 offen
    buffer_load_dwordx4 v[28:31], v110, s[12:15], s25 offen
    s_add_u32 s25, s25, 0x60000
    s_barrier
    ds_read_b64_tr_b16 a[0:1], v114 offset:0
    ds_read_b64_tr_b16 a[2:3], v114 offset:12800
    ds_read_b64_tr_b16 a[80:81], v114 offset:32
    ds_read_b64_tr_b16 a[82:83], v114 offset:12832
    ds_read_b64_tr_b16 a[160:161], v114 offset:64
    ds_read_b64_tr_b16 a[162:163], v114 offset:12864
    ds_read_b64_tr_b16 a[240:241], v114 offset:384
    ds_read_b64_tr_b16 a[242:243], v114 offset:13184
    ds_read_b64_tr_b16 v[192:193], v114 offset:416
    ds_read_b64_tr_b16 v[194:195], v114 offset:13216
    ds_read_b64_tr_b16 v[80:81], v114 offset:448
    ds_read_b64_tr_b16 v[82:83], v114 offset:13248
    s_waitcnt lgkmcnt(0)
    ds_write_b128 v115, v[80:83] offset:0
    s_waitcnt vmcnt(12)
    ds_write_b128 v111, v[32:35] offset:25600
    ds_write_b128 v112, v[36:39] offset:25600
    ds_write_b128 v113, v[40:43] offset:25600
    ds_write_b128 v111, v[44:47] offset:25984
    ds_write_b128 v112, v[48:51] offset:25984
    ds_write_b128 v113, v[52:55] offset:25984
    s_waitcnt lgkmcnt(0)
    buffer_load_dwordx4 v[32:35], v108, s[8:11], s25 offen
    buffer_load_dwordx4 v[36:39], v109, s[8:11], s25 offen
    buffer_load_dwordx4 v[40:43], v110, s[8:11], s25 offen
    buffer_load_dwordx4 v[44:47], v108, s[12:15], s25 offen
    buffer_load_dwordx4 v[48:51], v109, s[12:15], s25 offen
    buffer_load_dwordx4 v[52:55], v110, s[12:15], s25 offen
    s_add_u32 s25, s25, 0x60000
    s_barrier
    ds_read_b64_tr_b16 a[4:5], v114 offset:25600
    ds_read_b64_tr_b16 a[6:7], v114 offset:38400
    ds_read_b64_tr_b16 a[84:85], v114 offset:25632
    ds_read_b64_tr_b16 a[86:87], v114 offset:38432
    ds_read_b64_tr_b16 a[164:165], v114 offset:25664
    ds_read_b64_tr_b16 a[166:167], v114 offset:38464
    ds_read_b64_tr_b16 a[244:245], v114 offset:25984
    ds_read_b64_tr_b16 a[246:247], v114 offset:38784
    ds_read_b64_tr_b16 v[196:197], v114 offset:26016
    ds_read_b64_tr_b16 v[198:199], v114 offset:38816
    ds_read_b64_tr_b16 v[80:81], v114 offset:26048
    ds_read_b64_tr_b16 v[82:83], v114 offset:38848
    s_waitcnt lgkmcnt(0)
    ds_write_b128 v115, v[80:83] offset:1024
    s_waitcnt vmcnt(12)
    ds_write_b128 v111, v[56:59] offset:0
    ds_write_b128 v112, v[60:63] offset:0
    ds_write_b128 v113, v[64:67] offset:0
    ds_write_b128 v111, v[68:71] offset:384
    ds_write_b128 v112, v[72:75] offset:384
    ds_write_b128 v113, v[76:79] offset:384
    s_waitcnt lgkmcnt(0)
    buffer_load_dwordx4 v[56:59], v108, s[8:11], s25 offen
    buffer_load_dwordx4 v[60:63], v109, s[8:11], s25 offen
    buffer_load_dwordx4 v[64:67], v110, s[8:11], s25 offen
    buffer_load_dwordx4 v[68:71], v108, s[12:15], s25 offen
    buffer_load_dwordx4 v[72:75], v109, s[12:15], s25 offen
    buffer_load_dwordx4 v[76:79], v110, s[12:15], s25 offen
    s_add_u32 s25, s25, 0x60000
    s_barrier
    ds_read_b64_tr_b16 a[8:9], v114 offset:0
    ds_read_b64_tr_b16 a[10:11], v114 offset:12800
    ds_read_b64_tr_b16 a[88:89], v114 offset:32
    ds_read_b64_tr_b16 a[90:91], v114 offset:12832
    ds_read_b64_tr_b16 a[168:169], v114 offset:64
    ds_read_b64_tr_b16 a[170:171], v114 offset:12864
    ds_read_b64_tr_b16 a[248:249], v114 offset:384
    ds_read_b64_tr_b16 a[250:251], v114 offset:13184
    ds_read_b64_tr_b16 v[200:201], v114 offset:416
    ds_read_b64_tr_b16 v[202:203], v114 offset:13216
    ds_read_b64_tr_b16 v[80:81], v114 offset:448
    ds_read_b64_tr_b16 v[82:83], v114 offset:13248
    s_waitcnt lgkmcnt(0)
    ds_write_b128 v115, v[80:83] offset:2048
    s_waitcnt vmcnt(12)
    ds_write_b128 v111, v[8:11] offset:25600
    ds_write_b128 v112, v[12:15] offset:25600
    ds_write_b128 v113, v[16:19] offset:25600
    ds_write_b128 v111, v[20:23] offset:25984
    ds_write_b128 v112, v[24:27] offset:25984
    ds_write_b128 v113, v[28:31] offset:25984
    s_waitcnt lgkmcnt(0)
    buffer_load_dwordx4 v[8:11], v108, s[8:11], s25 offen
    buffer_load_dwordx4 v[12:15], v109, s[8:11], s25 offen
    buffer_load_dwordx4 v[16:19], v110, s[8:11], s25 offen
    buffer_load_dwordx4 v[20:23], v108, s[12:15], s25 offen
    buffer_load_dwordx4 v[24:27], v109, s[12:15], s25 offen
    buffer_load_dwordx4 v[28:31], v110, s[12:15], s25 offen
    s_add_u32 s25, s25, 0x60000
    s_barrier
    ds_read_b64_tr_b16 a[12:13], v114 offset:25600
    ds_read_b64_tr_b16 a[14:15], v114 offset:38400
    ds_read_b64_tr_b16 a[92:93], v114 offset:25632
    ds_read_b64_tr_b16 a[94:95], v114 offset:38432
    ds_read_b64_tr_b16 a[172:173], v114 offset:25664
    ds_read_b64_tr_b16 a[174:175], v114 offset:38464
    ds_read_b64_tr_b16 a[252:253], v114 offset:25984
    ds_read_b64_tr_b16 a[254:255], v114 offset:38784
    ds_read_b64_tr_b16 v[204:205], v114 offset:26016
    ds_read_b64_tr_b16 v[206:207], v114 offset:38816
    ds_read_b64_tr_b16 v[80:81], v114 offset:26048
    ds_read_b64_tr_b16 v[82:83], v114 offset:38848
    s_waitcnt lgkmcnt(0)
    ds_write_b128 v115, v[80:83] offset:3072
    s_waitcnt vmcnt(12)
    ds_write_b128 v111, v[32:35] offset:0
    ds_write_b128 v112, v[36:39] offset:0
    ds_write_b128 v113, v[40:43] offset:0
    ds_write_b128 v111, v[44:47] offset:384
    ds_write_b128 v112, v[48:51] offset:384
    ds_write_b128 v113, v[52:55] offset:384
    s_waitcnt lgkmcnt(0)
    buffer_load_dwordx4 v[32:35], v108, s[8:11], s25 offen
    buffer_load_dwordx4 v[36:39], v109, s[8:11], s25 offen
    buffer_load_dwordx4 v[40:43], v110, s[8:11], s25 offen
    buffer_load_dwordx4 v[44:47], v108, s[12:15], s25 offen
    buffer_load_dwordx4 v[48:51], v109, s[12:15], s25 offen
    buffer_load_dwordx4 v[52:55], v110, s[12:15], s25 offen
    s_add_u32 s25, s25, 0x60000
    s_barrier
    ds_read_b64_tr_b16 a[16:17], v114 offset:0
    ds_read_b64_tr_b16 a[18:19], v114 offset:12800
    ds_read_b64_tr_b16 a[96:97], v114 offset:32
    ds_read_b64_tr_b16 a[98:99], v114 offset:12832
    ds_read_b64_tr_b16 a[176:177], v114 offset:64
    ds_read_b64_tr_b16 a[178:179], v114 offset:12864
    ds_read_b64_tr_b16 v[128:129], v114 offset:384
    ds_read_b64_tr_b16 v[130:131], v114 offset:13184
    ds_read_b64_tr_b16 v[208:209], v114 offset:416
    ds_read_b64_tr_b16 v[210:211], v114 offset:13216
    ds_read_b64_tr_b16 v[80:81], v114 offset:448
    ds_read_b64_tr_b16 v[82:83], v114 offset:13248
    s_waitcnt lgkmcnt(0)
    ds_write_b128 v115, v[80:83] offset:4096
    s_waitcnt vmcnt(12)
    ds_write_b128 v111, v[56:59] offset:25600
    ds_write_b128 v112, v[60:63] offset:25600
    ds_write_b128 v113, v[64:67] offset:25600
    ds_write_b128 v111, v[68:71] offset:25984
    ds_write_b128 v112, v[72:75] offset:25984
    ds_write_b128 v113, v[76:79] offset:25984
    s_waitcnt lgkmcnt(0)
    buffer_load_dwordx4 v[56:59], v108, s[8:11], s25 offen
    buffer_load_dwordx4 v[60:63], v109, s[8:11], s25 offen
    buffer_load_dwordx4 v[64:67], v110, s[8:11], s25 offen
    buffer_load_dwordx4 v[68:71], v108, s[12:15], s25 offen
    buffer_load_dwordx4 v[72:75], v109, s[12:15], s25 offen
    buffer_load_dwordx4 v[76:79], v110, s[12:15], s25 offen
    s_add_u32 s25, s25, 0x60000
    s_barrier
    ds_read_b64_tr_b16 a[20:21], v114 offset:25600
    ds_read_b64_tr_b16 a[22:23], v114 offset:38400
    ds_read_b64_tr_b16 a[100:101], v114 offset:25632
    ds_read_b64_tr_b16 a[102:103], v114 offset:38432
    ds_read_b64_tr_b16 a[180:181], v114 offset:25664
    ds_read_b64_tr_b16 a[182:183], v114 offset:38464
    ds_read_b64_tr_b16 v[132:133], v114 offset:25984
    ds_read_b64_tr_b16 v[134:135], v114 offset:38784
    ds_read_b64_tr_b16 v[212:213], v114 offset:26016
    ds_read_b64_tr_b16 v[214:215], v114 offset:38816
    ds_read_b64_tr_b16 v[80:81], v114 offset:26048
    ds_read_b64_tr_b16 v[82:83], v114 offset:38848
    s_waitcnt lgkmcnt(0)
    ds_write_b128 v115, v[80:83] offset:5120
    s_waitcnt vmcnt(12)
    ds_write_b128 v111, v[8:11] offset:0
    ds_write_b128 v112, v[12:15] offset:0
    ds_write_b128 v113, v[16:19] offset:0
    ds_write_b128 v111, v[20:23] offset:384
    ds_write_b128 v112, v[24:27] offset:384
    ds_write_b128 v113, v[28:31] offset:384
    s_waitcnt lgkmcnt(0)
    buffer_load_dwordx4 v[8:11], v108, s[8:11], s25 offen
    buffer_load_dwordx4 v[12:15], v109, s[8:11], s25 offen
    buffer_load_dwordx4 v[16:19], v110, s[8:11], s25 offen
    buffer_load_dwordx4 v[20:23], v108, s[12:15], s25 offen
    buffer_load_dwordx4 v[24:27], v109, s[12:15], s25 offen
    buffer_load_dwordx4 v[28:31], v110, s[12:15], s25 offen
    s_add_u32 s25, s25, 0x60000
    s_barrier
    ds_read_b64_tr_b16 a[24:25], v114 offset:0
    ds_read_b64_tr_b16 a[26:27], v114 offset:12800
    ds_read_b64_tr_b16 a[104:105], v114 offset:32
    ds_read_b64_tr_b16 a[106:107], v114 offset:12832
    ds_read_b64_tr_b16 a[184:185], v114 offset:64
    ds_read_b64_tr_b16 a[186:187], v114 offset:12864
    ds_read_b64_tr_b16 v[136:137], v114 offset:384
    ds_read_b64_tr_b16 v[138:139], v114 offset:13184
    ds_read_b64_tr_b16 v[216:217], v114 offset:416
    ds_read_b64_tr_b16 v[218:219], v114 offset:13216
    ds_read_b64_tr_b16 v[80:81], v114 offset:448
    ds_read_b64_tr_b16 v[82:83], v114 offset:13248
    s_waitcnt lgkmcnt(0)
    ds_write_b128 v115, v[80:83] offset:6144
    s_waitcnt vmcnt(12)
    ds_write_b128 v111, v[32:35] offset:25600
    ds_write_b128 v112, v[36:39] offset:25600
    ds_write_b128 v113, v[40:43] offset:25600
    ds_write_b128 v111, v[44:47] offset:25984
    ds_write_b128 v112, v[48:51] offset:25984
    ds_write_b128 v113, v[52:55] offset:25984
    s_waitcnt lgkmcnt(0)
    buffer_load_dwordx4 v[32:35], v108, s[8:11], s25 offen
    buffer_load_dwordx4 v[36:39], v109, s[8:11], s25 offen
    buffer_load_dwordx4 v[40:43], v110, s[8:11], s25 offen
    buffer_load_dwordx4 v[44:47], v108, s[12:15], s25 offen
    buffer_load_dwordx4 v[48:51], v109, s[12:15], s25 offen
    buffer_load_dwordx4 v[52:55], v110, s[12:15], s25 offen
    s_add_u32 s25, s25, 0x60000
    s_barrier
    ds_read_b64_tr_b16 a[28:29], v114 offset:25600
    ds_read_b64_tr_b16 a[30:31], v114 offset:38400
    ds_read_b64_tr_b16 a[108:109], v114 offset:25632
    ds_read_b64_tr_b16 a[110:111], v114 offset:38432
    ds_read_b64_tr_b16 a[188:189], v114 offset:25664
    ds_read_b64_tr_b16 a[190:191], v114 offset:38464
    ds_read_b64_tr_b16 v[140:141], v114 offset:25984
    ds_read_b64_tr_b16 v[142:143], v114 offset:38784
    ds_read_b64_tr_b16 v[220:221], v114 offset:26016
    ds_read_b64_tr_b16 v[222:223], v114 offset:38816
    ds_read_b64_tr_b16 v[80:81], v114 offset:26048
    ds_read_b64_tr_b16 v[82:83], v114 offset:38848
    s_waitcnt lgkmcnt(0)
    ds_write_b128 v115, v[80:83] offset:7168
    s_waitcnt vmcnt(12)
    ds_write_b128 v111, v[56:59] offset:0
    ds_write_b128 v112, v[60:63] offset:0
    ds_write_b128 v113, v[64:67] offset:0
    ds_write_b128 v111, v[68:71] offset:384
    ds_write_b128 v112, v[72:75] offset:384
    ds_write_b128 v113, v[76:79] offset:384
    s_waitcnt lgkmcnt(0)
    buffer_load_dwordx4 v[56:59], v108, s[8:11], s25 offen
    buffer_load_dwordx4 v[60:63], v109, s[8:11], s25 offen
    buffer_load_dwordx4 v[64:67], v110, s[8:11], s25 offen
    buffer_load_dwordx4 v[68:71], v108, s[12:15], s25 offen
    buffer_load_dwordx4 v[72:75], v109, s[12:15], s25 offen
    buffer_load_dwordx4 v[76:79], v110, s[12:15], s25 offen
    s_add_u32 s25, s25, 0x60000
    s_barrier
    ds_read_b64_tr_b16 a[32:33], v114 offset:0
    ds_read_b64_tr_b16 a[34:35], v114 offset:12800
    ds_read_b64_tr_b16 a[112:113], v114 offset:32
    ds_read_b64_tr_b16 a[114:115], v114 offset:12832
    ds_read_b64_tr_b16 a[192:193], v114 offset:64
    ds_read_b64_tr_b16 a[194:195], v114 offset:12864
    ds_read_b64_tr_b16 v[144:145], v114 offset:384
    ds_read_b64_tr_b16 v[146:147], v114 offset:13184
    ds_read_b64_tr_b16 v[224:225], v114 offset:416
    ds_read_b64_tr_b16 v[226:227], v114 offset:13216
    ds_read_b64_tr_b16 v[80:81], v114 offset:448
    ds_read_b64_tr_b16 v[82:83], v114 offset:13248
    s_waitcnt lgkmcnt(0)
    ds_write_b128 v115, v[80:83] offset:8192
    s_waitcnt vmcnt(12)
    ds_write_b128 v111, v[8:11] offset:25600
    ds_write_b128 v112, v[12:15] offset:25600
    ds_write_b128 v113, v[16:19] offset:25600
    ds_write_b128 v111, v[20:23] offset:25984
    ds_write_b128 v112, v[24:27] offset:25984
    ds_write_b128 v113, v[28:31] offset:25984
    s_waitcnt lgkmcnt(0)
    buffer_load_dwordx4 v[8:11], v108, s[8:11], s25 offen
    buffer_load_dwordx4 v[12:15], v109, s[8:11], s25 offen
    buffer_load_dwordx4 v[16:19], v110, s[8:11], s25 offen
    buffer_load_dwordx4 v[20:23], v108, s[12:15], s25 offen
    buffer_load_dwordx4 v[24:27], v109, s[12:15], s25 offen
    buffer_load_dwordx4 v[28:31], v110, s[12:15], s25 offen
    s_add_u32 s25, s25, 0x60000
    s_barrier
    ds_read_b64_tr_b16 a[36:37], v114 offset:25600
    ds_read_b64_tr_b16 a[38:39], v114 offset:38400
    ds_read_b64_tr_b16 a[116:117], v114 offset:25632
    ds_read_b64_tr_b16 a[118:119], v114 offset:38432
    ds_read_b64_tr_b16 a[196:197], v114 offset:25664
    ds_read_b64_tr_b16 a[198:199], v114 offset:38464
    ds_read_b64_tr_b16 v[148:149], v114 offset:25984
    ds_read_b64_tr_b16 v[150:151], v114 offset:38784
    ds_read_b64_tr_b16 v[228:229], v114 offset:26016
    ds_read_b64_tr_b16 v[230:231], v114 offset:38816
    ds_read_b64_tr_b16 v[80:81], v114 offset:26048
    ds_read_b64_tr_b16 v[82:83], v114 offset:38848
    s_waitcnt lgkmcnt(0)
    ds_write_b128 v115, v[80:83] offset:9216
    s_waitcnt vmcnt(12)
    ds_write_b128 v111, v[32:35] offset:0
    ds_write_b128 v112, v[36:39] offset:0
    ds_write_b128 v113, v[40:43] offset:0
    ds_write_b128 v111, v[44:47] offset:384
    ds_write_b128 v112, v[48:51] offset:384
    ds_write_b128 v113, v[52:55] offset:384
    s_waitcnt lgkmcnt(0)
    buffer_load_dwordx4 v[32:35], v108, s[8:11], s25 offen
    buffer_load_dwordx4 v[36:39], v109, s[8:11], s25 offen
    buffer_load_dwordx4 v[40:43], v110, s[8:11], s25 offen
    buffer_load_dwordx4 v[44:47], v108, s[12:15], s25 offen
    buffer_load_dwordx4 v[48:51], v109, s[12:15], s25 offen
    buffer_load_dwordx4 v[52:55], v110, s[12:15], s25 offen
    s_add_u32 s25, s25, 0x60000
    s_barrier
    ds_read_b64_tr_b16 a[40:41], v114 offset:0
    ds_read_b64_tr_b16 a[42:43], v114 offset:12800
    ds_read_b64_tr_b16 a[120:121], v114 offset:32
    ds_read_b64_tr_b16 a[122:123], v114 offset:12832
    ds_read_b64_tr_b16 a[200:201], v114 offset:64
    ds_read_b64_tr_b16 a[202:203], v114 offset:12864
    ds_read_b64_tr_b16 v[152:153], v114 offset:384
    ds_read_b64_tr_b16 v[154:155], v114 offset:13184
    ds_read_b64_tr_b16 v[232:233], v114 offset:416
    ds_read_b64_tr_b16 v[234:235], v114 offset:13216
    ds_read_b64_tr_b16 v[80:81], v114 offset:448
    ds_read_b64_tr_b16 v[82:83], v114 offset:13248
    s_waitcnt lgkmcnt(0)
    ds_write_b128 v115, v[80:83] offset:10240
    s_waitcnt vmcnt(12)
    ds_write_b128 v111, v[56:59] offset:25600
    ds_write_b128 v112, v[60:63] offset:25600
    ds_write_b128 v113, v[64:67] offset:25600
    ds_write_b128 v111, v[68:71] offset:25984
    ds_write_b128 v112, v[72:75] offset:25984
    ds_write_b128 v113, v[76:79] offset:25984
    s_waitcnt lgkmcnt(0)
    buffer_load_dwordx4 v[56:59], v108, s[8:11], s25 offen
    buffer_load_dwordx4 v[60:63], v109, s[8:11], s25 offen
    buffer_load_dwordx4 v[64:67], v110, s[8:11], s25 offen
    buffer_load_dwordx4 v[68:71], v108, s[12:15], s25 offen
    buffer_load_dwordx4 v[72:75], v109, s[12:15], s25 offen
    buffer_load_dwordx4 v[76:79], v110, s[12:15], s25 offen
    s_add_u32 s25, s25, 0x60000
    s_barrier
    ds_read_b64_tr_b16 a[44:45], v114 offset:25600
    ds_read_b64_tr_b16 a[46:47], v114 offset:38400
    ds_read_b64_tr_b16 a[124:125], v114 offset:25632
    ds_read_b64_tr_b16 a[126:127], v114 offset:38432
    ds_read_b64_tr_b16 a[204:205], v114 offset:25664
    ds_read_b64_tr_b16 a[206:207], v114 offset:38464
    ds_read_b64_tr_b16 v[156:157], v114 offset:25984
    ds_read_b64_tr_b16 v[158:159], v114 offset:38784
    ds_read_b64_tr_b16 v[236:237], v114 offset:26016
    ds_read_b64_tr_b16 v[238:239], v114 offset:38816
    ds_read_b64_tr_b16 v[80:81], v114 offset:26048
    ds_read_b64_tr_b16 v[82:83], v114 offset:38848
    s_waitcnt lgkmcnt(0)
    ds_write_b128 v115, v[80:83] offset:11264
    s_waitcnt vmcnt(12)
    ds_write_b128 v111, v[8:11] offset:0
    ds_write_b128 v112, v[12:15] offset:0
    ds_write_b128 v113, v[16:19] offset:0
    ds_write_b128 v111, v[20:23] offset:384
    ds_write_b128 v112, v[24:27] offset:384
    ds_write_b128 v113, v[28:31] offset:384
    s_waitcnt lgkmcnt(0)
    buffer_load_dwordx4 v[8:11], v108, s[8:11], s25 offen
    buffer_load_dwordx4 v[12:15], v109, s[8:11], s25 offen
    buffer_load_dwordx4 v[16:19], v110, s[8:11], s25 offen
    buffer_load_dwordx4 v[20:23], v108, s[12:15], s25 offen
    buffer_load_dwordx4 v[24:27], v109, s[12:15], s25 offen
    buffer_load_dwordx4 v[28:31], v110, s[12:15], s25 offen
    s_add_u32 s25, s25, 0x60000
    s_barrier
    ds_read_b64_tr_b16 a[48:49], v114 offset:0
    ds_read_b64_tr_b16 a[50:51], v114 offset:12800
    ds_read_b64_tr_b16 a[128:129], v114 offset:32
    ds_read_b64_tr_b16 a[130:131], v114 offset:12832
    ds_read_b64_tr_b16 a[208:209], v114 offset:64
    ds_read_b64_tr_b16 a[210:211], v114 offset:12864
    ds_read_b64_tr_b16 v[160:161], v114 offset:384
    ds_read_b64_tr_b16 v[162:163], v114 offset:13184
    ds_read_b64_tr_b16 v[240:241], v114 offset:416
    ds_read_b64_tr_b16 v[242:243], v114 offset:13216
    ds_read_b64_tr_b16 v[80:81], v114 offset:448
    ds_read_b64_tr_b16 v[82:83], v114 offset:13248
    s_waitcnt lgkmcnt(0)
    ds_write_b128 v115, v[80:83] offset:12288
    s_waitcnt vmcnt(12)
    ds_write_b128 v111, v[32:35] offset:25600
    ds_write_b128 v112, v[36:39] offset:25600
    ds_write_b128 v113, v[40:43] offset:25600
    ds_write_b128 v111, v[44:47] offset:25984
    ds_write_b128 v112, v[48:51] offset:25984
    ds_write_b128 v113, v[52:55] offset:25984
    s_waitcnt lgkmcnt(0)
    buffer_load_dwordx4 v[32:35], v108, s[8:11], s25 offen
    buffer_load_dwordx4 v[36:39], v109, s[8:11], s25 offen
    buffer_load_dwordx4 v[40:43], v110, s[8:11], s25 offen
    buffer_load_dwordx4 v[44:47], v108, s[12:15], s25 offen
    buffer_load_dwordx4 v[48:51], v109, s[12:15], s25 offen
    buffer_load_dwordx4 v[52:55], v110, s[12:15], s25 offen
    s_add_u32 s25, s25, 0x60000
    s_barrier
    ds_read_b64_tr_b16 a[52:53], v114 offset:25600
    ds_read_b64_tr_b16 a[54:55], v114 offset:38400
    ds_read_b64_tr_b16 a[132:133], v114 offset:25632
    ds_read_b64_tr_b16 a[134:135], v114 offset:38432
    ds_read_b64_tr_b16 a[212:213], v114 offset:25664
    ds_read_b64_tr_b16 a[214:215], v114 offset:38464
    ds_read_b64_tr_b16 v[164:165], v114 offset:25984
    ds_read_b64_tr_b16 v[166:167], v114 offset:38784
    ds_read_b64_tr_b16 v[244:245], v114 offset:26016
    ds_read_b64_tr_b16 v[246:247], v114 offset:38816
    ds_read_b64_tr_b16 v[80:81], v114 offset:26048
    ds_read_b64_tr_b16 v[82:83], v114 offset:38848
    s_waitcnt lgkmcnt(0)
    ds_write_b128 v115, v[80:83] offset:13312
    s_waitcnt vmcnt(12)
    ds_write_b128 v111, v[56:59] offset:0
    ds_write_b128 v112, v[60:63] offset:0
    ds_write_b128 v113, v[64:67] offset:0
    ds_write_b128 v111, v[68:71] offset:384
    ds_write_b128 v112, v[72:75] offset:384
    ds_write_b128 v113, v[76:79] offset:384
    s_waitcnt lgkmcnt(0)
    buffer_load_dwordx4 v[56:59], v108, s[8:11], s25 offen
    buffer_load_dwordx4 v[60:63], v109, s[8:11], s25 offen
    buffer_load_dwordx4 v[64:67], v110, s[8:11], s25 offen
    buffer_load_dwordx4 v[68:71], v108, s[12:15], s25 offen
    buffer_load_dwordx4 v[72:75], v109, s[12:15], s25 offen
    buffer_load_dwordx4 v[76:79], v110, s[12:15], s25 offen
    s_add_u32 s25, s25, 0x60000
    s_barrier
    ds_read_b64_tr_b16 a[56:57], v114 offset:0
    ds_read_b64_tr_b16 a[58:59], v114 offset:12800
    ds_read_b64_tr_b16 a[136:137], v114 offset:32
    ds_read_b64_tr_b16 a[138:139], v114 offset:12832
    ds_read_b64_tr_b16 a[216:217], v114 offset:64
    ds_read_b64_tr_b16 a[218:219], v114 offset:12864
    ds_read_b64_tr_b16 v[168:169], v114 offset:384
    ds_read_b64_tr_b16 v[170:171], v114 offset:13184
    ds_read_b64_tr_b16 v[248:249], v114 offset:416
    ds_read_b64_tr_b16 v[250:251], v114 offset:13216
    ds_read_b64_tr_b16 v[80:81], v114 offset:448
    ds_read_b64_tr_b16 v[82:83], v114 offset:13248
    s_waitcnt lgkmcnt(0)
    ds_write_b128 v115, v[80:83] offset:14336
    s_waitcnt vmcnt(12)
    ds_write_b128 v111, v[8:11] offset:25600
    ds_write_b128 v112, v[12:15] offset:25600
    ds_write_b128 v113, v[16:19] offset:25600
    ds_write_b128 v111, v[20:23] offset:25984
    ds_write_b128 v112, v[24:27] offset:25984
    ds_write_b128 v113, v[28:31] offset:25984
    s_waitcnt lgkmcnt(0)
    buffer_load_dwordx4 v[8:11], v108, s[8:11], s25 offen
    buffer_load_dwordx4 v[12:15], v109, s[8:11], s25 offen
    buffer_load_dwordx4 v[16:19], v110, s[8:11], s25 offen
    buffer_load_dwordx4 v[20:23], v108, s[12:15], s25 offen
    buffer_load_dwordx4 v[24:27], v109, s[12:15], s25 offen
    buffer_load_dwordx4 v[28:31], v110, s[12:15], s25 offen
    s_add_u32 s25, s25, 0x60000
    s_barrier
    ds_read_b64_tr_b16 a[60:61], v114 offset:25600
    ds_read_b64_tr_b16 a[62:63], v114 offset:38400
    ds_read_b64_tr_b16 a[140:141], v114 offset:25632
    ds_read_b64_tr_b16 a[142:143], v114 offset:38432
    ds_read_b64_tr_b16 a[220:221], v114 offset:25664
    ds_read_b64_tr_b16 a[222:223], v114 offset:38464
    ds_read_b64_tr_b16 v[172:173], v114 offset:25984
    ds_read_b64_tr_b16 v[174:175], v114 offset:38784
    ds_read_b64_tr_b16 v[252:253], v114 offset:26016
    ds_read_b64_tr_b16 v[254:255], v114 offset:38816
    ds_read_b64_tr_b16 v[80:81], v114 offset:26048
    ds_read_b64_tr_b16 v[82:83], v114 offset:38848
    s_waitcnt lgkmcnt(0)
    ds_write_b128 v115, v[80:83] offset:15360
    s_waitcnt vmcnt(12)
    ds_write_b128 v111, v[32:35] offset:0
    ds_write_b128 v112, v[36:39] offset:0
    ds_write_b128 v113, v[40:43] offset:0
    ds_write_b128 v111, v[44:47] offset:384
    ds_write_b128 v112, v[48:51] offset:384
    ds_write_b128 v113, v[52:55] offset:384
    s_waitcnt lgkmcnt(0)
    buffer_load_dwordx4 v[32:35], v108, s[8:11], s25 offen
    buffer_load_dwordx4 v[36:39], v109, s[8:11], s25 offen
    buffer_load_dwordx4 v[40:43], v110, s[8:11], s25 offen
    buffer_load_dwordx4 v[44:47], v108, s[12:15], s25 offen
    buffer_load_dwordx4 v[48:51], v109, s[12:15], s25 offen
    buffer_load_dwordx4 v[52:55], v110, s[12:15], s25 offen
    s_add_u32 s25, s25, 0x60000
    s_barrier
    ds_read_b64_tr_b16 a[64:65], v114 offset:0
    ds_read_b64_tr_b16 a[66:67], v114 offset:12800
    ds_read_b64_tr_b16 a[144:145], v114 offset:32
    ds_read_b64_tr_b16 a[146:147], v114 offset:12832
    ds_read_b64_tr_b16 a[224:225], v114 offset:64
    ds_read_b64_tr_b16 a[226:227], v114 offset:12864
    ds_read_b64_tr_b16 v[176:177], v114 offset:384
    ds_read_b64_tr_b16 v[178:179], v114 offset:13184
    ds_read_b64_tr_b16 v[80:81], v114 offset:416
    ds_read_b64_tr_b16 v[82:83], v114 offset:13216
    ds_read_b64_tr_b16 v[84:85], v114 offset:448
    ds_read_b64_tr_b16 v[86:87], v114 offset:13248
    s_waitcnt lgkmcnt(0)
    ds_write_b128 v115, v[80:83] offset:16384
    ds_write_b128 v115, v[84:87] offset:18432
    s_waitcnt vmcnt(12)
    ds_write_b128 v111, v[56:59] offset:25600
    ds_write_b128 v112, v[60:63] offset:25600
    ds_write_b128 v113, v[64:67] offset:25600
    ds_write_b128 v111, v[68:71] offset:25984
    ds_write_b128 v112, v[72:75] offset:25984
    ds_write_b128 v113, v[76:79] offset:25984
    s_waitcnt lgkmcnt(0)
    s_barrier
    ds_read_b64_tr_b16 a[68:69], v114 offset:25600
    ds_read_b64_tr_b16 a[70:71], v114 offset:38400
    ds_read_b64_tr_b16 a[148:149], v114 offset:25632
    ds_read_b64_tr_b16 a[150:151], v114 offset:38432
    ds_read_b64_tr_b16 a[228:229], v114 offset:25664
    ds_read_b64_tr_b16 a[230:231], v114 offset:38464
    ds_read_b64_tr_b16 v[180:181], v114 offset:25984
    ds_read_b64_tr_b16 v[182:183], v114 offset:38784
    ds_read_b64_tr_b16 v[80:81], v114 offset:26016
    ds_read_b64_tr_b16 v[82:83], v114 offset:38816
    ds_read_b64_tr_b16 v[84:85], v114 offset:26048
    ds_read_b64_tr_b16 v[86:87], v114 offset:38848
    s_waitcnt lgkmcnt(0)
    ds_write_b128 v115, v[80:83] offset:17408
    ds_write_b128 v115, v[84:87] offset:19456
    s_waitcnt vmcnt(6)
    ds_write_b128 v111, v[8:11] offset:0
    ds_write_b128 v112, v[12:15] offset:0
    ds_write_b128 v113, v[16:19] offset:0
    ds_write_b128 v111, v[20:23] offset:384
    ds_write_b128 v112, v[24:27] offset:384
    ds_write_b128 v113, v[28:31] offset:384
    s_waitcnt lgkmcnt(0)
    s_barrier
    ds_read_b64_tr_b16 a[72:73], v114 offset:0
    ds_read_b64_tr_b16 a[74:75], v114 offset:12800
    ds_read_b64_tr_b16 a[152:153], v114 offset:32
    ds_read_b64_tr_b16 a[154:155], v114 offset:12832
    ds_read_b64_tr_b16 a[232:233], v114 offset:64
    ds_read_b64_tr_b16 a[234:235], v114 offset:12864
    ds_read_b64_tr_b16 v[184:185], v114 offset:384
    ds_read_b64_tr_b16 v[186:187], v114 offset:13184
    ds_read_b64_tr_b16 v[80:81], v114 offset:416
    ds_read_b64_tr_b16 v[82:83], v114 offset:13216
    ds_read_b64_tr_b16 v[84:85], v114 offset:448
    ds_read_b64_tr_b16 v[86:87], v114 offset:13248
    s_waitcnt lgkmcnt(0)
    ds_write_b128 v115, v[80:83] offset:20480
    ds_write_b128 v115, v[84:87] offset:22528
    s_waitcnt vmcnt(0)
    ds_write_b128 v111, v[32:35] offset:25600
    ds_write_b128 v112, v[36:39] offset:25600
    ds_write_b128 v113, v[40:43] offset:25600
    ds_write_b128 v111, v[44:47] offset:25984
    ds_write_b128 v112, v[48:51] offset:25984
    ds_write_b128 v113, v[52:55] offset:25984
    s_waitcnt lgkmcnt(0)
    s_barrier
    ds_read_b64_tr_b16 a[76:77], v114 offset:25600
    ds_read_b64_tr_b16 a[78:79], v114 offset:38400
    ds_read_b64_tr_b16 a[156:157], v114 offset:25632
    ds_read_b64_tr_b16 a[158:159], v114 offset:38432
    ds_read_b64_tr_b16 a[236:237], v114 offset:25664
    ds_read_b64_tr_b16 a[238:239], v114 offset:38464
    ds_read_b64_tr_b16 v[188:189], v114 offset:25984
    ds_read_b64_tr_b16 v[190:191], v114 offset:38784
    ds_read_b64_tr_b16 v[80:81], v114 offset:26016
    ds_read_b64_tr_b16 v[82:83], v114 offset:38816
    ds_read_b64_tr_b16 v[84:85], v114 offset:26048
    ds_read_b64_tr_b16 v[86:87], v114 offset:38848
    s_waitcnt lgkmcnt(0)
    ds_write_b128 v115, v[80:83] offset:21504
    ds_write_b128 v115, v[84:87] offset:23552
    s_waitcnt lgkmcnt(0)
    s_barrier
    v_mov_b32 v4, 4
Lwi_30:
    buffer_load_dword v5, v4, s[88:91], 0 offen sc1
    s_waitcnt vmcnt(0)
    v_cmp_gt_u32 vcc, 224, v5
    s_cbranch_vccz Lwid_31
    s_sub_u32 s101, s101, 1
    s_cbranch_scc1 L_abort
    s_sleep 8
    s_branch Lwi_30
Lwid_31:
    v_and_b32 v4, 7, v1
    v_lshlrev_b32 v4, 5, v4
Lac_32:
    buffer_load_dword v6, v4, s[88:91], 0 offen sc1
    s_waitcnt vmcnt(0)
    v_readlane_b32 s32, v6, 0
    v_readlane_b32 s33, v6, 1
    v_readlane_b32 s34, v6, 2
    v_readlane_b32 s35, v6, 3
    v_readlane_b32 s36, v6, 4
    v_readlane_b32 s37, v6, 5
    v_readlane_b32 s38, v6, 6
    v_readlane_b32 s39, v6, 7
    s_add_u32 s26, s32, s33
    s_add_u32 s26, s26, s34
    s_add_u32 s26, s26, s35
    s_add_u32 s26, s26, s36
    s_add_u32 s26, s26, s37
    s_add_u32 s26, s26, s38
    s_add_u32 s26, s26, s39
    s_cmp_ge_u32 s26, 256
    s_cbranch_scc1 Lacd_33
    s_sub_u32 s101, s101, 1
    s_cbranch_scc1 L_abort
    s_sleep 8
    s_branch Lac_32
Lacd_33:
    s_min_u32 s26, s32, s33
    s_min_u32 s26, s26, s34
    s_min_u32 s26, s26, s35
    s_cmp_lt_u32 s26, 28
    s_cselect_b32 s23, 1, 0
    v_and_b32 v3, 15, v1
    v_lshrrev_b32 v4, 4, v1
    v_mov_b32 v120, 0x4444
    v_mov_b32 v5, 0xeeee
    v_cmp_le_u32 vcc, 8, v3
    s_nop 1
    v_cndmask_b32 v120, v120, v5, vcc
    v_lshlrev_b32 v5, 2, v4
    v_sub_u32 v5, v3, v5
    v_mov_b32 v122, 0
    v_mov_b32 v123, 0
    v_mov_b32 v6, 0x3f80
    v_cmp_eq_u32 vcc, 0, v5
    s_nop 1
    v_cndmask_b32 v122, v122, v6, vcc
    v_mov_b32 v6, 0x3f800000
    v_cmp_eq_u32 vcc, 1, v5
    s_nop 1
    v_cndmask_b32 v122, v122, v6, vcc
    v_mov_b32 v6, 0x3f80
    v_cmp_eq_u32 vcc, 2, v5
    s_nop 1
    v_cndmask_b32 v123, v123, v6, vcc
    v_mov_b32 v6, 0x3f800000
    v_cmp_eq_u32 vcc, 3, v5
    s_nop 1
    v_cndmask_b32 v123, v123, v6, vcc
    s_mul_i32 s26, s20, 24576
    v_add_u32 v121, s26, v2
    v_mov_b32 v124, 0
    v_mov_b32 v125, 0
    s_mul_i32 s26, s20, 3072
    s_add_u32 s26, s26, 118784
    v_add_u32 v126, s26, v2
    v_and_b32 v3, 7, v1
    v_lshrrev_b32 v4, 4, v1
    s_and_b32 s26, s21, 1
    v_bfe_u32 v5, v1, 3, 1
    v_lshlrev_b32 v5, 8, v5
    v_lshrrev_b32 v6, 1, v4
    v_lshl_add_u32 v5, v6, 7, v5
    v_lshl_add_u32 v5, v3, 4, v5
    v_and_b32 v6, 1, v4
    v_lshl_add_u32 v5, v6, 3, v5
    s_lshl_b32 s27, s26, 9
    v_add_u32 v127, s27, v5
    v_lshlrev_b32 v5, 7, v6
    v_lshl_add_u32 v5, v3, 4, v5
    s_lshl_b32 s27, s26, 3
    s_add_u32 s27, s27, 1024
    v_add_u32 v7, s27, v5
    s_mul_i32 s27, s22, 10240
    s_add_u32 s27, s27, 0x100000
    s_mul_i32 s28, s21, 12288
    s_mul_i32 s26, s20, 3072
    s_add_u32 s28, s28, s26
    s_add_u32 s28, s28, 0x4200000
    s_mul_i32 s29, s21, 6144
    s_mul_i32 s26, s20, 1536
    s_add_u32 s29, s29, s26
    s_add_u32 s29, s29, 0x2000000
    s_lshr_b32 s30, s21, 1
    s_mul_i32 s30, s30, 1280
    s_add_u32 s30, s30, 0x380000
    s_lshl_b32 s26, s21, 7
    s_add_u32 s31, s26, 0
    s_add_u32 s33, s26, 16384
    s_mov_b32 s40, 0x3dd53b95
    s_mov_b32 s41, s40
    s_mul_i32 s42, s21, 40960
    s_add_u32 s42, s42, 0x7400000
    s_lshl_b32 s43, s21, 7
    s_add_u32 s43, s43, 8192
    v_mov_b32 v4, 0
    s_mov_b32 s35, 0
    s_add_u32 s37, s35, 1
    v_cmp_gt_u32 vcc, s37, v125
    s_cbranch_vccz Lck_34
Lw_35:
    buffer_load_dword v125, v124, s[4:7], s31 offen sc1
    s_waitcnt vmcnt(0)
    v_cmp_gt_u32 vcc, s37, v125
    s_cbranch_vccz Lwd_36
    s_sub_u32 s101, s101, 1
    s_cbranch_scc1 L_abort
    s_sleep 2
    s_branch Lw_35
Lwd_36:
Lck_34:
    s_mul_i32 s36, s35, 393216
    s_add_u32 s36, s36, s28
    buffer_load_dwordx4 v[72:75], v2, s[4:7], s36 offen offset:0 sc1
    buffer_load_dwordx4 v[76:79], v2, s[4:7], s36 offen offset:1024 sc1
    buffer_load_dwordx4 v[80:83], v2, s[4:7], s36 offen offset:2048 sc1
    buffer_load_dword v125, v124, s[4:7], s31 offen sc1
    s_mov_b32 s24, 0
Lq_loop:
    v_mov_b32 v48, 0
    v_mov_b32 v49, 0
    v_mov_b32 v50, 0
    v_mov_b32 v51, 0
    v_mov_b32 v52, 0
    v_mov_b32 v53, 0
    v_mov_b32 v54, 0
    v_mov_b32 v55, 0
    v_mov_b32 v56, 0
    v_mov_b32 v57, 0
    v_mov_b32 v58, 0
    v_mov_b32 v59, 0
    v_mov_b32 v60, 0
    v_mov_b32 v61, 0
    v_mov_b32 v62, 0
    v_mov_b32 v63, 0
    v_mov_b32 v64, 0
    v_mov_b32 v65, 0
    v_mov_b32 v66, 0
    v_mov_b32 v67, 0
    v_mov_b32 v68, 0
    v_mov_b32 v69, 0
    v_mov_b32 v70, 0
    v_mov_b32 v71, 0
    s_mul_i32 s34, s24, 40960
    s_add_u32 s34, s34, s27
    s_and_b32 s26, s24, 1
    s_mul_i32 s26, s26, 10240
    s_add_u32 s26, s26, 98304
    v_add_u32 v5, s26, v2
    s_cmp_eq_u32 s20, 1
    s_cbranch_scc1 Lq_w1
    s_cmp_eq_u32 s20, 2
    s_cbranch_scc1 Lq_w2
    s_cmp_eq_u32 s20, 3
    s_cbranch_scc1 Lq_w3
Lq_w0:
    ds_read_b128 v[84:87], v121 offset:0
    ds_read_b128 v[88:91], v121 offset:1024
    ds_read_b128 v[92:95], v121 offset:2048
    ds_read_b128 v[96:99], v121 offset:3072
    ds_read_b128 v[100:103], v121 offset:4096
    ds_read_b128 v[104:107], v121 offset:5120
    s_add_u32 s35, s34, 0
    buffer_load_dwordx4 v[8:11], v2, s[4:7], s35 offen offset:0 sc1
    buffer_load_dwordx4 v[12:15], v2, s[4:7], s35 offen offset:1024 sc1
    buffer_load_dwordx4 v[16:19], v2, s[4:7], s35 offen offset:2048 sc1
    s_sleep 2
    buffer_load_dwordx4 v[108:111], v2, s[4:7], s35 offen offset:0 sc1
    buffer_load_dwordx4 v[112:115], v2, s[4:7], s35 offen offset:1024 sc1
    buffer_load_dwordx4 v[116:119], v2, s[4:7], s35 offen offset:2048 sc1
    s_waitcnt lgkmcnt(0)
Lq_la0:
    s_waitcnt vmcnt(3)
    v_max3_u32 v6, v8, v9, v10
    v_max3_u32 v6, v6, v11, v12
    v_max3_u32 v6, v6, v13, v14
    v_max3_u32 v6, v6, v15, v16
    v_max3_u32 v6, v6, v17, v18
    v_max_u32 v6, v6, v19
    v_cmp_eq_u32 vcc, -1, v6
    s_cbranch_vccz Lq_ua0
    buffer_load_dwordx4 v[8:11], v2, s[4:7], s35 offen offset:0 sc1
    buffer_load_dwordx4 v[12:15], v2, s[4:7], s35 offen offset:1024 sc1
    buffer_load_dwordx4 v[16:19], v2, s[4:7], s35 offen offset:2048 sc1
    s_waitcnt vmcnt(3)
    v_max3_u32 v6, v108, v109, v110
    v_max3_u32 v6, v6, v111, v112
    v_max3_u32 v6, v6, v113, v114
    v_max3_u32 v6, v6, v115, v116
    v_max3_u32 v6, v6, v117, v118
    v_max_u32 v6, v6, v119
    v_cmp_eq_u32 vcc, -1, v6
    s_cbranch_vccz Lq_ub0
    s_sub_u32 s101, s101, 1
    s_cbranch_scc1 L_abort
    buffer_load_dwordx4 v[108:111], v2, s[4:7], s35 offen offset:0 sc1
    buffer_load_dwordx4 v[112:115], v2, s[4:7], s35 offen offset:1024 sc1
    buffer_load_dwordx4 v[116:119], v2, s[4:7], s35 offen offset:2048 sc1
    s_branch Lq_la0
Lq_ua0:
    ds_write_b128 v5, v[8:11] offset:0
    ds_write_b128 v5, v[12:15] offset:1024
    ds_write_b128 v5, v[16:19] offset:2048
    v_smfmac_f32_16x16x64_bf16 v[48:51], v[8:11], a[0:7], v120
    v_smfmac_f32_16x16x64_bf16 v[60:63], v[8:11], a[240:247], v120
    v_smfmac_f32_16x16x64_bf16 v[52:55], v[8:11], a[80:87], v120
    v_smfmac_f32_16x16x64_bf16 v[64:67], v[8:11], v[192:199], v120
    v_smfmac_f32_16x16x64_bf16 v[56:59], v[8:11], a[160:167], v120
    v_smfmac_f32_16x16x64_bf16 v[68:71], v[8:11], v[84:91], v120
    ds_read_b128 v[84:87], v121 offset:6144
    ds_read_b128 v[88:91], v121 offset:7168
    s_waitcnt lgkmcnt(2)
    s_barrier
    ds_read_b128 v[20:23], v5 offset:3072
    ds_read_b128 v[24:27], v5 offset:4096
    ds_read_b128 v[28:31], v5 offset:5120
    ds_read_b128 v[32:35], v5 offset:6144
    v_smfmac_f32_16x16x64_bf16 v[48:51], v[12:15], a[8:15], v120
    v_smfmac_f32_16x16x64_bf16 v[60:63], v[12:15], a[248:255], v120
    v_smfmac_f32_16x16x64_bf16 v[52:55], v[12:15], a[88:95], v120
    v_smfmac_f32_16x16x64_bf16 v[64:67], v[12:15], v[200:207], v120
    v_smfmac_f32_16x16x64_bf16 v[56:59], v[12:15], a[168:175], v120
    v_smfmac_f32_16x16x64_bf16 v[68:71], v[12:15], v[92:99], v120
    ds_read_b128 v[92:95], v121 offset:8192
    ds_read_b128 v[96:99], v121 offset:9216
    ds_read_b128 v[36:39], v5 offset:7168
    ds_read_b128 v[40:43], v5 offset:8192
    v_smfmac_f32_16x16x64_bf16 v[48:51], v[16:19], a[16:23], v120
    v_smfmac_f32_16x16x64_bf16 v[60:63], v[16:19], v[128:135], v120
    v_smfmac_f32_16x16x64_bf16 v[52:55], v[16:19], a[96:103], v120
    v_smfmac_f32_16x16x64_bf16 v[64:67], v[16:19], v[208:215], v120
    v_smfmac_f32_16x16x64_bf16 v[56:59], v[16:19], a[176:183], v120
    v_smfmac_f32_16x16x64_bf16 v[68:71], v[16:19], v[100:107], v120
    ds_read_b128 v[100:103], v121 offset:10240
    ds_read_b128 v[104:107], v121 offset:11264
    ds_read_b128 v[44:47], v5 offset:9216
    s_branch Lq_jn0
Lq_ub0:
    ds_write_b128 v5, v[108:111] offset:0
    ds_write_b128 v5, v[112:115] offset:1024
    ds_write_b128 v5, v[116:119] offset:2048
    v_smfmac_f32_16x16x64_bf16 v[48:51], v[108:111], a[0:7], v120
    v_smfmac_f32_16x16x64_bf16 v[60:63], v[108:111], a[240:247], v120
    v_smfmac_f32_16x16x64_bf16 v[52:55], v[108:111], a[80:87], v120
    v_smfmac_f32_16x16x64_bf16 v[64:67], v[108:111], v[192:199], v120
    v_smfmac_f32_16x16x64_bf16 v[56:59], v[108:111], a[160:167], v120
    v_smfmac_f32_16x16x64_bf16 v[68:71], v[108:111], v[84:91], v120
    ds_read_b128 v[84:87], v121 offset:6144
    ds_read_b128 v[88:91], v121 offset:7168
    s_waitcnt lgkmcnt(2)
    s_barrier
    ds_read_b128 v[20:23], v5 offset:3072
    ds_read_b128 v[24:27], v5 offset:4096
    ds_read_b128 v[28:31], v5 offset:5120
    ds_read_b128 v[32:35], v5 offset:6144
    v_smfmac_f32_16x16x64_bf16 v[48:51], v[112:115], a[8:15], v120
    v_smfmac_f32_16x16x64_bf16 v[60:63], v[112:115], a[248:255], v120
    v_smfmac_f32_16x16x64_bf16 v[52:55], v[112:115], a[88:95], v120
    v_smfmac_f32_16x16x64_bf16 v[64:67], v[112:115], v[200:207], v120
    v_smfmac_f32_16x16x64_bf16 v[56:59], v[112:115], a[168:175], v120
    v_smfmac_f32_16x16x64_bf16 v[68:71], v[112:115], v[92:99], v120
    ds_read_b128 v[92:95], v121 offset:8192
    ds_read_b128 v[96:99], v121 offset:9216
    ds_read_b128 v[36:39], v5 offset:7168
    ds_read_b128 v[40:43], v5 offset:8192
    v_smfmac_f32_16x16x64_bf16 v[48:51], v[116:119], a[16:23], v120
    v_smfmac_f32_16x16x64_bf16 v[60:63], v[116:119], v[128:135], v120
    v_smfmac_f32_16x16x64_bf16 v[52:55], v[116:119], a[96:103], v120
    v_smfmac_f32_16x16x64_bf16 v[64:67], v[116:119], v[208:215], v120
    v_smfmac_f32_16x16x64_bf16 v[56:59], v[116:119], a[176:183], v120
    v_smfmac_f32_16x16x64_bf16 v[68:71], v[116:119], v[100:107], v120
    ds_read_b128 v[100:103], v121 offset:10240
    ds_read_b128 v[104:107], v121 offset:11264
    ds_read_b128 v[44:47], v5 offset:9216
Lq_jn0:
    s_waitcnt lgkmcnt(10)
    v_smfmac_f32_16x16x64_bf16 v[48:51], v[20:23], a[24:31], v120
    v_smfmac_f32_16x16x64_bf16 v[60:63], v[20:23], v[136:143], v120
    v_smfmac_f32_16x16x64_bf16 v[52:55], v[20:23], a[104:111], v120
    v_smfmac_f32_16x16x64_bf16 v[64:67], v[20:23], v[216:223], v120
    v_smfmac_f32_16x16x64_bf16 v[56:59], v[20:23], a[184:191], v120
    v_smfmac_f32_16x16x64_bf16 v[68:71], v[20:23], v[84:91], v120
    ds_read_b128 v[84:87], v121 offset:12288
    ds_read_b128 v[88:91], v121 offset:13312
    s_waitcnt lgkmcnt(11)
    v_smfmac_f32_16x16x64_bf16 v[48:51], v[24:27], a[32:39], v120
    v_smfmac_f32_16x16x64_bf16 v[60:63], v[24:27], v[144:151], v120
    v_smfmac_f32_16x16x64_bf16 v[52:55], v[24:27], a[112:119], v120
    v_smfmac_f32_16x16x64_bf16 v[64:67], v[24:27], v[224:231], v120
    v_smfmac_f32_16x16x64_bf16 v[56:59], v[24:27], a[192:199], v120
    s_waitcnt lgkmcnt(7)
    v_smfmac_f32_16x16x64_bf16 v[68:71], v[24:27], v[92:99], v120
    ds_read_b128 v[92:95], v121 offset:14336
    ds_read_b128 v[96:99], v121 offset:15360
    v_smfmac_f32_16x16x64_bf16 v[48:51], v[28:31], a[40:47], v120
    v_smfmac_f32_16x16x64_bf16 v[60:63], v[28:31], v[152:159], v120
    v_smfmac_f32_16x16x64_bf16 v[52:55], v[28:31], a[120:127], v120
    v_smfmac_f32_16x16x64_bf16 v[64:67], v[28:31], v[232:239], v120
    v_smfmac_f32_16x16x64_bf16 v[56:59], v[28:31], a[200:207], v120
    s_waitcnt lgkmcnt(5)
    v_smfmac_f32_16x16x64_bf16 v[68:71], v[28:31], v[100:107], v120
    ds_read_b128 v[100:103], v121 offset:16384
    ds_read_b128 v[104:107], v121 offset:17408
    v_smfmac_f32_16x16x64_bf16 v[48:51], v[32:35], a[48:55], v120
    v_smfmac_f32_16x16x64_bf16 v[60:63], v[32:35], v[160:167], v120
    v_smfmac_f32_16x16x64_bf16 v[52:55], v[32:35], a[128:135], v120
    v_smfmac_f32_16x16x64_bf16 v[64:67], v[32:35], v[240:247], v120
    v_smfmac_f32_16x16x64_bf16 v[56:59], v[32:35], a[208:215], v120
    s_waitcnt lgkmcnt(4)
    v_smfmac_f32_16x16x64_bf16 v[68:71], v[32:35], v[84:91], v120
    ds_read_b128 v[84:87], v121 offset:18432
    ds_read_b128 v[88:91], v121 offset:19456
    v_smfmac_f32_16x16x64_bf16 v[48:51], v[36:39], a[56:63], v120
    v_smfmac_f32_16x16x64_bf16 v[60:63], v[36:39], v[168:175], v120
    v_smfmac_f32_16x16x64_bf16 v[52:55], v[36:39], a[136:143], v120
    v_smfmac_f32_16x16x64_bf16 v[64:67], v[36:39], v[248:255], v120
    v_smfmac_f32_16x16x64_bf16 v[56:59], v[36:39], a[216:223], v120
    s_waitcnt lgkmcnt(4)
    v_smfmac_f32_16x16x64_bf16 v[68:71], v[36:39], v[92:99], v120
    ds_read_b128 v[92:95], v121 offset:20480
    ds_read_b128 v[96:99], v121 offset:21504
    v_smfmac_f32_16x16x64_bf16 v[48:51], v[40:43], a[64:71], v120
    v_smfmac_f32_16x16x64_bf16 v[60:63], v[40:43], v[176:183], v120
    v_smfmac_f32_16x16x64_bf16 v[52:55], v[40:43], a[144:151], v120
    s_waitcnt lgkmcnt(4)
    v_smfmac_f32_16x16x64_bf16 v[64:67], v[40:43], v[100:107], v120
    ds_read_b128 v[100:103], v121 offset:22528
    ds_read_b128 v[104:107], v121 offset:23552
    v_smfmac_f32_16x16x64_bf16 v[56:59], v[40:43], a[224:231], v120
    s_waitcnt lgkmcnt(4)
    v_smfmac_f32_16x16x64_bf16 v[68:71], v[40:43], v[84:91], v120
    v_smfmac_f32_16x16x64_bf16 v[48:51], v[44:47], a[72:79], v120
    v_smfmac_f32_16x16x64_bf16 v[60:63], v[44:47], v[184:191], v120
    v_smfmac_f32_16x16x64_bf16 v[52:55], v[44:47], a[152:159], v120
    s_waitcnt lgkmcnt(2)
    v_smfmac_f32_16x16x64_bf16 v[64:67], v[44:47], v[92:99], v120
    v_smfmac_f32_16x16x64_bf16 v[56:59], v[44:47], a[232:239], v120
    s_waitcnt lgkmcnt(0)
    v_smfmac_f32_16x16x64_bf16 v[68:71], v[44:47], v[100:107], v120
    s_branch Lq_post
Lq_w1:
    ds_read_b128 v[84:87], v121 offset:6144
    ds_read_b128 v[88:91], v121 offset:7168
    ds_read_b128 v[92:95], v121 offset:8192
    ds_read_b128 v[96:99], v121 offset:9216
    ds_read_b128 v[100:103], v121 offset:10240
    ds_read_b128 v[104:107], v121 offset:11264
    s_add_u32 s35, s34, 3072
    buffer_load_dwordx4 v[20:23], v2, s[4:7], s35 offen offset:0 sc1
    buffer_load_dwordx4 v[24:27], v2, s[4:7], s35 offen offset:1024 sc1
    buffer_load_dwordx4 v[28:31], v2, s[4:7], s35 offen offset:2048 sc1
    s_sleep 2
    buffer_load_dwordx4 v[108:111], v2, s[4:7], s35 offen offset:0 sc1
    buffer_load_dwordx4 v[112:115], v2, s[4:7], s35 offen offset:1024 sc1
    buffer_load_dwordx4 v[116:119], v2, s[4:7], s35 offen offset:2048 sc1
    s_waitcnt lgkmcnt(0)
Lq_la1:
    s_waitcnt vmcnt(3)
    v_max3_u32 v6, v20, v21, v22
    v_max3_u32 v6, v6, v23, v24
    v_max3_u32 v6, v6, v25, v26
    v_max3_u32 v6, v6, v27, v28
    v_max3_u32 v6, v6, v29, v30
    v_max_u32 v6, v6, v31
    v_cmp_eq_u32 vcc, -1, v6
    s_cbranch_vccz Lq_ua1
    buffer_load_dwordx4 v[20:23], v2, s[4:7], s35 offen offset:0 sc1
    buffer_load_dwordx4 v[24:27], v2, s[4:7], s35 offen offset:1024 sc1
    buffer_load_dwordx4 v[28:31], v2, s[4:7], s35 offen offset:2048 sc1
    s_waitcnt vmcnt(3)
    v_max3_u32 v6, v108, v109, v110
    v_max3_u32 v6, v6, v111, v112
    v_max3_u32 v6, v6, v113, v114
    v_max3_u32 v6, v6, v115, v116
    v_max3_u32 v6, v6, v117, v118
    v_max_u32 v6, v6, v119
    v_cmp_eq_u32 vcc, -1, v6
    s_cbranch_vccz Lq_ub1
    s_sub_u32 s101, s101, 1
    s_cbranch_scc1 L_abort
    buffer_load_dwordx4 v[108:111], v2, s[4:7], s35 offen offset:0 sc1
    buffer_load_dwordx4 v[112:115], v2, s[4:7], s35 offen offset:1024 sc1
    buffer_load_dwordx4 v[116:119], v2, s[4:7], s35 offen offset:2048 sc1
    s_branch Lq_la1
Lq_ua1:
    ds_write_b128 v5, v[20:23] offset:3072
    ds_write_b128 v5, v[24:27] offset:4096
    ds_write_b128 v5, v[28:31] offset:5120
    v_smfmac_f32_16x16x64_bf16 v[48:51], v[20:23], a[24:31], v120
    v_smfmac_f32_16x16x64_bf16 v[60:63], v[20:23], v[136:143], v120
    v_smfmac_f32_16x16x64_bf16 v[52:55], v[20:23], a[104:111], v120
    v_smfmac_f32_16x16x64_bf16 v[64:67], v[20:23], v[216:223], v120
    v_smfmac_f32_16x16x64_bf16 v[56:59], v[20:23], a[184:191], v120
    v_smfmac_f32_16x16x64_bf16 v[68:71], v[20:23], v[84:91], v120
    ds_read_b128 v[84:87], v121 offset:12288
    ds_read_b128 v[88:91], v121 offset:13312
    s_waitcnt lgkmcnt(2)
    s_barrier
    ds_read_b128 v[32:35], v5 offset:6144
    ds_read_b128 v[36:39], v5 offset:7168
    ds_read_b128 v[40:43], v5 offset:8192
    ds_read_b128 v[44:47], v5 offset:9216
    v_smfmac_f32_16x16x64_bf16 v[48:51], v[24:27], a[32:39], v120
    v_smfmac_f32_16x16x64_bf16 v[60:63], v[24:27], v[144:151], v120
    v_smfmac_f32_16x16x64_bf16 v[52:55], v[24:27], a[112:119], v120
    v_smfmac_f32_16x16x64_bf16 v[64:67], v[24:27], v[224:231], v120
    v_smfmac_f32_16x16x64_bf16 v[56:59], v[24:27], a[192:199], v120
    v_smfmac_f32_16x16x64_bf16 v[68:71], v[24:27], v[92:99], v120
    ds_read_b128 v[92:95], v121 offset:14336
    ds_read_b128 v[96:99], v121 offset:15360
    ds_read_b128 v[8:11], v5 offset:0
    ds_read_b128 v[12:15], v5 offset:1024
    v_smfmac_f32_16x16x64_bf16 v[48:51], v[28:31], a[40:47], v120
    v_smfmac_f32_16x16x64_bf16 v[60:63], v[28:31], v[152:159], v120
    v_smfmac_f32_16x16x64_bf16 v[52:55], v[28:31], a[120:127], v120
    v_smfmac_f32_16x16x64_bf16 v[64:67], v[28:31], v[232:239], v120
    v_smfmac_f32_16x16x64_bf16 v[56:59], v[28:31], a[200:207], v120
    v_smfmac_f32_16x16x64_bf16 v[68:71], v[28:31], v[100:107], v120
    ds_read_b128 v[100:103], v121 offset:16384
    ds_read_b128 v[104:107], v121 offset:17408
    ds_read_b128 v[16:19], v5 offset:2048
    s_branch Lq_jn1
Lq_ub1:
    ds_write_b128 v5, v[108:111] offset:3072
    ds_write_b128 v5, v[112:115] offset:4096
    ds_write_b128 v5, v[116:119] offset:5120
    v_smfmac_f32_16x16x64_bf16 v[48:51], v[108:111], a[24:31], v120
    v_smfmac_f32_16x16x64_bf16 v[60:63], v[108:111], v[136:143], v120
    v_smfmac_f32_16x16x64_bf16 v[52:55], v[108:111], a[104:111], v120
    v_smfmac_f32_16x16x64_bf16 v[64:67], v[108:111], v[216:223], v120
    v_smfmac_f32_16x16x64_bf16 v[56:59], v[108:111], a[184:191], v120
    v_smfmac_f32_16x16x64_bf16 v[68:71], v[108:111], v[84:91], v120
    ds_read_b128 v[84:87], v121 offset:12288
    ds_read_b128 v[88:91], v121 offset:13312
    s_waitcnt lgkmcnt(2)
    s_barrier
    ds_read_b128 v[32:35], v5 offset:6144
    ds_read_b128 v[36:39], v5 offset:7168
    ds_read_b128 v[40:43], v5 offset:8192
    ds_read_b128 v[44:47], v5 offset:9216
    v_smfmac_f32_16x16x64_bf16 v[48:51], v[112:115], a[32:39], v120
    v_smfmac_f32_16x16x64_bf16 v[60:63], v[112:115], v[144:151], v120
    v_smfmac_f32_16x16x64_bf16 v[52:55], v[112:115], a[112:119], v120
    v_smfmac_f32_16x16x64_bf16 v[64:67], v[112:115], v[224:231], v120
    v_smfmac_f32_16x16x64_bf16 v[56:59], v[112:115], a[192:199], v120
    v_smfmac_f32_16x16x64_bf16 v[68:71], v[112:115], v[92:99], v120
    ds_read_b128 v[92:95], v121 offset:14336
    ds_read_b128 v[96:99], v121 offset:15360
    ds_read_b128 v[8:11], v5 offset:0
    ds_read_b128 v[12:15], v5 offset:1024
    v_smfmac_f32_16x16x64_bf16 v[48:51], v[116:119], a[40:47], v120
    v_smfmac_f32_16x16x64_bf16 v[60:63], v[116:119], v[152:159], v120
    v_smfmac_f32_16x16x64_bf16 v[52:55], v[116:119], a[120:127], v120
    v_smfmac_f32_16x16x64_bf16 v[64:67], v[116:119], v[232:239], v120
    v_smfmac_f32_16x16x64_bf16 v[56:59], v[116:119], a[200:207], v120
    v_smfmac_f32_16x16x64_bf16 v[68:71], v[116:119], v[100:107], v120
    ds_read_b128 v[100:103], v121 offset:16384
    ds_read_b128 v[104:107], v121 offset:17408
    ds_read_b128 v[16:19], v5 offset:2048
Lq_jn1:
    s_waitcnt lgkmcnt(10)
    v_smfmac_f32_16x16x64_bf16 v[48:51], v[32:35], a[48:55], v120
    v_smfmac_f32_16x16x64_bf16 v[60:63], v[32:35], v[160:167], v120
    v_smfmac_f32_16x16x64_bf16 v[52:55], v[32:35], a[128:135], v120
    v_smfmac_f32_16x16x64_bf16 v[64:67], v[32:35], v[240:247], v120
    v_smfmac_f32_16x16x64_bf16 v[56:59], v[32:35], a[208:215], v120
    v_smfmac_f32_16x16x64_bf16 v[68:71], v[32:35], v[84:91], v120
    ds_read_b128 v[84:87], v121 offset:18432
    ds_read_b128 v[88:91], v121 offset:19456
    s_waitcnt lgkmcnt(11)
    v_smfmac_f32_16x16x64_bf16 v[48:51], v[36:39], a[56:63], v120
    v_smfmac_f32_16x16x64_bf16 v[60:63], v[36:39], v[168:175], v120
    v_smfmac_f32_16x16x64_bf16 v[52:55], v[36:39], a[136:143], v120
    v_smfmac_f32_16x16x64_bf16 v[64:67], v[36:39], v[248:255], v120
    v_smfmac_f32_16x16x64_bf16 v[56:59], v[36:39], a[216:223], v120
    s_waitcnt lgkmcnt(7)
    v_smfmac_f32_16x16x64_bf16 v[68:71], v[36:39], v[92:99], v120
    ds_read_b128 v[92:95], v121 offset:20480
    ds_read_b128 v[96:99], v121 offset:21504
    v_smfmac_f32_16x16x64_bf16 v[48:51], v[40:43], a[64:71], v120
    v_smfmac_f32_16x16x64_bf16 v[60:63], v[40:43], v[176:183], v120
    v_smfmac_f32_16x16x64_bf16 v[52:55], v[40:43], a[144:151], v120
    s_waitcnt lgkmcnt(5)
    v_smfmac_f32_16x16x64_bf16 v[64:67], v[40:43], v[100:107], v120
    ds_read_b128 v[100:103], v121 offset:22528
    ds_read_b128 v[104:107], v121 offset:23552
    v_smfmac_f32_16x16x64_bf16 v[56:59], v[40:43], a[224:231], v120
    s_waitcnt lgkmcnt(4)
    v_smfmac_f32_16x16x64_bf16 v[68:71], v[40:43], v[84:91], v120
    ds_read_b128 v[84:87], v121 offset:0
    ds_read_b128 v[88:91], v121 offset:1024
    v_smfmac_f32_16x16x64_bf16 v[48:51], v[44:47], a[72:79], v120
    v_smfmac_f32_16x16x64_bf16 v[60:63], v[44:47], v[184:191], v120
    v_smfmac_f32_16x16x64_bf16 v[52:55], v[44:47], a[152:159], v120
    s_waitcnt lgkmcnt(4)
    v_smfmac_f32_16x16x64_bf16 v[64:67], v[44:47], v[92:99], v120
    ds_read_b128 v[92:95], v121 offset:2048
    ds_read_b128 v[96:99], v121 offset:3072
    v_smfmac_f32_16x16x64_bf16 v[56:59], v[44:47], a[232:239], v120
    s_waitcnt lgkmcnt(4)
    v_smfmac_f32_16x16x64_bf16 v[68:71], v[44:47], v[100:107], v120
    ds_read_b128 v[100:103], v121 offset:4096
    ds_read_b128 v[104:107], v121 offset:5120
    v_smfmac_f32_16x16x64_bf16 v[48:51], v[8:11], a[0:7], v120
    v_smfmac_f32_16x16x64_bf16 v[60:63], v[8:11], a[240:247], v120
    v_smfmac_f32_16x16x64_bf16 v[52:55], v[8:11], a[80:87], v120
    v_smfmac_f32_16x16x64_bf16 v[64:67], v[8:11], v[192:199], v120
    v_smfmac_f32_16x16x64_bf16 v[56:59], v[8:11], a[160:167], v120
    s_waitcnt lgkmcnt(4)
    v_smfmac_f32_16x16x64_bf16 v[68:71], v[8:11], v[84:91], v120
    v_smfmac_f32_16x16x64_bf16 v[48:51], v[12:15], a[8:15], v120
    v_smfmac_f32_16x16x64_bf16 v[60:63], v[12:15], a[248:255], v120
    v_smfmac_f32_16x16x64_bf16 v[52:55], v[12:15], a[88:95], v120
    v_smfmac_f32_16x16x64_bf16 v[64:67], v[12:15], v[200:207], v120
    v_smfmac_f32_16x16x64_bf16 v[56:59], v[12:15], a[168:175], v120
    s_waitcnt lgkmcnt(2)
    v_smfmac_f32_16x16x64_bf16 v[68:71], v[12:15], v[92:99], v120
    v_smfmac_f32_16x16x64_bf16 v[48:51], v[16:19], a[16:23], v120
    v_smfmac_f32_16x16x64_bf16 v[60:63], v[16:19], v[128:135], v120
    v_smfmac_f32_16x16x64_bf16 v[52:55], v[16:19], a[96:103], v120
    v_smfmac_f32_16x16x64_bf16 v[64:67], v[16:19], v[208:215], v120
    v_smfmac_f32_16x16x64_bf16 v[56:59], v[16:19], a[176:183], v120
    s_waitcnt lgkmcnt(0)
    v_smfmac_f32_16x16x64_bf16 v[68:71], v[16:19], v[100:107], v120
    s_branch Lq_post
Lq_w2:
    ds_read_b128 v[84:87], v121 offset:12288
    ds_read_b128 v[88:91], v121 offset:13312
    ds_read_b128 v[92:95], v121 offset:14336
    ds_read_b128 v[96:99], v121 offset:15360
    ds_read_b128 v[100:103], v121 offset:16384
    ds_read_b128 v[104:107], v121 offset:17408
    s_add_u32 s35, s34, 6144
    buffer_load_dwordx4 v[32:35], v2, s[4:7], s35 offen offset:0 sc1
    buffer_load_dwordx4 v[36:39], v2, s[4:7], s35 offen offset:1024 sc1
    s_sleep 2
    buffer_load_dwordx4 v[108:111], v2, s[4:7], s35 offen offset:0 sc1
    buffer_load_dwordx4 v[112:115], v2, s[4:7], s35 offen offset:1024 sc1
    s_waitcnt lgkmcnt(0)
Lq_la2:
    s_waitcnt vmcnt(2)
    v_max3_u32 v6, v32, v33, v34
    v_max3_u32 v6, v6, v35, v36
    v_max3_u32 v6, v6, v37, v38
    v_max_u32 v6, v6, v39
    v_cmp_eq_u32 vcc, -1, v6
    s_cbranch_vccz Lq_ua2
    buffer_load_dwordx4 v[32:35], v2, s[4:7], s35 offen offset:0 sc1
    buffer_load_dwordx4 v[36:39], v2, s[4:7], s35 offen offset:1024 sc1
    s_waitcnt vmcnt(2)
    v_max3_u32 v6, v108, v109, v110
    v_max3_u32 v6, v6, v111, v112
    v_max3_u32 v6, v6, v113, v114
    v_max_u32 v6, v6, v115
    v_cmp_eq_u32 vcc, -1, v6
    s_cbranch_vccz Lq_ub2
    s_sub_u32 s101, s101, 1
    s_cbranch_scc1 L_abort
    buffer_load_dwordx4 v[108:111], v2, s[4:7], s35 offen offset:0 sc1
    buffer_load_dwordx4 v[112:115], v2, s[4:7], s35 offen offset:1024 sc1
    s_branch Lq_la2
Lq_ua2:
    ds_write_b128 v5, v[32:35] offset:6144
    ds_write_b128 v5, v[36:39] offset:7168
    v_smfmac_f32_16x16x64_bf16 v[48:51], v[32:35], a[48:55], v120
    v_smfmac_f32_16x16x64_bf16 v[60:63], v[32:35], v[160:167], v120
    v_smfmac_f32_16x16x64_bf16 v[52:55], v[32:35], a[128:135], v120
    v_smfmac_f32_16x16x64_bf16 v[64:67], v[32:35], v[240:247], v120
    v_smfmac_f32_16x16x64_bf16 v[56:59], v[32:35], a[208:215], v120
    v_smfmac_f32_16x16x64_bf16 v[68:71], v[32:35], v[84:91], v120
    ds_read_b128 v[84:87], v121 offset:18432
    ds_read_b128 v[88:91], v121 offset:19456
    s_waitcnt lgkmcnt(2)
    s_barrier
    ds_read_b128 v[40:43], v5 offset:8192
    ds_read_b128 v[44:47], v5 offset:9216
    ds_read_b128 v[8:11], v5 offset:0
    ds_read_b128 v[12:15], v5 offset:1024
    v_smfmac_f32_16x16x64_bf16 v[48:51], v[36:39], a[56:63], v120
    v_smfmac_f32_16x16x64_bf16 v[60:63], v[36:39], v[168:175], v120
    v_smfmac_f32_16x16x64_bf16 v[52:55], v[36:39], a[136:143], v120
    v_smfmac_f32_16x16x64_bf16 v[64:67], v[36:39], v[248:255], v120
    v_smfmac_f32_16x16x64_bf16 v[56:59], v[36:39], a[216:223], v120
    v_smfmac_f32_16x16x64_bf16 v[68:71], v[36:39], v[92:99], v120
    ds_read_b128 v[92:95], v121 offset:20480
    ds_read_b128 v[96:99], v121 offset:21504
    ds_read_b128 v[16:19], v5 offset:2048
    ds_read_b128 v[20:23], v5 offset:3072
    s_branch Lq_jn2
Lq_ub2:
    ds_write_b128 v5, v[108:111] offset:6144
    ds_write_b128 v5, v[112:115] offset:7168
    v_smfmac_f32_16x16x64_bf16 v[48:51], v[108:111], a[48:55], v120
    v_smfmac_f32_16x16x64_bf16 v[60:63], v[108:111], v[160:167], v120
    v_smfmac_f32_16x16x64_bf16 v[52:55], v[108:111], a[128:135], v120
    v_smfmac_f32_16x16x64_bf16 v[64:67], v[108:111], v[240:247], v120
    v_smfmac_f32_16x16x64_bf16 v[56:59], v[108:111], a[208:215], v120
    v_smfmac_f32_16x16x64_bf16 v[68:71], v[108:111], v[84:91], v120
    ds_read_b128 v[84:87], v121 offset:18432
    ds_read_b128 v[88:91], v121 offset:19456
    s_waitcnt lgkmcnt(2)
    s_barrier
    ds_read_b128 v[40:43], v5 offset:8192
    ds_read_b128 v[44:47], v5 offset:9216
    ds_read_b128 v[8:11], v5 offset:0
    ds_read_b128 v[12:15], v5 offset:1024
    v_smfmac_f32_16x16x64_bf16 v[48:51], v[112:115], a[56:63], v120
    v_smfmac_f32_16x16x64_bf16 v[60:63], v[112:115], v[168:175], v120
    v_smfmac_f32_16x16x64_bf16 v[52:55], v[112:115], a[136:143], v120
    v_smfmac_f32_16x16x64_bf16 v[64:67], v[112:115], v[248:255], v120
    v_smfmac_f32_16x16x64_bf16 v[56:59], v[112:115], a[216:223], v120
    v_smfmac_f32_16x16x64_bf16 v[68:71], v[112:115], v[92:99], v120
    ds_read_b128 v[92:95], v121 offset:20480
    ds_read_b128 v[96:99], v121 offset:21504
    ds_read_b128 v[16:19], v5 offset:2048
    ds_read_b128 v[20:23], v5 offset:3072
Lq_jn2:
    s_waitcnt lgkmcnt(7)
    v_smfmac_f32_16x16x64_bf16 v[48:51], v[40:43], a[64:71], v120
    v_smfmac_f32_16x16x64_bf16 v[60:63], v[40:43], v[176:183], v120
    v_smfmac_f32_16x16x64_bf16 v[52:55], v[40:43], a[144:151], v120
    v_smfmac_f32_16x16x64_bf16 v[64:67], v[40:43], v[100:107], v120
    ds_read_b128 v[100:103], v121 offset:22528
    ds_read_b128 v[104:107], v121 offset:23552
    v_smfmac_f32_16x16x64_bf16 v[56:59], v[40:43], a[224:231], v120
    v_smfmac_f32_16x16x64_bf16 v[68:71], v[40:43], v[84:91], v120
    ds_read_b128 v[84:87], v121 offset:0
    ds_read_b128 v[88:91], v121 offset:1024
    ds_read_b128 v[24:27], v5 offset:4096
    s_waitcnt lgkmcnt(11)
    v_smfmac_f32_16x16x64_bf16 v[48:51], v[44:47], a[72:79], v120
    v_smfmac_f32_16x16x64_bf16 v[60:63], v[44:47], v[184:191], v120
    v_smfmac_f32_16x16x64_bf16 v[52:55], v[44:47], a[152:159], v120
    s_waitcnt lgkmcnt(7)
    v_smfmac_f32_16x16x64_bf16 v[64:67], v[44:47], v[92:99], v120
    ds_read_b128 v[92:95], v121 offset:2048
    ds_read_b128 v[96:99], v121 offset:3072
    v_smfmac_f32_16x16x64_bf16 v[56:59], v[44:47], a[232:239], v120
    s_waitcnt lgkmcnt(5)
    v_smfmac_f32_16x16x64_bf16 v[68:71], v[44:47], v[100:107], v120
    ds_read_b128 v[100:103], v121 offset:4096
    ds_read_b128 v[104:107], v121 offset:5120
    ds_read_b128 v[28:31], v5 offset:5120
    v_smfmac_f32_16x16x64_bf16 v[48:51], v[8:11], a[0:7], v120
    v_smfmac_f32_16x16x64_bf16 v[60:63], v[8:11], a[240:247], v120
    v_smfmac_f32_16x16x64_bf16 v[52:55], v[8:11], a[80:87], v120
    v_smfmac_f32_16x16x64_bf16 v[64:67], v[8:11], v[192:199], v120
    v_smfmac_f32_16x16x64_bf16 v[56:59], v[8:11], a[160:167], v120
    s_waitcnt lgkmcnt(6)
    v_smfmac_f32_16x16x64_bf16 v[68:71], v[8:11], v[84:91], v120
    ds_read_b128 v[84:87], v121 offset:6144
    ds_read_b128 v[88:91], v121 offset:7168
    v_smfmac_f32_16x16x64_bf16 v[48:51], v[12:15], a[8:15], v120
    v_smfmac_f32_16x16x64_bf16 v[60:63], v[12:15], a[248:255], v120
    v_smfmac_f32_16x16x64_bf16 v[52:55], v[12:15], a[88:95], v120
    v_smfmac_f32_16x16x64_bf16 v[64:67], v[12:15], v[200:207], v120
    v_smfmac_f32_16x16x64_bf16 v[56:59], v[12:15], a[168:175], v120
    s_waitcnt lgkmcnt(5)
    v_smfmac_f32_16x16x64_bf16 v[68:71], v[12:15], v[92:99], v120
    ds_read_b128 v[92:95], v121 offset:8192
    ds_read_b128 v[96:99], v121 offset:9216
    v_smfmac_f32_16x16x64_bf16 v[48:51], v[16:19], a[16:23], v120
    v_smfmac_f32_16x16x64_bf16 v[60:63], v[16:19], v[128:135], v120
    v_smfmac_f32_16x16x64_bf16 v[52:55], v[16:19], a[96:103], v120
    v_smfmac_f32_16x16x64_bf16 v[64:67], v[16:19], v[208:215], v120
    v_smfmac_f32_16x16x64_bf16 v[56:59], v[16:19], a[176:183], v120
    s_waitcnt lgkmcnt(5)
    v_smfmac_f32_16x16x64_bf16 v[68:71], v[16:19], v[100:107], v120
    ds_read_b128 v[100:103], v121 offset:10240
    ds_read_b128 v[104:107], v121 offset:11264
    v_smfmac_f32_16x16x64_bf16 v[48:51], v[20:23], a[24:31], v120
    v_smfmac_f32_16x16x64_bf16 v[60:63], v[20:23], v[136:143], v120
    v_smfmac_f32_16x16x64_bf16 v[52:55], v[20:23], a[104:111], v120
    v_smfmac_f32_16x16x64_bf16 v[64:67], v[20:23], v[216:223], v120
    v_smfmac_f32_16x16x64_bf16 v[56:59], v[20:23], a[184:191], v120
    s_waitcnt lgkmcnt(4)
    v_smfmac_f32_16x16x64_bf16 v[68:71], v[20:23], v[84:91], v120
    v_smfmac_f32_16x16x64_bf16 v[48:51], v[24:27], a[32:39], v120
    v_smfmac_f32_16x16x64_bf16 v[60:63], v[24:27], v[144:151], v120
    v_smfmac_f32_16x16x64_bf16 v[52:55], v[24:27], a[112:119], v120
    v_smfmac_f32_16x16x64_bf16 v[64:67], v[24:27], v[224:231], v120
    v_smfmac_f32_16x16x64_bf16 v[56:59], v[24:27], a[192:199], v120
    s_waitcnt lgkmcnt(2)
    v_smfmac_f32_16x16x64_bf16 v[68:71], v[24:27], v[92:99], v120
    v_smfmac_f32_16x16x64_bf16 v[48:51], v[28:31], a[40:47], v120
    v_smfmac_f32_16x16x64_bf16 v[60:63], v[28:31], v[152:159], v120
    v_smfmac_f32_16x16x64_bf16 v[52:55], v[28:31], a[120:127], v120
    v_smfmac_f32_16x16x64_bf16 v[64:67], v[28:31], v[232:239], v120
    v_smfmac_f32_16x16x64_bf16 v[56:59], v[28:31], a[200:207], v120
    s_waitcnt lgkmcnt(0)
    v_smfmac_f32_16x16x64_bf16 v[68:71], v[28:31], v[100:107], v120
    s_branch Lq_post
Lq_w3:
    ds_read_b128 v[84:87], v121 offset:16384
    ds_read_b128 v[88:91], v121 offset:17408
    ds_read_b128 v[92:95], v121 offset:18432
    ds_read_b128 v[96:99], v121 offset:19456
    ds_read_b128 v[100:103], v121 offset:20480
    ds_read_b128 v[104:107], v121 offset:21504
    s_add_u32 s35, s34, 8192
    buffer_load_dwordx4 v[40:43], v2, s[4:7], s35 offen offset:0 sc1
    buffer_load_dwordx4 v[44:47], v2, s[4:7], s35 offen offset:1024 sc1
    s_sleep 2
    buffer_load_dwordx4 v[108:111], v2, s[4:7], s35 offen offset:0 sc1
    buffer_load_dwordx4 v[112:115], v2, s[4:7], s35 offen offset:1024 sc1
    s_waitcnt lgkmcnt(0)
Lq_la3:
    s_waitcnt vmcnt(2)
    v_max3_u32 v6, v40, v41, v42
    v_max3_u32 v6, v6, v43, v44
    v_max3_u32 v6, v6, v45, v46
    v_max_u32 v6, v6, v47
    v_cmp_eq_u32 vcc, -1, v6
    s_cbranch_vccz Lq_ua3
    buffer_load_dwordx4 v[40:43], v2, s[4:7], s35 offen offset:0 sc1
    buffer_load_dwordx4 v[44:47], v2, s[4:7], s35 offen offset:1024 sc1
    s_waitcnt vmcnt(2)
    v_max3_u32 v6, v108, v109, v110
    v_max3_u32 v6, v6, v111, v112
    v_max3_u32 v6, v6, v113, v114
    v_max_u32 v6, v6, v115
    v_cmp_eq_u32 vcc, -1, v6
    s_cbranch_vccz Lq_ub3
    s_sub_u32 s101, s101, 1
    s_cbranch_scc1 L_abort
    buffer_load_dwordx4 v[108:111], v2, s[4:7], s35 offen offset:0 sc1
    buffer_load_dwordx4 v[112:115], v2, s[4:7], s35 offen offset:1024 sc1
    s_branch Lq_la3
Lq_ua3:
    ds_write_b128 v5, v[40:43] offset:8192
    ds_write_b128 v5, v[44:47] offset:9216
    v_smfmac_f32_16x16x64_bf16 v[48:51], v[40:43], a[64:71], v120
    v_smfmac_f32_16x16x64_bf16 v[60:63], v[40:43], v[176:183], v120
    v_smfmac_f32_16x16x64_bf16 v[52:55], v[40:43], a[144:151], v120
    v_smfmac_f32_16x16x64_bf16 v[64:67], v[40:43], v[84:91], v120
    ds_read_b128 v[84:87], v121 offset:22528
    ds_read_b128 v[88:91], v121 offset:23552
    v_smfmac_f32_16x16x64_bf16 v[56:59], v[40:43], a[224:231], v120
    v_smfmac_f32_16x16x64_bf16 v[68:71], v[40:43], v[92:99], v120
    ds_read_b128 v[92:95], v121 offset:0
    ds_read_b128 v[96:99], v121 offset:1024
    s_waitcnt lgkmcnt(4)
    s_barrier
    ds_read_b128 v[8:11], v5 offset:0
    ds_read_b128 v[12:15], v5 offset:1024
    ds_read_b128 v[16:19], v5 offset:2048
    ds_read_b128 v[20:23], v5 offset:3072
    v_smfmac_f32_16x16x64_bf16 v[48:51], v[44:47], a[72:79], v120
    v_smfmac_f32_16x16x64_bf16 v[60:63], v[44:47], v[184:191], v120
    v_smfmac_f32_16x16x64_bf16 v[52:55], v[44:47], a[152:159], v120
    v_smfmac_f32_16x16x64_bf16 v[64:67], v[44:47], v[100:107], v120
    ds_read_b128 v[100:103], v121 offset:2048
    ds_read_b128 v[104:107], v121 offset:3072
    v_smfmac_f32_16x16x64_bf16 v[56:59], v[44:47], a[232:239], v120
    s_waitcnt lgkmcnt(8)
    v_smfmac_f32_16x16x64_bf16 v[68:71], v[44:47], v[84:91], v120
    ds_read_b128 v[84:87], v121 offset:4096
    ds_read_b128 v[88:91], v121 offset:5120
    ds_read_b128 v[24:27], v5 offset:4096
    ds_read_b128 v[28:31], v5 offset:5120
    s_branch Lq_jn3
Lq_ub3:
    ds_write_b128 v5, v[108:111] offset:8192
    ds_write_b128 v5, v[112:115] offset:9216
    v_smfmac_f32_16x16x64_bf16 v[48:51], v[108:111], a[64:71], v120
    v_smfmac_f32_16x16x64_bf16 v[60:63], v[108:111], v[176:183], v120
    v_smfmac_f32_16x16x64_bf16 v[52:55], v[108:111], a[144:151], v120
    v_smfmac_f32_16x16x64_bf16 v[64:67], v[108:111], v[84:91], v120
    ds_read_b128 v[84:87], v121 offset:22528
    ds_read_b128 v[88:91], v121 offset:23552
    v_smfmac_f32_16x16x64_bf16 v[56:59], v[108:111], a[224:231], v120
    v_smfmac_f32_16x16x64_bf16 v[68:71], v[108:111], v[92:99], v120
    ds_read_b128 v[92:95], v121 offset:0
    ds_read_b128 v[96:99], v121 offset:1024
    s_waitcnt lgkmcnt(4)
    s_barrier
    ds_read_b128 v[8:11], v5 offset:0
    ds_read_b128 v[12:15], v5 offset:1024
    ds_read_b128 v[16:19], v5 offset:2048
    ds_read_b128 v[20:23], v5 offset:3072
    v_smfmac_f32_16x16x64_bf16 v[48:51], v[112:115], a[72:79], v120
    v_smfmac_f32_16x16x64_bf16 v[60:63], v[112:115], v[184:191], v120
    v_smfmac_f32_16x16x64_bf16 v[52:55], v[112:115], a[152:159], v120
    v_smfmac_f32_16x16x64_bf16 v[64:67], v[112:115], v[100:107], v120
    ds_read_b128 v[100:103], v121 offset:2048
    ds_read_b128 v[104:107], v121 offset:3072
    v_smfmac_f32_16x16x64_bf16 v[56:59], v[112:115], a[232:239], v120
    s_waitcnt lgkmcnt(8)
    v_smfmac_f32_16x16x64_bf16 v[68:71], v[112:115], v[84:91], v120
    ds_read_b128 v[84:87], v121 offset:4096
    ds_read_b128 v[88:91], v121 offset:5120
    ds_read_b128 v[24:27], v5 offset:4096
    ds_read_b128 v[28:31], v5 offset:5120
Lq_jn3:
    s_waitcnt lgkmcnt(9)
    v_smfmac_f32_16x16x64_bf16 v[48:51], v[8:11], a[0:7], v120
    v_smfmac_f32_16x16x64_bf16 v[60:63], v[8:11], a[240:247], v120
    v_smfmac_f32_16x16x64_bf16 v[52:55], v[8:11], a[80:87], v120
    v_smfmac_f32_16x16x64_bf16 v[64:67], v[8:11], v[192:199], v120
    v_smfmac_f32_16x16x64_bf16 v[56:59], v[8:11], a[160:167], v120
    v_smfmac_f32_16x16x64_bf16 v[68:71], v[8:11], v[92:99], v120
    ds_read_b128 v[92:95], v121 offset:6144
    ds_read_b128 v[96:99], v121 offset:7168
    ds_read_b128 v[32:35], v5 offset:6144
    s_waitcnt lgkmcnt(11)
    v_smfmac_f32_16x16x64_bf16 v[48:51], v[12:15], a[8:15], v120
    v_smfmac_f32_16x16x64_bf16 v[60:63], v[12:15], a[248:255], v120
    v_smfmac_f32_16x16x64_bf16 v[52:55], v[12:15], a[88:95], v120
    v_smfmac_f32_16x16x64_bf16 v[64:67], v[12:15], v[200:207], v120
    v_smfmac_f32_16x16x64_bf16 v[56:59], v[12:15], a[168:175], v120
    s_waitcnt lgkmcnt(7)
    v_smfmac_f32_16x16x64_bf16 v[68:71], v[12:15], v[100:107], v120
    ds_read_b128 v[100:103], v121 offset:8192
    ds_read_b128 v[104:107], v121 offset:9216
    ds_read_b128 v[36:39], v5 offset:7168
    v_smfmac_f32_16x16x64_bf16 v[48:51], v[16:19], a[16:23], v120
    v_smfmac_f32_16x16x64_bf16 v[60:63], v[16:19], v[128:135], v120
    v_smfmac_f32_16x16x64_bf16 v[52:55], v[16:19], a[96:103], v120
    v_smfmac_f32_16x16x64_bf16 v[64:67], v[16:19], v[208:215], v120
    v_smfmac_f32_16x16x64_bf16 v[56:59], v[16:19], a[176:183], v120
    s_waitcnt lgkmcnt(8)
    v_smfmac_f32_16x16x64_bf16 v[68:71], v[16:19], v[84:91], v120
    ds_read_b128 v[84:87], v121 offset:10240
    ds_read_b128 v[88:91], v121 offset:11264
    v_smfmac_f32_16x16x64_bf16 v[48:51], v[20:23], a[24:31], v120
    v_smfmac_f32_16x16x64_bf16 v[60:63], v[20:23], v[136:143], v120
    v_smfmac_f32_16x16x64_bf16 v[52:55], v[20:23], a[104:111], v120
    v_smfmac_f32_16x16x64_bf16 v[64:67], v[20:23], v[216:223], v120
    v_smfmac_f32_16x16x64_bf16 v[56:59], v[20:23], a[184:191], v120
    s_waitcnt lgkmcnt(6)
    v_smfmac_f32_16x16x64_bf16 v[68:71], v[20:23], v[92:99], v120
    ds_read_b128 v[92:95], v121 offset:12288
    ds_read_b128 v[96:99], v121 offset:13312
    v_smfmac_f32_16x16x64_bf16 v[48:51], v[24:27], a[32:39], v120
    v_smfmac_f32_16x16x64_bf16 v[60:63], v[24:27], v[144:151], v120
    v_smfmac_f32_16x16x64_bf16 v[52:55], v[24:27], a[112:119], v120
    v_smfmac_f32_16x16x64_bf16 v[64:67], v[24:27], v[224:231], v120
    v_smfmac_f32_16x16x64_bf16 v[56:59], v[24:27], a[192:199], v120
    s_waitcnt lgkmcnt(5)
    v_smfmac_f32_16x16x64_bf16 v[68:71], v[24:27], v[100:107], v120
    ds_read_b128 v[100:103], v121 offset:14336
    ds_read_b128 v[104:107], v121 offset:15360
    v_smfmac_f32_16x16x64_bf16 v[48:51], v[28:31], a[40:47], v120
    v_smfmac_f32_16x16x64_bf16 v[60:63], v[28:31], v[152:159], v120
    v_smfmac_f32_16x16x64_bf16 v[52:55], v[28:31], a[120:127], v120
    v_smfmac_f32_16x16x64_bf16 v[64:67], v[28:31], v[232:239], v120
    v_smfmac_f32_16x16x64_bf16 v[56:59], v[28:31], a[200:207], v120
    s_waitcnt lgkmcnt(4)
    v_smfmac_f32_16x16x64_bf16 v[68:71], v[28:31], v[84:91], v120
    v_smfmac_f32_16x16x64_bf16 v[48:51], v[32:35], a[48:55], v120
    v_smfmac_f32_16x16x64_bf16 v[60:63], v[32:35], v[160:167], v120
    v_smfmac_f32_16x16x64_bf16 v[52:55], v[32:35], a[128:135], v120
    v_smfmac_f32_16x16x64_bf16 v[64:67], v[32:35], v[240:247], v120
    v_smfmac_f32_16x16x64_bf16 v[56:59], v[32:35], a[208:215], v120
    s_waitcnt lgkmcnt(2)
    v_smfmac_f32_16x16x64_bf16 v[68:71], v[32:35], v[92:99], v120
    v_smfmac_f32_16x16x64_bf16 v[48:51], v[36:39], a[56:63], v120
    v_smfmac_f32_16x16x64_bf16 v[60:63], v[36:39], v[168:175], v120
    v_smfmac_f32_16x16x64_bf16 v[52:55], v[36:39], a[136:143], v120
    v_smfmac_f32_16x16x64_bf16 v[64:67], v[36:39], v[248:255], v120
    v_smfmac_f32_16x16x64_bf16 v[56:59], v[36:39], a[216:223], v120
    s_waitcnt lgkmcnt(0)
    v_smfmac_f32_16x16x64_bf16 v[68:71], v[36:39], v[100:107], v120
Lq_post:
    s_nop 2
    v_permlane32_swap_b32 v48, v60
    v_permlane32_swap_b32 v49, v61
    v_permlane32_swap_b32 v50, v62
    v_permlane32_swap_b32 v51, v63
    v_pk_add_f32 v[8:9], v[48:49], v[60:61]
    v_pk_add_f32 v[10:11], v[50:51], v[62:63]
    v_cvt_pk_bf16_f32 v20, v8, v9
    v_cvt_pk_bf16_f32 v21, v10, v11
    s_nop 1
    v_mfma_f32_16x16x16_bf16 v[28:31], v[20:21], v[122:123], 0
    v_permlane32_swap_b32 v52, v64
    v_permlane32_swap_b32 v53, v65
    v_permlane32_swap_b32 v54, v66
    v_permlane32_swap_b32 v55, v67
    v_pk_add_f32 v[12:13], v[52:53], v[64:65]
    v_pk_add_f32 v[14:15], v[54:55], v[66:67]
    v_cvt_pk_bf16_f32 v22, v12, v13
    v_cvt_pk_bf16_f32 v23, v14, v15
    s_nop 1
    v_mfma_f32_16x16x16_bf16 v[32:35], v[22:23], v[122:123], 0
    v_permlane32_swap_b32 v56, v68
    v_permlane32_swap_b32 v57, v69
    v_permlane32_swap_b32 v58, v70
    v_permlane32_swap_b32 v59, v71
    v_pk_add_f32 v[16:17], v[56:57], v[68:69]
    v_pk_add_f32 v[18:19], v[58:59], v[70:71]
    v_cvt_pk_bf16_f32 v24, v16, v17
    v_cvt_pk_bf16_f32 v25, v18, v19
    s_nop 1
    v_mfma_f32_16x16x16_bf16 v[36:39], v[24:25], v[122:123], 0
    s_mul_i32 s36, s24, 196608
    s_add_u32 s36, s36, s29
    s_cmp_eq_u32 s24, 63
    v_cvt_pk_bf16_f32 v40, v28, v29
    v_cvt_pk_bf16_f32 v41, v30, v31
    v_cvt_pk_bf16_f32 v42, v32, v33
    v_cvt_pk_bf16_f32 v43, v34, v35
    s_nop 0
    v_cvt_pk_bf16_f32 v44, v36, v37
    v_cvt_pk_bf16_f32 v45, v38, v39
    s_cbranch_scc1 Lq_last
    v_mfma_f32_16x16x32_bf16 v[12:15], v[72:75], v[40:43], 0
    v_mfma_f32_16x16x32_bf16 v[16:19], v[76:79], v[40:43], 0
    v_mfma_f32_16x16x32_bf16 v[8:11], v[40:43], v[40:43], 0
    v_mfma_f32_16x16x16_bf16 v[12:15], v[80:81], v[44:45], v[12:15]
    v_mfma_f32_16x16x16_bf16 v[16:19], v[82:83], v[44:45], v[16:19]
    v_mfma_f32_16x16x16_bf16 v[8:11], v[44:45], v[44:45], v[8:11]
    s_nop 6
    v_mov_b32_dpp v12, v16 row_ror:8 row_mask:0xf bank_mask:0xc
    v_mov_b32_dpp v13, v17 row_ror:8 row_mask:0xf bank_mask:0xc
    v_mov_b32_dpp v14, v18 row_ror:8 row_mask:0xf bank_mask:0xc
    v_mov_b32_dpp v15, v19 row_ror:8 row_mask:0xf bank_mask:0xc
    ds_write_b128 v126, v[12:15] offset:1024
    ds_write_b128 v126, v[8:11]
    s_waitcnt lgkmcnt(0)
    s_barrier
    s_cmp_lg_u32 s20, 0
    s_cbranch_scc1 Lq_rest
    ds_read_b128 v[8:11], v126 offset:0
    ds_read_b128 v[12:15], v126 offset:1024
    ds_read_b128 v[48:51], v126 offset:3072
    ds_read_b128 v[52:55], v126 offset:4096
    ds_read_b128 v[56:59], v126 offset:6144
    ds_read_b128 v[60:63], v126 offset:7168
    ds_read_b128 v[64:67], v126 offset:9216
    ds_read_b128 v[68:71], v126 offset:10240
    v_mov_b32 v3, 0xff800000
    s_waitcnt lgkmcnt(4)
    v_pk_add_f32 v[8:9], v[8:9], v[48:49]
    v_pk_add_f32 v[10:11], v[10:11], v[50:51]
    v_pk_add_f32 v[12:13], v[12:13], v[52:53]
    v_pk_add_f32 v[14:15], v[14:15], v[54:55]
    s_waitcnt lgkmcnt(0)
    v_pk_add_f32 v[56:57], v[56:57], v[64:65]
    v_pk_add_f32 v[58:59], v[58:59], v[66:67]
    v_pk_add_f32 v[60:61], v[60:61], v[68:69]
    v_pk_add_f32 v[62:63], v[62:63], v[70:71]
    v_pk_add_f32 v[8:9], v[8:9], v[56:57]
    v_pk_add_f32 v[10:11], v[10:11], v[58:59]
    v_pk_add_f32 v[12:13], v[12:13], v[60:61]
    v_pk_add_f32 v[14:15], v[14:15], v[62:63]
    s_mov_b32 exec_lo, 0xffffffff
    s_mov_b32 exec_hi, 0xff00ff00
    v_mov_b32 v8, v3
    v_mov_b32 v9, v3
    v_mov_b32 v10, v3
    v_mov_b32 v11, v3
    s_mov_b64 exec, -1
    v_max3_f32 v60, v8, v9, v10
    v_max3_f32 v61, v11, v12, v13
    v_max3_f32 v60, v60, v14, v15
    v_max_f32 v60, v60, v61
    s_nop 1
    v_max_f32_dpp v60, v60, v60 row_ror:8 row_mask:0xf bank_mask:0xf
    v_mov_b32 v61, v60
    s_nop 1
    v_permlane16_swap_b32 v60, v61
    v_max_f32 v60, v60, v61
    v_mov_b32 v61, v60
    s_nop 1
    v_permlane32_swap_b32 v60, v61
    v_max_f32 v60, v60, v61
    v_mul_f32 v60, s40, v60
    v_pk_fma_f32 v[8:9], v[8:9], s[40:41], v[60:61] op_sel_hi:[1,1,0] neg_lo:[0,0,1] neg_hi:[0,0,1]
    v_pk_fma_f32 v[10:11], v[10:11], s[40:41], v[60:61] op_sel_hi:[1,1,0] neg_lo:[0,0,1] neg_hi:[0,0,1]
    v_pk_fma_f32 v[12:13], v[12:13], s[40:41], v[60:61] op_sel_hi:[1,1,0] neg_lo:[0,0,1] neg_hi:[0,0,1]
    v_pk_fma_f32 v[14:15], v[14:15], s[40:41], v[60:61] op_sel_hi:[1,1,0] neg_lo:[0,0,1] neg_hi:[0,0,1]
    v_exp_f32 v8, v8
    v_exp_f32 v9, v9
    v_exp_f32 v10, v10
    v_exp_f32 v11, v11
    v_exp_f32 v12, v12
    v_exp_f32 v13, v13
    v_exp_f32 v14, v14
    v_exp_f32 v15, v15
    v_pk_add_f32 v[62:63], v[8:9], v[10:11]
    v_pk_add_f32 v[64:65], v[12:13], v[14:15]
    v_pk_add_f32 v[62:63], v[62:63], v[64:65]
    v_add_f32 v60, v62, v63
    s_nop 1
    v_add_f32_dpp v60, v60, v60 row_ror:8 row_mask:0xf bank_mask:0xf
    v_mov_b32 v61, v60
    s_nop 1
    v_permlane16_swap_b32 v60, v61
    v_add_f32 v60, v60, v61
    v_mov_b32 v61, v60
    s_nop 1
    v_permlane32_swap_b32 v60, v61
    v_add_f32 v60, v60, v61
    v_rcp_f32 v60, v60
    s_nop 0
    v_pk_mul_f32 v[8:9], v[8:9], v[60:61] op_sel_hi:[1,0]
    v_pk_mul_f32 v[10:11], v[10:11], v[60:61] op_sel_hi:[1,0]
    v_pk_mul_f32 v[12:13], v[12:13], v[60:61] op_sel_hi:[1,0]
    v_pk_mul_f32 v[14:15], v[14:15], v[60:61] op_sel_hi:[1,0]
    v_cvt_pk_bf16_f32 v24, v12, v13
    v_cvt_pk_bf16_f32 v25, v14, v15
    v_cvt_pk_bf16_f32 v26, v8, v9
    v_cvt_pk_bf16_f32 v27, v10, v11
    v_min_u32 v24, -2, v24
    v_min_u32 v25, -2, v25
    v_min_u32 v26, -2, v26
    v_min_u32 v27, -2, v27
    s_mul_i32 s37, s24, 20480
    s_add_u32 s37, s37, s30
    s_cmp_lg_u32 s23, 0
    s_cbranch_scc1 Lsm_37
    buffer_store_dwordx2 v[24:25], v127, s[4:7], s37 offen
    s_branch Lsm_38
Lsm_37:
    buffer_store_dwordx2 v[24:25], v127, s[4:7], s37 offen sc1
Lsm_38:
    s_mov_b32 exec_lo, 0x0
    s_mov_b32 exec_hi, 0xff00ff
    s_cmp_lg_u32 s23, 0
    s_cbranch_scc1 Lsm_39
    buffer_store_dwordx2 v[26:27], v7, s[4:7], s37 offen
    s_branch Lsm_40
Lsm_39:
    buffer_store_dwordx2 v[26:27], v7, s[4:7], s37 offen sc1
Lsm_40:
    s_mov_b64 exec, -1
Lq_rest:
    s_mov_b32 exec_lo, 0xff00ff00
    s_mov_b32 exec_hi, 0xff00ff00
    buffer_store_dwordx4 v[40:43], v2, s[4:7], s36 offen sc1
    v_lshlrev_b32 v3, 3, v1
    buffer_store_dwordx2 v[44:45], v3, s[4:7], s36 offen offset:1024 sc1
    s_mov_b64 exec, -1
Lq_next:
    s_add_u32 s35, s24, 1
    s_min_u32 s35, s35, 63
    s_add_u32 s37, s35, 1
    v_cmp_gt_u32 vcc, s37, v125
    s_cbranch_vccz Lck_41
Lw_42:
    buffer_load_dword v125, v124, s[4:7], s31 offen sc1
    s_waitcnt vmcnt(0)
    v_cmp_gt_u32 vcc, s37, v125
    s_cbranch_vccz Lwd_43
    s_sub_u32 s101, s101, 1
    s_cbranch_scc1 L_abort
    s_sleep 2
    s_branch Lw_42
Lwd_43:
Lck_41:
    s_mul_i32 s36, s35, 393216
    s_add_u32 s36, s36, s28
    buffer_load_dwordx4 v[72:75], v2, s[4:7], s36 offen offset:0 sc1
    buffer_load_dwordx4 v[76:79], v2, s[4:7], s36 offen offset:1024 sc1
    buffer_load_dwordx4 v[80:83], v2, s[4:7], s36 offen offset:2048 sc1
    buffer_load_dword v125, v124, s[4:7], s31 offen sc1
    s_waitcnt vmcnt(4)
    s_barrier
    s_cmp_eq_u32 s20, 0
    s_cbranch_scc1 Lq_nt_44
    s_add_u32 s35, s24, 2
    s_cmp_gt_u32 s35, 63
    s_cbranch_scc1 Lq_nt_44
    v_cmp_gt_u32 vcc, s35, v4
    s_cbranch_vccnz Lq_nt_44s
    s_sub_u32 s35, s35, 1
    s_mul_i32 s36, s35, 1310720
    s_add_u32 s36, s36, s42
    s_sub_u32 s26, s20, 1
    s_lshl_b32 s26, s26, 7
    s_add_u32 s26, s26, 0
    v_add_u32 v3, s26, v1
    v_min_u32 v3, 319, v3
    v_lshlrev_b32 v3, 7, v3
    buffer_load_dword v8, v3, s[4:7], s36 offen sc1
    s_sub_u32 s26, s20, 1
    s_lshl_b32 s26, s26, 7
    s_add_u32 s26, s26, 64
    v_add_u32 v3, s26, v1
    v_min_u32 v3, 319, v3
    v_lshlrev_b32 v3, 7, v3
    buffer_load_dword v8, v3, s[4:7], s36 offen sc1
Lq_nt_44s:
    buffer_load_dword v4, v124, s[4:7], s43 offen sc1
Lq_nt_44:
    s_cmp_lg_u32 s20, 3
    s_cbranch_scc1 Lq_nf_45
    s_add_u32 s26, s24, 1
    v_mov_b32 v6, s26
    s_mov_b64 exec, 1
    buffer_store_dword v6, v124, s[4:7], s33 offen sc1
    s_mov_b64 exec, -1
Lq_nf_45:
    s_sleep 24
    s_add_u32 s24, s24, 1
    s_branch Lq_loop
Lq_last:
    s_mov_b32 exec_lo, 0xff00ff00
    s_mov_b32 exec_hi, 0xff00ff00
    buffer_store_dwordx4 v[40:43], v2, s[4:7], s36 offen sc1
    v_lshlrev_b32 v3, 3, v1
    buffer_store_dwordx2 v[44:45], v3, s[4:7], s36 offen offset:1024 sc1
    s_mov_b64 exec, -1
    s_waitcnt vmcnt(0)
    s_barrier
    s_cmp_lg_u32 s20, 3
    s_cbranch_scc1 L_exit
    v_mov_b32 v6, 64
    s_mov_b64 exec, 1
    buffer_store_dword v6, v124, s[4:7], s33 offen sc1
    s_branch L_exit
Ld_b:
    v_mov_b32 v4, 4
Lwi_46:
    buffer_load_dword v5, v4, s[88:91], 0 offen sc1
    s_waitcnt vmcnt(0)
    v_cmp_gt_u32 vcc, 224, v5
    s_cbranch_vccz Lwid_47
    s_sub_u32 s101, s101, 1
    s_cbranch_scc1 L_abort
    s_sleep 8
    s_branch Lwi_46
Lwid_47:
    v_and_b32 v4, 7, v1
    v_lshlrev_b32 v4, 5, v4
Lac_48:
    buffer_load_dword v6, v4, s[88:91], 0 offen sc1
    s_waitcnt vmcnt(0)
    v_readlane_b32 s32, v6, 0
    v_readlane_b32 s33, v6, 1
    v_readlane_b32 s34, v6, 2
    v_readlane_b32 s35, v6, 3
    v_readlane_b32 s36, v6, 4
    v_readlane_b32 s37, v6, 5
    v_readlane_b32 s38, v6, 6
    v_readlane_b32 s39, v6, 7
    s_add_u32 s26, s32, s33
    s_add_u32 s26, s26, s34
    s_add_u32 s26, s26, s35
    s_add_u32 s26, s26, s36
    s_add_u32 s26, s26, s37
    s_add_u32 s26, s26, s38
    s_add_u32 s26, s26, s39
    s_cmp_ge_u32 s26, 256
    s_cbranch_scc1 Lacd_49
    s_sub_u32 s101, s101, 1
    s_cbranch_scc1 L_abort
    s_sleep 8
    s_branch Lac_48
Lacd_49:
    s_min_u32 s26, s32, s33
    s_min_u32 s26, s26, s34
    s_min_u32 s26, s26, s35
    s_cmp_lt_u32 s26, 28
    s_cselect_b32 s23, 1, 0
    s_mul_i32 s26, s22, 20
    s_add_u32 s26, s26, s21
    s_lshl_b32 s26, s26, 2
    s_add_u32 s26, s26, s20
    s_mul_i32 s28, s26, 81920
    s_add_u32 s28, s28, 0xc500000
    s_lshl_b32 s29, s22, 3
    s_lshl_b32 s26, s20, 1
    s_add_u32 s29, s29, s26
    s_lshl_b32 s29, s29, 5
    s_cmp_ge_u32 s21, 10
    s_cselect_b32 s26, 4, 0
    s_add_u32 s29, s29, s26
    s_add_u32 s29, s29, 45056
    v_and_b32 v5, 1, v1
    v_lshlrev_b32 v5, 5, v5
    v_bfe_u32 v6, v1, 1, 2
    v_lshl_add_u32 v5, v6, 3, v5
    buffer_load_dword v6, v5, s[4:7], s29 offen sc1
    s_waitcnt vmcnt(0)
Lbl_50:
    v_cmp_gt_u32 vcc, 1, v6
    s_and_b64 vcc, vcc, 0xc0
    s_cbranch_vccz Lbl_51
    s_sub_u32 s101, s101, 1
    s_cbranch_scc1 L_abort
    s_sleep 4
    buffer_load_dword v6, v5, s[4:7], s29 offen sc1
    s_waitcnt vmcnt(0)
    s_branch Lbl_50
Lbl_51:
    s_add_u32 s26, s28, 58368
    buffer_load_dwordx4 a[228:231], v2, s[4:7], s26 offen offset:0 sc1
    buffer_load_dwordx4 a[236:239], v2, s[4:7], s26 offen offset:2048 sc1
    s_add_u32 s26, s26, 4096
    buffer_load_dwordx4 a[244:247], v2, s[4:7], s26 offen offset:0 sc1
    buffer_load_dwordx4 a[252:255], v2, s[4:7], s26 offen offset:2048 sc1
    s_add_u32 s26, s28, 65536
    buffer_load_dwordx4 v[192:195], v2, s[4:7], s26 offen offset:0 sc1
    buffer_load_dwordx4 v[200:203], v2, s[4:7], s26 offen offset:2048 sc1
    s_add_u32 s26, s26, 4096
    buffer_load_dwordx4 v[208:211], v2, s[4:7], s26 offen offset:0 sc1
    buffer_load_dwordx4 v[216:219], v2, s[4:7], s26 offen offset:2048 sc1
    s_add_u32 s26, s28, 66560
    buffer_load_dwordx4 v[196:199], v2, s[4:7], s26 offen offset:0 sc1
    buffer_load_dwordx4 v[204:207], v2, s[4:7], s26 offen offset:2048 sc1
    s_add_u32 s26, s26, 4096
    buffer_load_dwordx4 v[212:215], v2, s[4:7], s26 offen offset:0 sc1
    buffer_load_dwordx4 v[220:223], v2, s[4:7], s26 offen offset:2048 sc1
    s_add_u32 s26, s28, 73728
    buffer_load_dwordx4 v[224:227], v2, s[4:7], s26 offen offset:0 sc1
    buffer_load_dwordx4 v[232:235], v2, s[4:7], s26 offen offset:2048 sc1
    s_add_u32 s26, s26, 4096
    buffer_load_dwordx4 v[240:243], v2, s[4:7], s26 offen offset:0 sc1
    buffer_load_dwordx4 v[248:251], v2, s[4:7], s26 offen offset:2048 sc1
    s_add_u32 s26, s28, 74752
    buffer_load_dwordx4 v[228:231], v2, s[4:7], s26 offen offset:0 sc1
    buffer_load_dwordx4 v[236:239], v2, s[4:7], s26 offen offset:2048 sc1
    s_add_u32 s26, s26, 4096
    buffer_load_dwordx4 v[244:247], v2, s[4:7], s26 offen offset:0 sc1
    buffer_load_dwordx4 v[252:255], v2, s[4:7], s26 offen offset:2048 sc1
Lbl_52:
    v_cmp_gt_u32 vcc, 1, v6
    s_and_b64 vcc, vcc, 0x3
    s_cbranch_vccz Lbl_53
    s_sub_u32 s101, s101, 1
    s_cbranch_scc1 L_abort
    s_sleep 4
    buffer_load_dword v6, v5, s[4:7], s29 offen sc1
    s_waitcnt vmcnt(0)
    s_branch Lbl_52
Lbl_53:
    s_add_u32 s26, s28, 0
    buffer_load_dwordx4 a[0:3], v2, s[4:7], s26 offen offset:0 sc1
    buffer_load_dwordx4 a[8:11], v2, s[4:7], s26 offen offset:2048 sc1
    s_add_u32 s26, s26, 4096
    buffer_load_dwordx4 a[16:19], v2, s[4:7], s26 offen offset:0 sc1
    buffer_load_dwordx4 a[24:27], v2, s[4:7], s26 offen offset:2048 sc1
    s_add_u32 s26, s28, 1024
    buffer_load_dwordx4 a[4:7], v2, s[4:7], s26 offen offset:0 sc1
    buffer_load_dwordx4 a[12:15], v2, s[4:7], s26 offen offset:2048 sc1
    s_add_u32 s26, s26, 4096
    buffer_load_dwordx4 a[20:23], v2, s[4:7], s26 offen offset:0 sc1
    buffer_load_dwordx4 a[28:31], v2, s[4:7], s26 offen offset:2048 sc1
    s_add_u32 s26, s28, 8192
    buffer_load_dwordx4 a[32:35], v2, s[4:7], s26 offen offset:0 sc1
    buffer_load_dwordx4 a[40:43], v2, s[4:7], s26 offen offset:2048 sc1
    s_add_u32 s26, s26, 4096
    buffer_load_dwordx4 a[48:51], v2, s[4:7], s26 offen offset:0 sc1
    buffer_load_dwordx4 a[56:59], v2, s[4:7], s26 offen offset:2048 sc1
    s_add_u32 s26, s28, 9216
    buffer_load_dwordx4 a[36:39], v2, s[4:7], s26 offen offset:0 sc1
    buffer_load_dwordx4 a[44:47], v2, s[4:7], s26 offen offset:2048 sc1
    s_add_u32 s26, s26, 4096
    buffer_load_dwordx4 a[52:55], v2, s[4:7], s26 offen offset:0 sc1
    buffer_load_dwordx4 a[60:63], v2, s[4:7], s26 offen offset:2048 sc1
    s_add_u32 s26, s28, 16384
    buffer_load_dwordx4 a[64:67], v2, s[4:7], s26 offen offset:0 sc1
    buffer_load_dwordx4 a[72:75], v2, s[4:7], s26 offen offset:2048 sc1
    s_add_u32 s26, s26, 4096
    buffer_load_dwordx4 a[80:83], v2, s[4:7], s26 offen offset:0 sc1
    buffer_load_dwordx4 a[88:91], v2, s[4:7], s26 offen offset:2048 sc1
Lbl_54:
    v_cmp_gt_u32 vcc, 1, v6
    s_and_b64 vcc, vcc, 0xc
    s_cbranch_vccz Lbl_55
    s_sub_u32 s101, s101, 1
    s_cbranch_scc1 L_abort
    s_sleep 4
    buffer_load_dword v6, v5, s[4:7], s29 offen sc1
    s_waitcnt vmcnt(0)
    s_branch Lbl_54
Lbl_55:
    s_add_u32 s26, s28, 17408
    buffer_load_dwordx4 a[68:71], v2, s[4:7], s26 offen offset:0 sc1
    buffer_load_dwordx4 a[76:79], v2, s[4:7], s26 offen offset:2048 sc1
    s_add_u32 s26, s26, 4096
    buffer_load_dwordx4 a[84:87], v2, s[4:7], s26 offen offset:0 sc1
    buffer_load_dwordx4 a[92:95], v2, s[4:7], s26 offen offset:2048 sc1
    s_add_u32 s26, s28, 24576
    buffer_load_dwordx4 a[96:99], v2, s[4:7], s26 offen offset:0 sc1
    buffer_load_dwordx4 a[104:107], v2, s[4:7], s26 offen offset:2048 sc1
    s_add_u32 s26, s26, 4096
    buffer_load_dwordx4 a[112:115], v2, s[4:7], s26 offen offset:0 sc1
    buffer_load_dwordx4 a[120:123], v2, s[4:7], s26 offen offset:2048 sc1
    s_add_u32 s26, s28, 25600
    buffer_load_dwordx4 a[100:103], v2, s[4:7], s26 offen offset:0 sc1
    buffer_load_dwordx4 a[108:111], v2, s[4:7], s26 offen offset:2048 sc1
    s_add_u32 s26, s26, 4096
    buffer_load_dwordx4 a[116:119], v2, s[4:7], s26 offen offset:0 sc1
    buffer_load_dwordx4 a[124:127], v2, s[4:7], s26 offen offset:2048 sc1
    s_add_u32 s26, s28, 32768
    buffer_load_dwordx4 a[128:131], v2, s[4:7], s26 offen offset:0 sc1
    buffer_load_dwordx4 a[136:139], v2, s[4:7], s26 offen offset:2048 sc1
    s_add_u32 s26, s26, 4096
    buffer_load_dwordx4 a[144:147], v2, s[4:7], s26 offen offset:0 sc1
    buffer_load_dwordx4 a[152:155], v2, s[4:7], s26 offen offset:2048 sc1
    s_add_u32 s26, s28, 33792
    buffer_load_dwordx4 a[132:135], v2, s[4:7], s26 offen offset:0 sc1
    buffer_load_dwordx4 a[140:143], v2, s[4:7], s26 offen offset:2048 sc1
    s_add_u32 s26, s26, 4096
    buffer_load_dwordx4 a[148:151], v2, s[4:7], s26 offen offset:0 sc1
    buffer_load_dwordx4 a[156:159], v2, s[4:7], s26 offen offset:2048 sc1
Lbl_56:
    v_cmp_gt_u32 vcc, 1, v6
    s_and_b64 vcc, vcc, 0x30
    s_cbranch_vccz Lbl_57
    s_sub_u32 s101, s101, 1
    s_cbranch_scc1 L_abort
    s_sleep 4
    buffer_load_dword v6, v5, s[4:7], s29 offen sc1
    s_waitcnt vmcnt(0)
    s_branch Lbl_56
Lbl_57:
    s_add_u32 s26, s28, 40960
    buffer_load_dwordx4 a[160:163], v2, s[4:7], s26 offen offset:0 sc1
    buffer_load_dwordx4 a[168:171], v2, s[4:7], s26 offen offset:2048 sc1
    s_add_u32 s26, s26, 4096
    buffer_load_dwordx4 a[176:179], v2, s[4:7], s26 offen offset:0 sc1
    buffer_load_dwordx4 a[184:187], v2, s[4:7], s26 offen offset:2048 sc1
    s_add_u32 s26, s28, 41984
    buffer_load_dwordx4 a[164:167], v2, s[4:7], s26 offen offset:0 sc1
    buffer_load_dwordx4 a[172:175], v2, s[4:7], s26 offen offset:2048 sc1
    s_add_u32 s26, s26, 4096
    buffer_load_dwordx4 a[180:183], v2, s[4:7], s26 offen offset:0 sc1
    buffer_load_dwordx4 a[188:191], v2, s[4:7], s26 offen offset:2048 sc1
    s_add_u32 s26, s28, 49152
    buffer_load_dwordx4 a[192:195], v2, s[4:7], s26 offen offset:0 sc1
    buffer_load_dwordx4 a[200:203], v2, s[4:7], s26 offen offset:2048 sc1
    s_add_u32 s26, s26, 4096
    buffer_load_dwordx4 a[208:211], v2, s[4:7], s26 offen offset:0 sc1
    buffer_load_dwordx4 a[216:219], v2, s[4:7], s26 offen offset:2048 sc1
    s_add_u32 s26, s28, 50176
    buffer_load_dwordx4 a[196:199], v2, s[4:7], s26 offen offset:0 sc1
    buffer_load_dwordx4 a[204:207], v2, s[4:7], s26 offen offset:2048 sc1
    s_add_u32 s26, s26, 4096
    buffer_load_dwordx4 a[212:215], v2, s[4:7], s26 offen offset:0 sc1
    buffer_load_dwordx4 a[220:223], v2, s[4:7], s26 offen offset:2048 sc1
    s_add_u32 s26, s28, 57344
    buffer_load_dwordx4 a[224:227], v2, s[4:7], s26 offen offset:0 sc1
    buffer_load_dwordx4 a[232:235], v2, s[4:7], s26 offen offset:2048 sc1
    s_add_u32 s26, s26, 4096
    buffer_load_dwordx4 a[240:243], v2, s[4:7], s26 offen offset:0 sc1
    buffer_load_dwordx4 a[248:251], v2, s[4:7], s26 offen offset:2048 sc1
    s_waitcnt vmcnt(0)
    v_and_b32 v3, 15, v1
    v_lshrrev_b32 v4, 4, v1
    v_mov_b32 v148, 0x4444
    v_mov_b32 v5, 0xeeee
    v_cmp_le_u32 vcc, 8, v3
    s_nop 1
    v_cndmask_b32 v148, v148, v5, vcc
    v_lshlrev_b32 v5, 2, v4
    v_sub_u32 v5, v3, v5
    v_mov_b32 v150, 0
    v_mov_b32 v151, 0
    v_mov_b32 v6, 0x3f80
    v_cmp_eq_u32 vcc, 0, v5
    s_nop 1
    v_cndmask_b32 v150, v150, v6, vcc
    v_mov_b32 v6, 0x3f800000
    v_cmp_eq_u32 vcc, 1, v5
    s_nop 1
    v_cndmask_b32 v150, v150, v6, vcc
    v_mov_b32 v6, 0x3f80
    v_cmp_eq_u32 vcc, 2, v5
    s_nop 1
    v_cndmask_b32 v151, v151, v6, vcc
    v_mov_b32 v6, 0x3f800000
    v_cmp_eq_u32 vcc, 3, v5
    s_nop 1
    v_cndmask_b32 v151, v151, v6, vcc
    v_mov_b32 v156, 0
    v_mov_b32 v157, 0
    v_mov_b32 v92, 0
    v_mov_b32 v172, 0
    v_mov_b32 v93, 0
    v_mov_b32 v173, 0
    v_mov_b32 v94, 0
    v_mov_b32 v174, 0
    v_mov_b32 v95, 0
    v_mov_b32 v175, 0
    s_cmp_eq_u32 s20, 2
    s_cselect_b32 s26, 4096, 0
    s_cmp_eq_u32 s20, 3
    s_cselect_b32 s26, 7168, s26
    v_add_u32 v152, s26, v2
    s_cmp_eq_u32 s20, 0
    s_cselect_b32 s28, 3072, s26
    v_add_u32 v153, s28, v2
    s_lshr_b32 s26, s26, 7
    v_min_u32 v3, 31, v1
    v_add_u32 v3, s26, v3
    v_min_u32 v3, 79, v3
    v_lshlrev_b32 v163, 7, v3
    s_lshl_b32 s27, s22, 3
    s_lshl_b32 s26, s20, 1
    s_add_u32 s27, s27, s26
    v_and_b32 v3, 15, v1
    v_lshrrev_b32 v4, 4, v1
    v_lshrrev_b32 v5, 1, v4
    v_lshlrev_b32 v5, 9, v5
    v_and_b32 v6, 1, v4
    v_lshl_add_u32 v5, v6, 7, v5
    v_lshrrev_b32 v6, 3, v3
    v_lshl_add_u32 v5, v6, 8, v5
    v_and_b32 v6, 7, v3
    v_lshl_add_u32 v154, v6, 4, v5
    v_and_b32 v5, 1, v4
    v_lshlrev_b32 v5, 7, v5
    v_lshl_add_u32 v5, v6, 4, v5
    v_add_u32 v155, 1024, v5
    s_lshr_b32 s30, s27, 1
    s_mul_i32 s30, s30, 1280
    s_add_u32 s30, s30, 0x380000
    v_and_b32 v5, 1, v1
    v_add_u32 v5, s27, v5
    v_lshlrev_b32 v5, 7, v5
    v_add_u32 v158, 8192, v5
    s_mul_i32 s29, s27, 40960
    s_lshl_b32 s26, s21, 11
    s_add_u32 s29, s29, s26
    s_add_u32 s29, s29, 0x7400000
    s_lshl_b32 s26, s20, 10
    s_add_u32 s26, s26, 86016
    v_add_u32 v159, s26, v2
    s_lshl_b32 s26, s22, 10
    v_add_u32 v160, s26, v2
    s_xor_b32 s26, s22, 1
    s_lshl_b32 s26, s26, 10
    v_add_u32 v165, s26, v2
    s_xor_b32 s26, s22, 2
    s_lshl_b32 s26, s26, 10
    v_add_u32 v166, s26, v2
    s_xor_b32 s26, s22, 3
    s_lshl_b32 s26, s26, 10
    v_add_u32 v167, s26, v2
    s_mul_i32 s31, s21, 4096
    s_add_u32 s31, s31, 0x4c0000
    v_mov_b32 v140, -1
    v_mov_b32 v141, -1
    v_mov_b32 v142, -1
    v_mov_b32 v143, -1
    v_lshlrev_b32 v5, 7, v4
    v_and_b32 v6, 7, v3
    v_lshl_add_u32 v5, v6, 4, v5
    s_lshl_b32 s26, s21, 9
    v_add_u32 v161, s26, v5
    s_mul_i32 s33, s22, 10240
    s_add_u32 s33, s33, 0x100000
    v_lshrrev_b32 v5, 1, v4
    v_lshlrev_b32 v5, 10, v5
    v_and_b32 v6, 1, v4
    v_lshl_add_u32 v5, v6, 8, v5
    v_lshl_add_u32 v5, v3, 4, v5
    s_lshr_b32 s26, s27, 2
    s_mul_i32 s26, s26, 40960
    s_lshl_b32 s28, s21, 11
    s_add_u32 s26, s26, s28
    s_and_b32 s28, s20, 1
    s_lshl_b32 s28, s28, 9
    s_add_u32 s26, s26, s28
    s_add_u32 s26, s26, 0x2d00000
    v_add_u32 v162, s26, v5
    s_mul_i32 s26, s22, 20
    s_add_u32 s26, s26, s21
    s_lshl_b32 s26, s26, 7
    s_add_u32 s41, s26, 20480
    s_mov_b32 s24, 0
Lb_loop:
    v_mov_b32 v48, 0
    v_mov_b32 v49, 0
    v_mov_b32 v50, 0
    v_mov_b32 v51, 0
    v_mov_b32 v52, 0
    v_mov_b32 v53, 0
    v_mov_b32 v54, 0
    v_mov_b32 v55, 0
    v_mov_b32 v56, 0
    v_mov_b32 v57, 0
    v_mov_b32 v58, 0
    v_mov_b32 v59, 0
    v_mov_b32 v60, 0
    v_mov_b32 v61, 0
    v_mov_b32 v62, 0
    v_mov_b32 v63, 0
    s_mul_i32 s34, s24, 40960
    s_add_u32 s34, s34, s33
    s_and_b32 s26, s24, 1
    s_mul_i32 s26, s26, 10240
    s_add_u32 s26, s26, 65536
    v_add_u32 v5, s26, v2
    s_cmp_eq_u32 s20, 1
    s_cbranch_scc1 Lb_bar
    v_add_u32 v3, s26, v152
    v_add_u32 v4, s26, v153
Lb_poll:
    buffer_load_dwordx4 v[104:107], v152, s[4:7], s34 offen offset:0 sc1
    buffer_load_dwordx4 v[108:111], v152, s[4:7], s34 offen offset:1024 sc1
    buffer_load_dwordx4 v[112:115], v152, s[4:7], s34 offen offset:2048 sc1
    buffer_load_dwordx4 v[116:119], v153, s[4:7], s34 offen sc1
    s_waitcnt vmcnt(0)
    v_max3_u32 v6, v104, v105, v106
    v_max3_u32 v6, v6, v107, v108
    v_max3_u32 v6, v6, v109, v110
    v_max3_u32 v6, v6, v111, v112
    v_max3_u32 v6, v6, v113, v114
    v_max3_u32 v6, v6, v115, v116
    v_max3_u32 v6, v6, v117, v118
    v_max_u32 v6, v6, v119
    v_cmp_eq_u32 vcc, -1, v6
    s_cbranch_vccz Lpd_58
    s_sub_u32 s101, s101, 1
    s_cbranch_scc1 L_abort
    s_branch Lb_poll
Lpd_58:
    ds_write_b128 v3, v[104:107] offset:0
    ds_write_b128 v3, v[108:111] offset:1024
    ds_write_b128 v3, v[112:115] offset:2048
    ds_write_b128 v4, v[116:119]
    s_waitcnt lgkmcnt(0)
Lb_bar:
    s_barrier
    ds_read_b128 v[8:11], v5 offset:0
    ds_read_b128 v[12:15], v5 offset:1024
    ds_read_b128 v[16:19], v5 offset:2048
    ds_read_b128 v[20:23], v5 offset:3072
    ds_read_b128 v[24:27], v5 offset:4096
    ds_read_b128 v[28:31], v5 offset:5120
    ds_read_b128 v[32:35], v5 offset:6144
    ds_read_b128 v[36:39], v5 offset:7168
    ds_read_b128 v[40:43], v5 offset:8192
    ds_read_b128 v[44:47], v5 offset:9216
    s_cmp_lg_u32 s20, 2
    s_cbranch_scc1 Lb_nf_59
    v_mov_b32 v6, s24
    s_mov_b64 exec, 1
    buffer_store_dword v6, v156, s[4:7], s41 offen sc1
    s_mov_b64 exec, -1
Lb_nf_59:
    s_cmp_eq_u32 s24, 63
    s_cbranch_scc1 Lb_nu_60
    s_add_u32 s37, s24, 1
    v_cmp_gt_u32 vcc, s37, v157
    s_cbranch_vccz Lck_61
Lw_62:
    buffer_load_dword v157, v158, s[4:7], 0 offen sc1
    s_waitcnt vmcnt(0)
    v_cmp_gt_u32 vcc, s37, v157
    s_cbranch_vccz Lwd_63
    s_sub_u32 s101, s101, 1
    s_cbranch_scc1 L_abort
    s_sleep 2
    s_branch Lw_62
Lwd_63:
Lck_61:
    s_mul_i32 s36, s24, 1310720
    s_add_u32 s36, s36, s29
    s_add_u32 s37, s36, 40960
    buffer_load_dwordx4 v[64:67], v2, s[4:7], s36 offen offset:0 sc1
    buffer_load_dwordx4 v[68:71], v2, s[4:7], s37 offen offset:0 sc1
    buffer_load_dwordx4 v[72:75], v2, s[4:7], s36 offen offset:1024 sc1
    buffer_load_dwordx4 v[76:79], v2, s[4:7], s37 offen offset:1024 sc1
    buffer_load_dword v157, v158, s[4:7], 0 offen sc1
    s_mul_i32 s36, s24, 20480
    s_add_u32 s36, s36, s30
    buffer_load_dword v7, v154, s[4:7], s36 offen sc1
    buffer_load_dword v7, v155, s[4:7], s36 offen sc1
Lb_nu_60:
    s_waitcnt lgkmcnt(9)
    v_smfmac_f32_16x16x64_bf16 v[48:51], v[8:11], a[0:7], v148
    v_smfmac_f32_16x16x64_bf16 v[52:55], v[8:11], a[8:15], v148
    v_smfmac_f32_16x16x64_bf16 v[56:59], v[8:11], a[16:23], v148
    v_smfmac_f32_16x16x64_bf16 v[60:63], v[8:11], a[24:31], v148
    s_waitcnt lgkmcnt(8)
    v_smfmac_f32_16x16x64_bf16 v[48:51], v[12:15], a[32:39], v148
    v_smfmac_f32_16x16x64_bf16 v[52:55], v[12:15], a[40:47], v148
    v_smfmac_f32_16x16x64_bf16 v[56:59], v[12:15], a[48:55], v148
    v_smfmac_f32_16x16x64_bf16 v[60:63], v[12:15], a[56:63], v148
    s_waitcnt lgkmcnt(7)
    v_smfmac_f32_16x16x64_bf16 v[48:51], v[16:19], a[64:71], v148
    v_smfmac_f32_16x16x64_bf16 v[52:55], v[16:19], a[72:79], v148
    v_smfmac_f32_16x16x64_bf16 v[56:59], v[16:19], a[80:87], v148
    v_smfmac_f32_16x16x64_bf16 v[60:63], v[16:19], a[88:95], v148
    s_waitcnt lgkmcnt(6)
    v_smfmac_f32_16x16x64_bf16 v[48:51], v[20:23], a[96:103], v148
    v_smfmac_f32_16x16x64_bf16 v[52:55], v[20:23], a[104:111], v148
    v_smfmac_f32_16x16x64_bf16 v[56:59], v[20:23], a[112:119], v148
    v_smfmac_f32_16x16x64_bf16 v[60:63], v[20:23], a[120:127], v148
    s_waitcnt lgkmcnt(5)
    v_smfmac_f32_16x16x64_bf16 v[48:51], v[24:27], a[128:135], v148
    v_smfmac_f32_16x16x64_bf16 v[52:55], v[24:27], a[136:143], v148
    v_smfmac_f32_16x16x64_bf16 v[56:59], v[24:27], a[144:151], v148
    v_smfmac_f32_16x16x64_bf16 v[60:63], v[24:27], a[152:159], v148
    s_waitcnt lgkmcnt(4)
    v_smfmac_f32_16x16x64_bf16 v[48:51], v[28:31], a[160:167], v148
    v_smfmac_f32_16x16x64_bf16 v[52:55], v[28:31], a[168:175], v148
    v_smfmac_f32_16x16x64_bf16 v[56:59], v[28:31], a[176:183], v148
    v_smfmac_f32_16x16x64_bf16 v[60:63], v[28:31], a[184:191], v148
    s_waitcnt lgkmcnt(3)
    v_smfmac_f32_16x16x64_bf16 v[48:51], v[32:35], a[192:199], v148
    v_smfmac_f32_16x16x64_bf16 v[52:55], v[32:35], a[200:207], v148
    v_smfmac_f32_16x16x64_bf16 v[56:59], v[32:35], a[208:215], v148
    v_smfmac_f32_16x16x64_bf16 v[60:63], v[32:35], a[216:223], v148
    s_waitcnt lgkmcnt(2)
    v_smfmac_f32_16x16x64_bf16 v[48:51], v[36:39], a[224:231], v148
    v_smfmac_f32_16x16x64_bf16 v[52:55], v[36:39], a[232:239], v148
    v_smfmac_f32_16x16x64_bf16 v[56:59], v[36:39], a[240:247], v148
    v_smfmac_f32_16x16x64_bf16 v[60:63], v[36:39], a[248:255], v148
    s_waitcnt lgkmcnt(1)
    v_smfmac_f32_16x16x64_bf16 v[48:51], v[40:43], v[192:199], v148
    v_smfmac_f32_16x16x64_bf16 v[52:55], v[40:43], v[200:207], v148
    v_smfmac_f32_16x16x64_bf16 v[56:59], v[40:43], v[208:215], v148
    v_smfmac_f32_16x16x64_bf16 v[60:63], v[40:43], v[216:223], v148
    s_waitcnt lgkmcnt(0)
    v_smfmac_f32_16x16x64_bf16 v[48:51], v[44:47], v[224:231], v148
    v_smfmac_f32_16x16x64_bf16 v[52:55], v[44:47], v[232:239], v148
    v_smfmac_f32_16x16x64_bf16 v[56:59], v[44:47], v[240:247], v148
    v_smfmac_f32_16x16x64_bf16 v[60:63], v[44:47], v[248:255], v148
    s_nop 4
    v_cvt_pk_bf16_f32 v80, v48, v49
    v_cvt_pk_bf16_f32 v81, v50, v51
    v_cvt_pk_bf16_f32 v82, v56, v57
    v_cvt_pk_bf16_f32 v83, v58, v59
    v_cvt_pk_bf16_f32 v84, v52, v53
    v_cvt_pk_bf16_f32 v85, v54, v55
    v_cvt_pk_bf16_f32 v86, v60, v61
    v_cvt_pk_bf16_f32 v87, v62, v63
    v_permlane32_swap_b32 v48, v52
    v_permlane32_swap_b32 v49, v53
    v_permlane32_swap_b32 v50, v54
    v_permlane32_swap_b32 v51, v55
    v_add_f32 v48, v48, v52
    v_add_f32 v49, v49, v53
    v_add_f32 v50, v50, v54
    v_add_f32 v51, v51, v55
    v_cvt_pk_bf16_f32 v136, v48, v49
    v_cvt_pk_bf16_f32 v137, v50, v51
    v_permlane32_swap_b32 v56, v60
    v_permlane32_swap_b32 v57, v61
    v_permlane32_swap_b32 v58, v62
    v_permlane32_swap_b32 v59, v63
    v_add_f32 v56, v56, v60
    v_add_f32 v57, v57, v61
    v_add_f32 v58, v58, v62
    v_add_f32 v59, v59, v63
    v_cvt_pk_bf16_f32 v138, v56, v57
    v_cvt_pk_bf16_f32 v139, v58, v59
    s_nop 0
    v_permlane16_swap_b32 v136, v138
    v_permlane16_swap_b32 v137, v139
    s_mul_i32 s39, s24, 327680
    s_cmp_eq_u32 s24, 63
    s_cbranch_scc1 Lb_last
    s_mul_i32 s36, s24, 20480
    s_add_u32 s36, s36, s30
    buffer_load_dwordx4 v[88:91], v154, s[4:7], s36 offen sc1
    s_mov_b32 exec_lo, 0xff00ff
    s_mov_b32 exec_hi, 0xff00ff
    buffer_load_dwordx4 v[92:95], v155, s[4:7], s36 offen sc1
    s_mov_b64 exec, -1
    s_sleep 2
    buffer_load_dwordx4 v[168:171], v154, s[4:7], s36 offen sc1
    s_mov_b32 exec_lo, 0xff00ff
    s_mov_b32 exec_hi, 0xff00ff
    buffer_load_dwordx4 v[172:175], v155, s[4:7], s36 offen sc1
    s_mov_b64 exec, -1
Lb_pollp:
    s_waitcnt vmcnt(2)
    v_max3_u32 v6, v88, v89, v90
    v_max3_u32 v6, v6, v91, v92
    v_max3_u32 v6, v6, v93, v94
    v_max_u32 v6, v6, v95
    v_cmp_eq_u32 vcc, -1, v6
    s_cbranch_vccz Lb_pa
    buffer_load_dwordx4 v[88:91], v154, s[4:7], s36 offen sc1
    s_mov_b32 exec_lo, 0xff00ff
    s_mov_b32 exec_hi, 0xff00ff
    buffer_load_dwordx4 v[92:95], v155, s[4:7], s36 offen sc1
    s_mov_b64 exec, -1
    s_waitcnt vmcnt(2)
    v_max3_u32 v6, v168, v169, v170
    v_max3_u32 v6, v6, v171, v172
    v_max3_u32 v6, v6, v173, v174
    v_max_u32 v6, v6, v175
    v_cmp_eq_u32 vcc, -1, v6
    s_cbranch_vccz Lb_pb
    s_sub_u32 s101, s101, 1
    s_cbranch_scc1 L_abort
    buffer_load_dwordx4 v[168:171], v154, s[4:7], s36 offen sc1
    s_mov_b32 exec_lo, 0xff00ff
    s_mov_b32 exec_hi, 0xff00ff
    buffer_load_dwordx4 v[172:175], v155, s[4:7], s36 offen sc1
    s_mov_b64 exec, -1
    s_branch Lb_pollp
Lb_pb:
    v_mfma_f32_16x16x32_bf16 v[96:99], v[172:175], v[80:83], 0
    v_mfma_f32_16x16x32_bf16 v[100:103], v[172:175], v[84:87], 0
    v_smfmac_f32_16x16x64_bf16 v[96:99], v[168:171], v[64:71], v148
    v_smfmac_f32_16x16x64_bf16 v[100:103], v[168:171], v[72:79], v148
    s_branch Lb_pj
Lb_pa:
    v_mfma_f32_16x16x32_bf16 v[96:99], v[92:95], v[80:83], 0
    v_mfma_f32_16x16x32_bf16 v[100:103], v[92:95], v[84:87], 0
    v_smfmac_f32_16x16x64_bf16 v[96:99], v[88:91], v[64:71], v148
    v_smfmac_f32_16x16x64_bf16 v[100:103], v[88:91], v[72:79], v148
Lb_pj:
    s_mul_i32 s36, s24, 81920
    s_add_u32 s36, s36, s31
    v_add_u32 v3, 86016, v2
    s_nop 4
    v_permlane32_swap_b32 v96, v100
    v_permlane32_swap_b32 v97, v101
    v_permlane32_swap_b32 v98, v102
    v_permlane32_swap_b32 v99, v103
    v_pk_add_f32 v[96:97], v[96:97], v[100:101]
    v_pk_add_f32 v[98:99], v[98:99], v[102:103]
    ds_write_b128 v159, v[96:99]
    s_waitcnt lgkmcnt(0)
    s_barrier
    s_cmp_ge_u32 s20, 2
    s_cbranch_scc1 Lb_w23
    ds_read_b128 v[120:123], v3 offset:0
    ds_read_b128 v[124:127], v3 offset:1024
    ds_read_b128 v[128:131], v3 offset:2048
    ds_read_b128 v[132:135], v3 offset:3072
    s_waitcnt lgkmcnt(2)
    v_pk_add_f32 v[120:121], v[120:121], v[124:125]
    v_pk_add_f32 v[122:123], v[122:123], v[126:127]
    s_waitcnt lgkmcnt(0)
    v_pk_add_f32 v[132:133], v[128:129], v[132:133]
    v_pk_add_f32 v[134:135], v[130:131], v[134:135]
    v_pk_add_f32 v[132:133], v[120:121], v[132:133]
    v_pk_add_f32 v[134:135], v[122:123], v[134:135]
    s_cmp_eq_u32 s20, 1
    s_cbranch_scc1 Lb_gather
    v_min_u32 v132, -2, v132
    v_min_u32 v133, -2, v133
    v_min_u32 v134, -2, v134
    v_min_u32 v135, -2, v135
    buffer_store_dwordx4 v[132:135], v160, s[4:7], s36 offen sc1
    s_branch Lb_zm
Lb_gather:
    s_sleep 13
Lb_pollg:
    buffer_load_dwordx4 v[120:123], v165, s[4:7], s36 offen sc1
    buffer_load_dwordx4 v[124:127], v166, s[4:7], s36 offen sc1
    buffer_load_dwordx4 v[128:131], v167, s[4:7], s36 offen sc1
    s_waitcnt vmcnt(0)
    v_max3_u32 v6, v120, v121, v122
    v_max3_u32 v6, v6, v123, v124
    v_max3_u32 v6, v6, v125, v126
    v_max3_u32 v6, v6, v127, v128
    v_max3_u32 v6, v6, v129, v130
    v_max_u32 v6, v6, v131
    v_cmp_eq_u32 vcc, -1, v6
    s_cbranch_vccz Lpd_64
    s_sub_u32 s101, s101, 1
    s_cbranch_scc1 L_abort
    s_branch Lb_pollg
Lpd_64:
    v_pk_add_f32 v[132:133], v[132:133], v[120:121]
    v_pk_add_f32 v[124:125], v[124:125], v[128:129]
    v_pk_add_f32 v[134:135], v[134:135], v[122:123]
    v_pk_add_f32 v[126:127], v[126:127], v[130:131]
    v_pk_add_f32 v[132:133], v[132:133], v[124:125]
    v_pk_add_f32 v[134:135], v[134:135], v[126:127]
Lb_gdone:
    v_cvt_pk_bf16_f32 v120, v132, v133
    v_cvt_pk_bf16_f32 v121, v134, v135
    s_add_u32 s36, s24, 1
    s_mul_i32 s36, s36, 40960
    v_mfma_f32_16x16x16_bf16 v[124:127], v[120:121], v[150:151], 0
    s_add_u32 s36, s36, s33
    s_nop 6
    v_cvt_pk_bf16_f32 v132, v124, v125
    v_cvt_pk_bf16_f32 v134, v126, v127
    s_nop 1
    v_permlane16_swap_b32 v132, v134
    s_nop 1
    v_mov_b32_dpp v133, v132 row_ror:8 row_mask:0xf bank_mask:0xf
    v_mov_b32_dpp v135, v134 row_ror:8 row_mask:0xf bank_mask:0xf
    v_min_u32 v132, -2, v132
    v_min_u32 v133, -2, v133
    v_min_u32 v134, -2, v134
    v_min_u32 v135, -2, v135
    s_mov_b32 exec_lo, 0xff00ff
    s_mov_b32 exec_hi, 0xff00ff
    s_cmp_lg_u32 s23, 0
    s_cbranch_scc1 Lsm_65
    buffer_store_dwordx4 v[132:135], v161, s[4:7], s36 offen
    s_branch Lsm_66
Lsm_65:
    buffer_store_dwordx4 v[132:135], v161, s[4:7], s36 offen sc1
Lsm_66:
    s_mov_b64 exec, -1
    s_barrier
    buffer_store_dwordx4 v[136:139], v162, s[4:7], s39 offen sc1
    s_waitcnt vmcnt(0)
    s_branch Lb_next
Lb_w23:
Lb_zm:
    buffer_store_dwordx4 v[136:139], v162, s[4:7], s39 offen sc1
    s_barrier
    s_sleep 2
Lb_next:
    s_add_u32 s24, s24, 1
    s_branch Lb_loop
Lb_last:
    buffer_store_dwordx4 v[136:139], v162, s[4:7], s39 offen sc1
    s_waitcnt vmcnt(0)
    s_barrier
    s_cmp_lg_u32 s20, 2
    s_cbranch_scc1 L_exit
    v_mov_b32 v6, 64
    s_mov_b64 exec, 1
    buffer_store_dword v6, v156, s[4:7], s41 offen sc1
    s_branch L_exit
Ld_k:
    s_load_dwordx2 s[8:9], s[0:1], 24
    s_waitcnt lgkmcnt(0)
    s_mov_b32 s10, 0x780000
    s_mov_b32 s11, 0x20000
    s_mov_b32 s30, 0x4200000
    s_mov_b32 s31, 0
    s_mov_b32 s49, 0
    s_branch Ld_kv
Ld_v:
    s_load_dwordx2 s[8:9], s[0:1], 32
    s_waitcnt lgkmcnt(0)
    s_mov_b32 s10, 0x780000
    s_mov_b32 s11, 0x20000
    s_mov_b32 s30, 0x5b00000
    s_mov_b32 s31, 4096
    s_mov_b32 s49, 1
Ld_kv:
    v_add_u32 v3, 0, v0
    v_mul_u32_u24 v4, 0x2ab, v3
    v_lshrrev_b32 v4, 14, v4
    v_mul_u32_u24 v5, 24, v4
    v_sub_u32 v5, v3, v5
    v_mul_u32_u24 v8, 0x3000, v4
    v_lshl_add_u32 v8, v5, 4, v8
    v_mul_u32_u24 v14, 0x1a0, v4
    v_lshl_add_u32 v14, v5, 4, v14
    v_add_u32 v3, 256, v0
    v_mul_u32_u24 v4, 0x2ab, v3
    v_lshrrev_b32 v4, 14, v4
    v_mul_u32_u24 v5, 24, v4
    v_sub_u32 v5, v3, v5
    v_mul_u32_u24 v9, 0x3000, v4
    v_lshl_add_u32 v9, v5, 4, v9
    v_mul_u32_u24 v15, 0x1a0, v4
    v_lshl_add_u32 v15, v5, 4, v15
    v_add_u32 v3, 512, v0
    v_mul_u32_u24 v4, 0x2ab, v3
    v_lshrrev_b32 v4, 14, v4
    v_mul_u32_u24 v5, 24, v4
    v_sub_u32 v5, v3, v5
    v_mul_u32_u24 v10, 0x3000, v4
    v_lshl_add_u32 v10, v5, 4, v10
    v_mul_u32_u24 v16, 0x1a0, v4
    v_lshl_add_u32 v16, v5, 4, v16
    v_add_u32 v3, 768, v0
    v_mul_u32_u24 v4, 0x2ab, v3
    v_lshrrev_b32 v4, 14, v4
    v_mul_u32_u24 v5, 24, v4
    v_sub_u32 v5, v3, v5
    v_mul_u32_u24 v11, 0x3000, v4
    v_lshl_add_u32 v11, v5, 4, v11
    v_mul_u32_u24 v17, 0x1a0, v4
    v_lshl_add_u32 v17, v5, 4, v17
    v_add_u32 v3, 1024, v0
    v_mul_u32_u24 v4, 0x2ab, v3
    v_lshrrev_b32 v4, 14, v4
    v_mul_u32_u24 v5, 24, v4
    v_sub_u32 v5, v3, v5
    v_mul_u32_u24 v12, 0x3000, v4
    v_lshl_add_u32 v12, v5, 4, v12
    v_mul_u32_u24 v18, 0x1a0, v4
    v_lshl_add_u32 v18, v5, 4, v18
    v_add_u32 v3, 1280, v0
    v_mul_u32_u24 v4, 0x2ab, v3
    v_lshrrev_b32 v4, 14, v4
    v_mul_u32_u24 v5, 24, v4
    v_sub_u32 v5, v3, v5
    v_mul_u32_u24 v13, 0x3000, v4
    v_lshl_add_u32 v13, v5, 4, v13
    v_mul_u32_u24 v19, 0x1a0, v4
    v_lshl_add_u32 v19, v5, 4, v19
    s_mul_i32 s25, s21, 384
    v_and_b32 v3, 15, v1
    v_lshrrev_b32 v4, 4, v1
    v_lshrrev_b32 v5, 2, v3
    v_lshl_add_u32 v5, v4, 3, v5
    v_mul_u32_u24 v20, 0x1a0, v5
    v_and_b32 v3, 3, v3
    v_lshl_add_u32 v20, v3, 3, v20
    s_mul_i32 s26, s20, 96
    v_add_u32 v20, s26, v20
    buffer_load_dwordx4 v[24:27], v8, s[8:11], s25 offen
    buffer_load_dwordx4 v[28:31], v9, s[8:11], s25 offen
    buffer_load_dwordx4 v[32:35], v10, s[8:11], s25 offen
    buffer_load_dwordx4 v[36:39], v11, s[8:11], s25 offen
    buffer_load_dwordx4 v[40:43], v12, s[8:11], s25 offen
    buffer_load_dwordx4 v[44:47], v13, s[8:11], s25 offen
    s_add_u32 s25, s25, 0xc0000
    buffer_load_dwordx4 v[48:51], v8, s[8:11], s25 offen
    buffer_load_dwordx4 v[52:55], v9, s[8:11], s25 offen
    buffer_load_dwordx4 v[56:59], v10, s[8:11], s25 offen
    buffer_load_dwordx4 v[60:63], v11, s[8:11], s25 offen
    buffer_load_dwordx4 v[64:67], v12, s[8:11], s25 offen
    buffer_load_dwordx4 v[68:71], v13, s[8:11], s25 offen
    s_add_u32 s25, s25, 0xc0000
    buffer_load_dwordx4 v[72:75], v8, s[8:11], s25 offen
    buffer_load_dwordx4 v[76:79], v9, s[8:11], s25 offen
    buffer_load_dwordx4 v[80:83], v10, s[8:11], s25 offen
    buffer_load_dwordx4 v[84:87], v11, s[8:11], s25 offen
    buffer_load_dwordx4 v[88:91], v12, s[8:11], s25 offen
    buffer_load_dwordx4 v[92:95], v13, s[8:11], s25 offen
    s_add_u32 s25, s25, 0xc0000
    s_waitcnt vmcnt(12)
    ds_write_b128 v14, v[24:27] offset:0
    ds_write_b128 v15, v[28:31] offset:0
    ds_write_b128 v16, v[32:35] offset:0
    ds_write_b128 v17, v[36:39] offset:0
    ds_write_b128 v18, v[40:43] offset:0
    ds_write_b128 v19, v[44:47] offset:0
    s_waitcnt lgkmcnt(0)
    buffer_load_dwordx4 v[24:27], v8, s[8:11], s25 offen
    buffer_load_dwordx4 v[28:31], v9, s[8:11], s25 offen
    buffer_load_dwordx4 v[32:35], v10, s[8:11], s25 offen
    buffer_load_dwordx4 v[36:39], v11, s[8:11], s25 offen
    buffer_load_dwordx4 v[40:43], v12, s[8:11], s25 offen
    buffer_load_dwordx4 v[44:47], v13, s[8:11], s25 offen
    s_add_u32 s25, s25, 0xc0000
    s_barrier
    ds_read_b64_tr_b16 a[0:1], v20 offset:0
    ds_read_b64_tr_b16 a[2:3], v20 offset:1664
    ds_read_b64_tr_b16 a[80:81], v20 offset:32
    ds_read_b64_tr_b16 a[82:83], v20 offset:1696
    ds_read_b64_tr_b16 a[160:161], v20 offset:64
    ds_read_b64_tr_b16 a[162:163], v20 offset:1728
    ds_read_b64_tr_b16 a[4:5], v20 offset:13312
    ds_read_b64_tr_b16 a[6:7], v20 offset:14976
    ds_read_b64_tr_b16 a[84:85], v20 offset:13344
    ds_read_b64_tr_b16 a[86:87], v20 offset:15008
    ds_read_b64_tr_b16 a[164:165], v20 offset:13376
    ds_read_b64_tr_b16 a[166:167], v20 offset:15040
    s_waitcnt vmcnt(12)
    ds_write_b128 v14, v[48:51] offset:26624
    ds_write_b128 v15, v[52:55] offset:26624
    ds_write_b128 v16, v[56:59] offset:26624
    ds_write_b128 v17, v[60:63] offset:26624
    ds_write_b128 v18, v[64:67] offset:26624
    ds_write_b128 v19, v[68:71] offset:26624
    s_waitcnt lgkmcnt(0)
    buffer_load_dwordx4 v[48:51], v8, s[8:11], s25 offen
    buffer_load_dwordx4 v[52:55], v9, s[8:11], s25 offen
    buffer_load_dwordx4 v[56:59], v10, s[8:11], s25 offen
    buffer_load_dwordx4 v[60:63], v11, s[8:11], s25 offen
    buffer_load_dwordx4 v[64:67], v12, s[8:11], s25 offen
    buffer_load_dwordx4 v[68:71], v13, s[8:11], s25 offen
    s_add_u32 s25, s25, 0xc0000
    s_barrier
    ds_read_b64_tr_b16 a[8:9], v20 offset:26624
    ds_read_b64_tr_b16 a[10:11], v20 offset:28288
    ds_read_b64_tr_b16 a[88:89], v20 offset:26656
    ds_read_b64_tr_b16 a[90:91], v20 offset:28320
    ds_read_b64_tr_b16 a[168:169], v20 offset:26688
    ds_read_b64_tr_b16 a[170:171], v20 offset:28352
    ds_read_b64_tr_b16 a[12:13], v20 offset:39936
    ds_read_b64_tr_b16 a[14:15], v20 offset:41600
    ds_read_b64_tr_b16 a[92:93], v20 offset:39968
    ds_read_b64_tr_b16 a[94:95], v20 offset:41632
    ds_read_b64_tr_b16 a[172:173], v20 offset:40000
    ds_read_b64_tr_b16 a[174:175], v20 offset:41664
    s_waitcnt vmcnt(12)
    ds_write_b128 v14, v[72:75] offset:0
    ds_write_b128 v15, v[76:79] offset:0
    ds_write_b128 v16, v[80:83] offset:0
    ds_write_b128 v17, v[84:87] offset:0
    ds_write_b128 v18, v[88:91] offset:0
    ds_write_b128 v19, v[92:95] offset:0
    s_waitcnt lgkmcnt(0)
    buffer_load_dwordx4 v[72:75], v8, s[8:11], s25 offen
    buffer_load_dwordx4 v[76:79], v9, s[8:11], s25 offen
    buffer_load_dwordx4 v[80:83], v10, s[8:11], s25 offen
    buffer_load_dwordx4 v[84:87], v11, s[8:11], s25 offen
    buffer_load_dwordx4 v[88:91], v12, s[8:11], s25 offen
    buffer_load_dwordx4 v[92:95], v13, s[8:11], s25 offen
    s_add_u32 s25, s25, 0xc0000
    s_barrier
    ds_read_b64_tr_b16 a[16:17], v20 offset:0
    ds_read_b64_tr_b16 a[18:19], v20 offset:1664
    ds_read_b64_tr_b16 a[96:97], v20 offset:32
    ds_read_b64_tr_b16 a[98:99], v20 offset:1696
    ds_read_b64_tr_b16 a[176:177], v20 offset:64
    ds_read_b64_tr_b16 a[178:179], v20 offset:1728
    ds_read_b64_tr_b16 a[20:21], v20 offset:13312
    ds_read_b64_tr_b16 a[22:23], v20 offset:14976
    ds_read_b64_tr_b16 a[100:101], v20 offset:13344
    ds_read_b64_tr_b16 a[102:103], v20 offset:15008
    ds_read_b64_tr_b16 a[180:181], v20 offset:13376
    ds_read_b64_tr_b16 a[182:183], v20 offset:15040
    s_waitcnt vmcnt(12)
    ds_write_b128 v14, v[24:27] offset:26624
    ds_write_b128 v15, v[28:31] offset:26624
    ds_write_b128 v16, v[32:35] offset:26624
    ds_write_b128 v17, v[36:39] offset:26624
    ds_write_b128 v18, v[40:43] offset:26624
    ds_write_b128 v19, v[44:47] offset:26624
    s_waitcnt lgkmcnt(0)
    buffer_load_dwordx4 v[24:27], v8, s[8:11], s25 offen
    buffer_load_dwordx4 v[28:31], v9, s[8:11], s25 offen
    buffer_load_dwordx4 v[32:35], v10, s[8:11], s25 offen
    buffer_load_dwordx4 v[36:39], v11, s[8:11], s25 offen
    buffer_load_dwordx4 v[40:43], v12, s[8:11], s25 offen
    buffer_load_dwordx4 v[44:47], v13, s[8:11], s25 offen
    s_add_u32 s25, s25, 0xc0000
    s_barrier
    ds_read_b64_tr_b16 a[24:25], v20 offset:26624
    ds_read_b64_tr_b16 a[26:27], v20 offset:28288
    ds_read_b64_tr_b16 a[104:105], v20 offset:26656
    ds_read_b64_tr_b16 a[106:107], v20 offset:28320
    ds_read_b64_tr_b16 a[184:185], v20 offset:26688
    ds_read_b64_tr_b16 a[186:187], v20 offset:28352
    ds_read_b64_tr_b16 a[28:29], v20 offset:39936
    ds_read_b64_tr_b16 a[30:31], v20 offset:41600
    ds_read_b64_tr_b16 a[108:109], v20 offset:39968
    ds_read_b64_tr_b16 a[110:111], v20 offset:41632
    ds_read_b64_tr_b16 a[188:189], v20 offset:40000
    ds_read_b64_tr_b16 a[190:191], v20 offset:41664
    s_waitcnt vmcnt(12)
    ds_write_b128 v14, v[48:51] offset:0
    ds_write_b128 v15, v[52:55] offset:0
    ds_write_b128 v16, v[56:59] offset:0
    ds_write_b128 v17, v[60:63] offset:0
    ds_write_b128 v18, v[64:67] offset:0
    ds_write_b128 v19, v[68:71] offset:0
    s_waitcnt lgkmcnt(0)
    buffer_load_dwordx4 v[48:51], v8, s[8:11], s25 offen
    buffer_load_dwordx4 v[52:55], v9, s[8:11], s25 offen
    buffer_load_dwordx4 v[56:59], v10, s[8:11], s25 offen
    buffer_load_dwordx4 v[60:63], v11, s[8:11], s25 offen
    buffer_load_dwordx4 v[64:67], v12, s[8:11], s25 offen
    buffer_load_dwordx4 v[68:71], v13, s[8:11], s25 offen
    s_add_u32 s25, s25, 0xc0000
    s_barrier
    ds_read_b64_tr_b16 a[32:33], v20 offset:0
    ds_read_b64_tr_b16 a[34:35], v20 offset:1664
    ds_read_b64_tr_b16 a[112:113], v20 offset:32
    ds_read_b64_tr_b16 a[114:115], v20 offset:1696
    ds_read_b64_tr_b16 a[192:193], v20 offset:64
    ds_read_b64_tr_b16 a[194:195], v20 offset:1728
    ds_read_b64_tr_b16 a[36:37], v20 offset:13312
    ds_read_b64_tr_b16 a[38:39], v20 offset:14976
    ds_read_b64_tr_b16 a[116:117], v20 offset:13344
    ds_read_b64_tr_b16 a[118:119], v20 offset:15008
    ds_read_b64_tr_b16 a[196:197], v20 offset:13376
    ds_read_b64_tr_b16 a[198:199], v20 offset:15040
    s_waitcnt vmcnt(12)
    ds_write_b128 v14, v[72:75] offset:26624
    ds_write_b128 v15, v[76:79] offset:26624
    ds_write_b128 v16, v[80:83] offset:26624
    ds_write_b128 v17, v[84:87] offset:26624
    ds_write_b128 v18, v[88:91] offset:26624
    ds_write_b128 v19, v[92:95] offset:26624
    s_waitcnt lgkmcnt(0)
    buffer_load_dwordx4 v[72:75], v8, s[8:11], s25 offen
    buffer_load_dwordx4 v[76:79], v9, s[8:11], s25 offen
    buffer_load_dwordx4 v[80:83], v10, s[8:11], s25 offen
    buffer_load_dwordx4 v[84:87], v11, s[8:11], s25 offen
    buffer_load_dwordx4 v[88:91], v12, s[8:11], s25 offen
    buffer_load_dwordx4 v[92:95], v13, s[8:11], s25 offen
    s_add_u32 s25, s25, 0xc0000
    s_barrier
    ds_read_b64_tr_b16 a[40:41], v20 offset:26624
    ds_read_b64_tr_b16 a[42:43], v20 offset:28288
    ds_read_b64_tr_b16 a[120:121], v20 offset:26656
    ds_read_b64_tr_b16 a[122:123], v20 offset:28320
    ds_read_b64_tr_b16 a[200:201], v20 offset:26688
    ds_read_b64_tr_b16 a[202:203], v20 offset:28352
    ds_read_b64_tr_b16 a[44:45], v20 offset:39936
    ds_read_b64_tr_b16 a[46:47], v20 offset:41600
    ds_read_b64_tr_b16 a[124:125], v20 offset:39968
    ds_read_b64_tr_b16 a[126:127], v20 offset:41632
    ds_read_b64_tr_b16 a[204:205], v20 offset:40000
    ds_read_b64_tr_b16 a[206:207], v20 offset:41664
    s_waitcnt vmcnt(12)
    ds_write_b128 v14, v[24:27] offset:0
    ds_write_b128 v15, v[28:31] offset:0
    ds_write_b128 v16, v[32:35] offset:0
    ds_write_b128 v17, v[36:39] offset:0
    ds_write_b128 v18, v[40:43] offset:0
    ds_write_b128 v19, v[44:47] offset:0
    s_waitcnt lgkmcnt(0)
    buffer_load_dwordx4 v[24:27], v8, s[8:11], s25 offen
    buffer_load_dwordx4 v[28:31], v9, s[8:11], s25 offen
    buffer_load_dwordx4 v[32:35], v10, s[8:11], s25 offen
    buffer_load_dwordx4 v[36:39], v11, s[8:11], s25 offen
    buffer_load_dwordx4 v[40:43], v12, s[8:11], s25 offen
    buffer_load_dwordx4 v[44:47], v13, s[8:11], s25 offen
    s_add_u32 s25, s25, 0xc0000
    s_barrier
    ds_read_b64_tr_b16 a[48:49], v20 offset:0
    ds_read_b64_tr_b16 a[50:51], v20 offset:1664
    ds_read_b64_tr_b16 a[128:129], v20 offset:32
    ds_read_b64_tr_b16 a[130:131], v20 offset:1696
    ds_read_b64_tr_b16 a[208:209], v20 offset:64
    ds_read_b64_tr_b16 a[210:211], v20 offset:1728
    ds_read_b64_tr_b16 a[52:53], v20 offset:13312
    ds_read_b64_tr_b16 a[54:55], v20 offset:14976
    ds_read_b64_tr_b16 a[132:133], v20 offset:13344
    ds_read_b64_tr_b16 a[134:135], v20 offset:15008
    ds_read_b64_tr_b16 a[212:213], v20 offset:13376
    ds_read_b64_tr_b16 a[214:215], v20 offset:15040
    s_waitcnt vmcnt(12)
    ds_write_b128 v14, v[48:51] offset:26624
    ds_write_b128 v15, v[52:55] offset:26624
    ds_write_b128 v16, v[56:59] offset:26624
    ds_write_b128 v17, v[60:63] offset:26624
    ds_write_b128 v18, v[64:67] offset:26624
    ds_write_b128 v19, v[68:71] offset:26624
    s_waitcnt lgkmcnt(0)
    s_barrier
    ds_read_b64_tr_b16 a[56:57], v20 offset:26624
    ds_read_b64_tr_b16 a[58:59], v20 offset:28288
    ds_read_b64_tr_b16 a[136:137], v20 offset:26656
    ds_read_b64_tr_b16 a[138:139], v20 offset:28320
    ds_read_b64_tr_b16 a[216:217], v20 offset:26688
    ds_read_b64_tr_b16 a[218:219], v20 offset:28352
    ds_read_b64_tr_b16 a[60:61], v20 offset:39936
    ds_read_b64_tr_b16 a[62:63], v20 offset:41600
    ds_read_b64_tr_b16 a[140:141], v20 offset:39968
    ds_read_b64_tr_b16 a[142:143], v20 offset:41632
    ds_read_b64_tr_b16 a[220:221], v20 offset:40000
    ds_read_b64_tr_b16 a[222:223], v20 offset:41664
    s_waitcnt vmcnt(6)
    ds_write_b128 v14, v[72:75] offset:0
    ds_write_b128 v15, v[76:79] offset:0
    ds_write_b128 v16, v[80:83] offset:0
    ds_write_b128 v17, v[84:87] offset:0
    ds_write_b128 v18, v[88:91] offset:0
    ds_write_b128 v19, v[92:95] offset:0
    s_waitcnt lgkmcnt(0)
    s_barrier
    ds_read_b64_tr_b16 a[64:65], v20 offset:0
    ds_read_b64_tr_b16 a[66:67], v20 offset:1664
    ds_read_b64_tr_b16 a[144:145], v20 offset:32
    ds_read_b64_tr_b16 a[146:147], v20 offset:1696
    ds_read_b64_tr_b16 a[224:225], v20 offset:64
    ds_read_b64_tr_b16 a[226:227], v20 offset:1728
    ds_read_b64_tr_b16 a[68:69], v20 offset:13312
    ds_read_b64_tr_b16 a[70:71], v20 offset:14976
    ds_read_b64_tr_b16 a[148:149], v20 offset:13344
    ds_read_b64_tr_b16 a[150:151], v20 offset:15008
    ds_read_b64_tr_b16 a[228:229], v20 offset:13376
    ds_read_b64_tr_b16 a[230:231], v20 offset:15040
    s_waitcnt vmcnt(0)
    ds_write_b128 v14, v[24:27] offset:26624
    ds_write_b128 v15, v[28:31] offset:26624
    ds_write_b128 v16, v[32:35] offset:26624
    ds_write_b128 v17, v[36:39] offset:26624
    ds_write_b128 v18, v[40:43] offset:26624
    ds_write_b128 v19, v[44:47] offset:26624
    s_waitcnt lgkmcnt(0)
    s_barrier
    ds_read_b64_tr_b16 a[72:73], v20 offset:26624
    ds_read_b64_tr_b16 a[74:75], v20 offset:28288
    ds_read_b64_tr_b16 a[152:153], v20 offset:26656
    ds_read_b64_tr_b16 a[154:155], v20 offset:28320
    ds_read_b64_tr_b16 a[232:233], v20 offset:26688
    ds_read_b64_tr_b16 a[234:235], v20 offset:28352
    ds_read_b64_tr_b16 a[76:77], v20 offset:39936
    ds_read_b64_tr_b16 a[78:79], v20 offset:41600
    ds_read_b64_tr_b16 a[156:157], v20 offset:39968
    ds_read_b64_tr_b16 a[158:159], v20 offset:41632
    ds_read_b64_tr_b16 a[236:237], v20 offset:40000
    ds_read_b64_tr_b16 a[238:239], v20 offset:41664
    s_waitcnt lgkmcnt(0)
    s_barrier
    s_mul_i32 s32, s21, 12288
    s_mul_i32 s33, s20, 3072
    s_add_u32 s30, s30, s32
    s_add_u32 s30, s30, s33
    s_lshl_b32 s32, s21, 7
    s_add_u32 s31, s31, s32
    v_mov_b32 v93, 0
    s_mul_i32 s34, s20, 10240
    s_add_u32 s35, s34, 0xc00000
    s_mov_b32 s37, s34
    v_mov_b32 v4, 4
Lwi_67:
    buffer_load_dword v5, v4, s[88:91], 0 offen sc1
    s_waitcnt vmcnt(0)
    v_cmp_gt_u32 vcc, 224, v5
    s_cbranch_vccz Lwid_68
    s_sub_u32 s101, s101, 1
    s_cbranch_scc1 L_abort
    s_sleep 8
    s_branch Lwi_67
Lwid_68:
    s_add_u32 m0, s37, 0
    s_add_u32 s36, s35, 0
    buffer_load_dwordx4 v2, s[4:7], s36 offen offset:0 sc1 lds
    buffer_load_dwordx4 v2, s[4:7], s36 offen offset:1024 sc1 lds
    buffer_load_dwordx4 v2, s[4:7], s36 offen offset:2048 sc1 lds
    buffer_load_dwordx4 v2, s[4:7], s36 offen offset:3072 sc1 lds
    s_add_u32 m0, s37, 4096
    s_add_u32 s36, s35, 4096
    buffer_load_dwordx4 v2, s[4:7], s36 offen offset:0 sc1 lds
    buffer_load_dwordx4 v2, s[4:7], s36 offen offset:1024 sc1 lds
    buffer_load_dwordx4 v2, s[4:7], s36 offen offset:2048 sc1 lds
    buffer_load_dwordx4 v2, s[4:7], s36 offen offset:3072 sc1 lds
    s_add_u32 m0, s37, 8192
    s_add_u32 s36, s35, 8192
    buffer_load_dwordx4 v2, s[4:7], s36 offen offset:0 sc1 lds
    buffer_load_dwordx4 v2, s[4:7], s36 offen offset:1024 sc1 lds
    s_mov_b32 s24, 0
    s_waitcnt vmcnt(0)
Lkv_loop:
    s_cmp_lt_u32 s24, 4
    s_cbranch_scc1 Lts_69
    s_waitcnt vmcnt(3)
    s_sub_u32 s32, s24, 1
    s_branch Lts_70
Lts_69:
    s_waitcnt vmcnt(0)
    s_mov_b32 s32, s24
Lts_70:
    s_barrier
    s_cmp_lg_u32 s20, 0
    s_cbranch_scc1 Lts_71
    v_mov_b32 v94, s32
    s_mov_b64 exec, 1
    buffer_store_dword v94, v93, s[4:7], s31 offen sc1
    s_mov_b64 exec, -1
Lts_71:
    s_add_u32 s32, s24, 1
    s_min_u32 s33, s32, 63
    s_mul_i32 s35, s33, 40960
    s_add_u32 s35, s35, s34
    s_add_u32 s35, s35, 0xc00000
    s_and_b32 s32, s32, 1
    s_mul_i32 s37, s32, 40960
    s_add_u32 s37, s37, s34
    s_and_b32 s32, s24, 1
    s_mul_i32 s32, s32, 40960
    v_add_u32 v92, s32, v2
    ds_read_b128 v[24:27], v92 offset:0
    ds_read_b128 v[28:31], v92 offset:20480
    ds_read_b128 v[32:35], v92 offset:1024
    ds_read_b128 v[36:39], v92 offset:21504
    ds_read_b128 v[40:43], v92 offset:2048
    ds_read_b128 v[44:47], v92 offset:22528
    ds_read_b128 v[48:51], v92 offset:3072
    ds_read_b128 v[52:55], v92 offset:23552
    s_waitcnt lgkmcnt(6)
    v_mfma_f32_16x16x32_bf16 v[64:67], a[0:3], v[24:27], 0
    v_mfma_f32_16x16x32_bf16 v[68:71], a[0:3], v[28:31], 0
    v_mfma_f32_16x16x32_bf16 v[72:75], a[80:83], v[24:27], 0
    v_mfma_f32_16x16x32_bf16 v[76:79], a[80:83], v[28:31], 0
    v_mfma_f32_16x16x32_bf16 v[80:83], a[160:163], v[24:27], 0
    v_mfma_f32_16x16x32_bf16 v[84:87], a[160:163], v[28:31], 0
    s_add_u32 m0, s37, 0
    s_add_u32 s36, s35, 0
    buffer_load_dwordx4 v2, s[4:7], s36 offen offset:0 sc1 lds
    ds_read_b128 v[24:27], v92 offset:4096
    ds_read_b128 v[28:31], v92 offset:24576
    s_waitcnt lgkmcnt(6)
    v_mfma_f32_16x16x32_bf16 v[64:67], a[4:7], v[32:35], v[64:67]
    v_mfma_f32_16x16x32_bf16 v[68:71], a[4:7], v[36:39], v[68:71]
    v_mfma_f32_16x16x32_bf16 v[72:75], a[84:87], v[32:35], v[72:75]
    v_mfma_f32_16x16x32_bf16 v[76:79], a[84:87], v[36:39], v[76:79]
    v_mfma_f32_16x16x32_bf16 v[80:83], a[164:167], v[32:35], v[80:83]
    v_mfma_f32_16x16x32_bf16 v[84:87], a[164:167], v[36:39], v[84:87]
    buffer_load_dwordx4 v2, s[4:7], s36 offen offset:1024 sc1 lds
    ds_read_b128 v[32:35], v92 offset:5120
    ds_read_b128 v[36:39], v92 offset:25600
    s_waitcnt lgkmcnt(6)
    v_mfma_f32_16x16x32_bf16 v[64:67], a[8:11], v[40:43], v[64:67]
    v_mfma_f32_16x16x32_bf16 v[68:71], a[8:11], v[44:47], v[68:71]
    v_mfma_f32_16x16x32_bf16 v[72:75], a[88:91], v[40:43], v[72:75]
    v_mfma_f32_16x16x32_bf16 v[76:79], a[88:91], v[44:47], v[76:79]
    v_mfma_f32_16x16x32_bf16 v[80:83], a[168:171], v[40:43], v[80:83]
    v_mfma_f32_16x16x32_bf16 v[84:87], a[168:171], v[44:47], v[84:87]
    buffer_load_dwordx4 v2, s[4:7], s36 offen offset:2048 sc1 lds
    ds_read_b128 v[40:43], v92 offset:6144
    ds_read_b128 v[44:47], v92 offset:26624
    s_waitcnt lgkmcnt(6)
    v_mfma_f32_16x16x32_bf16 v[64:67], a[12:15], v[48:51], v[64:67]
    v_mfma_f32_16x16x32_bf16 v[68:71], a[12:15], v[52:55], v[68:71]
    v_mfma_f32_16x16x32_bf16 v[72:75], a[92:95], v[48:51], v[72:75]
    v_mfma_f32_16x16x32_bf16 v[76:79], a[92:95], v[52:55], v[76:79]
    v_mfma_f32_16x16x32_bf16 v[80:83], a[172:175], v[48:51], v[80:83]
    v_mfma_f32_16x16x32_bf16 v[84:87], a[172:175], v[52:55], v[84:87]
    buffer_load_dwordx4 v2, s[4:7], s36 offen offset:3072 sc1 lds
    ds_read_b128 v[48:51], v92 offset:7168
    ds_read_b128 v[52:55], v92 offset:27648
    s_waitcnt lgkmcnt(6)
    v_mfma_f32_16x16x32_bf16 v[64:67], a[16:19], v[24:27], v[64:67]
    v_mfma_f32_16x16x32_bf16 v[68:71], a[16:19], v[28:31], v[68:71]
    v_mfma_f32_16x16x32_bf16 v[72:75], a[96:99], v[24:27], v[72:75]
    v_mfma_f32_16x16x32_bf16 v[76:79], a[96:99], v[28:31], v[76:79]
    v_mfma_f32_16x16x32_bf16 v[80:83], a[176:179], v[24:27], v[80:83]
    v_mfma_f32_16x16x32_bf16 v[84:87], a[176:179], v[28:31], v[84:87]
    s_add_u32 m0, s37, 4096
    s_add_u32 s36, s35, 4096
    buffer_load_dwordx4 v2, s[4:7], s36 offen offset:0 sc1 lds
    ds_read_b128 v[24:27], v92 offset:8192
    ds_read_b128 v[28:31], v92 offset:28672
    s_waitcnt lgkmcnt(6)
    v_mfma_f32_16x16x32_bf16 v[64:67], a[20:23], v[32:35], v[64:67]
    v_mfma_f32_16x16x32_bf16 v[68:71], a[20:23], v[36:39], v[68:71]
    v_mfma_f32_16x16x32_bf16 v[72:75], a[100:103], v[32:35], v[72:75]
    v_mfma_f32_16x16x32_bf16 v[76:79], a[100:103], v[36:39], v[76:79]
    v_mfma_f32_16x16x32_bf16 v[80:83], a[180:183], v[32:35], v[80:83]
    v_mfma_f32_16x16x32_bf16 v[84:87], a[180:183], v[36:39], v[84:87]
    buffer_load_dwordx4 v2, s[4:7], s36 offen offset:1024 sc1 lds
    ds_read_b128 v[32:35], v92 offset:9216
    ds_read_b128 v[36:39], v92 offset:29696
    s_waitcnt lgkmcnt(6)
    v_mfma_f32_16x16x32_bf16 v[64:67], a[24:27], v[40:43], v[64:67]
    v_mfma_f32_16x16x32_bf16 v[68:71], a[24:27], v[44:47], v[68:71]
    v_mfma_f32_16x16x32_bf16 v[72:75], a[104:107], v[40:43], v[72:75]
    v_mfma_f32_16x16x32_bf16 v[76:79], a[104:107], v[44:47], v[76:79]
    v_mfma_f32_16x16x32_bf16 v[80:83], a[184:187], v[40:43], v[80:83]
    v_mfma_f32_16x16x32_bf16 v[84:87], a[184:187], v[44:47], v[84:87]
    buffer_load_dwordx4 v2, s[4:7], s36 offen offset:2048 sc1 lds
    ds_read_b128 v[40:43], v92 offset:10240
    ds_read_b128 v[44:47], v92 offset:30720
    s_waitcnt lgkmcnt(6)
    v_mfma_f32_16x16x32_bf16 v[64:67], a[28:31], v[48:51], v[64:67]
    v_mfma_f32_16x16x32_bf16 v[68:71], a[28:31], v[52:55], v[68:71]
    v_mfma_f32_16x16x32_bf16 v[72:75], a[108:111], v[48:51], v[72:75]
    v_mfma_f32_16x16x32_bf16 v[76:79], a[108:111], v[52:55], v[76:79]
    v_mfma_f32_16x16x32_bf16 v[80:83], a[188:191], v[48:51], v[80:83]
    v_mfma_f32_16x16x32_bf16 v[84:87], a[188:191], v[52:55], v[84:87]
    buffer_load_dwordx4 v2, s[4:7], s36 offen offset:3072 sc1 lds
    ds_read_b128 v[48:51], v92 offset:11264
    ds_read_b128 v[52:55], v92 offset:31744
    s_waitcnt lgkmcnt(6)
    v_mfma_f32_16x16x32_bf16 v[64:67], a[32:35], v[24:27], v[64:67]
    v_mfma_f32_16x16x32_bf16 v[68:71], a[32:35], v[28:31], v[68:71]
    v_mfma_f32_16x16x32_bf16 v[72:75], a[112:115], v[24:27], v[72:75]
    v_mfma_f32_16x16x32_bf16 v[76:79], a[112:115], v[28:31], v[76:79]
    v_mfma_f32_16x16x32_bf16 v[80:83], a[192:195], v[24:27], v[80:83]
    v_mfma_f32_16x16x32_bf16 v[84:87], a[192:195], v[28:31], v[84:87]
    s_add_u32 m0, s37, 8192
    s_add_u32 s36, s35, 8192
    buffer_load_dwordx4 v2, s[4:7], s36 offen offset:0 sc1 lds
    ds_read_b128 v[24:27], v92 offset:12288
    ds_read_b128 v[28:31], v92 offset:32768
    s_waitcnt lgkmcnt(6)
    v_mfma_f32_16x16x32_bf16 v[64:67], a[36:39], v[32:35], v[64:67]
    v_mfma_f32_16x16x32_bf16 v[68:71], a[36:39], v[36:39], v[68:71]
    v_mfma_f32_16x16x32_bf16 v[72:75], a[116:119], v[32:35], v[72:75]
    v_mfma_f32_16x16x32_bf16 v[76:79], a[116:119], v[36:39], v[76:79]
    v_mfma_f32_16x16x32_bf16 v[80:83], a[196:199], v[32:35], v[80:83]
    v_mfma_f32_16x16x32_bf16 v[84:87], a[196:199], v[36:39], v[84:87]
    buffer_load_dwordx4 v2, s[4:7], s36 offen offset:1024 sc1 lds
    ds_read_b128 v[32:35], v92 offset:13312
    ds_read_b128 v[36:39], v92 offset:33792
    s_waitcnt lgkmcnt(6)
    v_mfma_f32_16x16x32_bf16 v[64:67], a[40:43], v[40:43], v[64:67]
    v_mfma_f32_16x16x32_bf16 v[68:71], a[40:43], v[44:47], v[68:71]
    v_mfma_f32_16x16x32_bf16 v[72:75], a[120:123], v[40:43], v[72:75]
    v_mfma_f32_16x16x32_bf16 v[76:79], a[120:123], v[44:47], v[76:79]
    v_mfma_f32_16x16x32_bf16 v[80:83], a[200:203], v[40:43], v[80:83]
    v_mfma_f32_16x16x32_bf16 v[84:87], a[200:203], v[44:47], v[84:87]
    ds_read_b128 v[40:43], v92 offset:14336
    ds_read_b128 v[44:47], v92 offset:34816
    s_waitcnt lgkmcnt(6)
    v_mfma_f32_16x16x32_bf16 v[64:67], a[44:47], v[48:51], v[64:67]
    v_mfma_f32_16x16x32_bf16 v[68:71], a[44:47], v[52:55], v[68:71]
    v_mfma_f32_16x16x32_bf16 v[72:75], a[124:127], v[48:51], v[72:75]
    v_mfma_f32_16x16x32_bf16 v[76:79], a[124:127], v[52:55], v[76:79]
    v_mfma_f32_16x16x32_bf16 v[80:83], a[204:207], v[48:51], v[80:83]
    v_mfma_f32_16x16x32_bf16 v[84:87], a[204:207], v[52:55], v[84:87]
    ds_read_b128 v[48:51], v92 offset:15360
    ds_read_b128 v[52:55], v92 offset:35840
    s_waitcnt lgkmcnt(6)
    v_mfma_f32_16x16x32_bf16 v[64:67], a[48:51], v[24:27], v[64:67]
    v_mfma_f32_16x16x32_bf16 v[68:71], a[48:51], v[28:31], v[68:71]
    v_mfma_f32_16x16x32_bf16 v[72:75], a[128:131], v[24:27], v[72:75]
    v_mfma_f32_16x16x32_bf16 v[76:79], a[128:131], v[28:31], v[76:79]
    v_mfma_f32_16x16x32_bf16 v[80:83], a[208:211], v[24:27], v[80:83]
    v_mfma_f32_16x16x32_bf16 v[84:87], a[208:211], v[28:31], v[84:87]
    ds_read_b128 v[24:27], v92 offset:16384
    ds_read_b128 v[28:31], v92 offset:36864
    s_waitcnt lgkmcnt(6)
    v_mfma_f32_16x16x32_bf16 v[64:67], a[52:55], v[32:35], v[64:67]
    v_mfma_f32_16x16x32_bf16 v[68:71], a[52:55], v[36:39], v[68:71]
    v_mfma_f32_16x16x32_bf16 v[72:75], a[132:135], v[32:35], v[72:75]
    v_mfma_f32_16x16x32_bf16 v[76:79], a[132:135], v[36:39], v[76:79]
    v_mfma_f32_16x16x32_bf16 v[80:83], a[212:215], v[32:35], v[80:83]
    v_mfma_f32_16x16x32_bf16 v[84:87], a[212:215], v[36:39], v[84:87]
    ds_read_b128 v[32:35], v92 offset:17408
    ds_read_b128 v[36:39], v92 offset:37888
    s_waitcnt lgkmcnt(6)
    v_mfma_f32_16x16x32_bf16 v[64:67], a[56:59], v[40:43], v[64:67]
    v_mfma_f32_16x16x32_bf16 v[68:71], a[56:59], v[44:47], v[68:71]
    v_mfma_f32_16x16x32_bf16 v[72:75], a[136:139], v[40:43], v[72:75]
    v_mfma_f32_16x16x32_bf16 v[76:79], a[136:139], v[44:47], v[76:79]
    v_mfma_f32_16x16x32_bf16 v[80:83], a[216:219], v[40:43], v[80:83]
    v_mfma_f32_16x16x32_bf16 v[84:87], a[216:219], v[44:47], v[84:87]
    ds_read_b128 v[40:43], v92 offset:18432
    ds_read_b128 v[44:47], v92 offset:38912
    s_waitcnt lgkmcnt(6)
    v_mfma_f32_16x16x32_bf16 v[64:67], a[60:63], v[48:51], v[64:67]
    v_mfma_f32_16x16x32_bf16 v[68:71], a[60:63], v[52:55], v[68:71]
    v_mfma_f32_16x16x32_bf16 v[72:75], a[140:143], v[48:51], v[72:75]
    v_mfma_f32_16x16x32_bf16 v[76:79], a[140:143], v[52:55], v[76:79]
    v_mfma_f32_16x16x32_bf16 v[80:83], a[220:223], v[48:51], v[80:83]
    v_mfma_f32_16x16x32_bf16 v[84:87], a[220:223], v[52:55], v[84:87]
    ds_read_b128 v[48:51], v92 offset:19456
    ds_read_b128 v[52:55], v92 offset:39936
    s_waitcnt lgkmcnt(6)
    v_mfma_f32_16x16x32_bf16 v[64:67], a[64:67], v[24:27], v[64:67]
    v_mfma_f32_16x16x32_bf16 v[68:71], a[64:67], v[28:31], v[68:71]
    v_mfma_f32_16x16x32_bf16 v[72:75], a[144:147], v[24:27], v[72:75]
    v_mfma_f32_16x16x32_bf16 v[76:79], a[144:147], v[28:31], v[76:79]
    v_mfma_f32_16x16x32_bf16 v[80:83], a[224:227], v[24:27], v[80:83]
    v_mfma_f32_16x16x32_bf16 v[84:87], a[224:227], v[28:31], v[84:87]
    s_waitcnt lgkmcnt(4)
    v_mfma_f32_16x16x32_bf16 v[64:67], a[68:71], v[32:35], v[64:67]
    v_mfma_f32_16x16x32_bf16 v[68:71], a[68:71], v[36:39], v[68:71]
    v_mfma_f32_16x16x32_bf16 v[72:75], a[148:151], v[32:35], v[72:75]
    v_mfma_f32_16x16x32_bf16 v[76:79], a[148:151], v[36:39], v[76:79]
    v_mfma_f32_16x16x32_bf16 v[80:83], a[228:231], v[32:35], v[80:83]
    v_mfma_f32_16x16x32_bf16 v[84:87], a[228:231], v[36:39], v[84:87]
    s_waitcnt lgkmcnt(2)
    v_mfma_f32_16x16x32_bf16 v[64:67], a[72:75], v[40:43], v[64:67]
    v_mfma_f32_16x16x32_bf16 v[68:71], a[72:75], v[44:47], v[68:71]
    v_mfma_f32_16x16x32_bf16 v[72:75], a[152:155], v[40:43], v[72:75]
    v_mfma_f32_16x16x32_bf16 v[76:79], a[152:155], v[44:47], v[76:79]
    v_mfma_f32_16x16x32_bf16 v[80:83], a[232:235], v[40:43], v[80:83]
    v_mfma_f32_16x16x32_bf16 v[84:87], a[232:235], v[44:47], v[84:87]
    s_waitcnt lgkmcnt(0)
    v_mfma_f32_16x16x32_bf16 v[64:67], a[76:79], v[48:51], v[64:67]
    v_mfma_f32_16x16x32_bf16 v[68:71], a[76:79], v[52:55], v[68:71]
    v_mfma_f32_16x16x32_bf16 v[72:75], a[156:159], v[48:51], v[72:75]
    v_mfma_f32_16x16x32_bf16 v[76:79], a[156:159], v[52:55], v[76:79]
    v_mfma_f32_16x16x32_bf16 v[80:83], a[236:239], v[48:51], v[80:83]
    v_mfma_f32_16x16x32_bf16 v[84:87], a[236:239], v[52:55], v[84:87]
    s_nop 2
    v_cvt_pk_bf16_f32 v96, v64, v65
    v_cvt_pk_bf16_f32 v97, v66, v67
    v_cvt_pk_bf16_f32 v98, v72, v73
    v_cvt_pk_bf16_f32 v99, v74, v75
    v_cvt_pk_bf16_f32 v100, v68, v69
    v_cvt_pk_bf16_f32 v101, v70, v71
    v_cvt_pk_bf16_f32 v102, v76, v77
    v_cvt_pk_bf16_f32 v103, v78, v79
    v_cvt_pk_bf16_f32 v104, v80, v81
    v_cvt_pk_bf16_f32 v105, v82, v83
    v_cvt_pk_bf16_f32 v106, v84, v85
    v_cvt_pk_bf16_f32 v107, v86, v87
    s_mul_i32 s32, s24, 393216
    s_add_u32 s32, s32, s30
    buffer_store_dwordx4 v[96:99], v2, s[4:7], s32 offen offset:0 sc1
    buffer_store_dwordx4 v[100:103], v2, s[4:7], s32 offen offset:1024 sc1
    buffer_store_dwordx4 v[104:107], v2, s[4:7], s32 offen offset:2048 sc1
    s_add_u32 s24, s24, 1
    s_cmp_lt_u32 s24, 64
    s_cbranch_scc1 Lkv_loop
    s_waitcnt vmcnt(0)
    s_barrier
    s_cmp_lg_u32 s20, 0
    s_cbranch_scc1 Lff_72
    v_mov_b32 v94, 64
    s_mov_b64 exec, 1
    buffer_store_dword v94, v93, s[4:7], s31 offen sc1
    s_mov_b64 exec, -1
Lff_72:
    s_branch Ld_after_kv
Ld_after_kv:
    s_cmp_eq_u32 s49, 0
    s_cbranch_scc1 Ld_bx
    s_cmp_lt_u32 s21, 16
    s_cbranch_scc0 Ld_tof2
    s_mov_b32 s22, 1
    s_branch Ld_f1
Ld_tof2:
    s_sub_u32 s21, s21, 16
    s_lshr_b32 s22, s21, 3
    s_and_b32 s21, s21, 7
    s_load_dwordx2 s[8:9], s[0:1], 80
    s_waitcnt lgkmcnt(0)
    s_mov_b32 s10, 0x1e0000
    s_mov_b32 s11, 0x20000
    v_add_u32 v3, 0, v1
    v_mul_u32_u24 v4, 0xcd, v3
    v_lshrrev_b32 v4, 11, v4
    v_mul_u32_u24 v5, 10, v4
    v_sub_u32 v5, v3, v5
    v_mul_u32_u24 v96, 0x500, v4
    v_lshl_add_u32 v96, v5, 4, v96
    v_mul_u32_u24 v112, 0xa0, v4
    v_lshl_add_u32 v112, v5, 4, v112
    v_add_u32 v3, 64, v1
    v_mul_u32_u24 v4, 0xcd, v3
    v_lshrrev_b32 v4, 11, v4
    v_mul_u32_u24 v5, 10, v4
    v_sub_u32 v5, v3, v5
    v_mul_u32_u24 v97, 0x500, v4
    v_lshl_add_u32 v97, v5, 4, v97
    v_mul_u32_u24 v113, 0xa0, v4
    v_lshl_add_u32 v113, v5, 4, v113
    v_add_u32 v3, 128, v1
    v_mul_u32_u24 v4, 0xcd, v3
    v_lshrrev_b32 v4, 11, v4
    v_mul_u32_u24 v5, 10, v4
    v_sub_u32 v5, v3, v5
    v_mul_u32_u24 v98, 0x500, v4
    v_lshl_add_u32 v98, v5, 4, v98
    v_mul_u32_u24 v114, 0xa0, v4
    v_lshl_add_u32 v114, v5, 4, v114
    v_add_u32 v3, 192, v1
    v_mul_u32_u24 v4, 0xcd, v3
    v_lshrrev_b32 v4, 11, v4
    v_mul_u32_u24 v5, 10, v4
    v_sub_u32 v5, v3, v5
    v_mul_u32_u24 v99, 0x500, v4
    v_lshl_add_u32 v99, v5, 4, v99
    v_mul_u32_u24 v115, 0xa0, v4
    v_lshl_add_u32 v115, v5, 4, v115
    v_add_u32 v3, 256, v1
    v_mul_u32_u24 v4, 0xcd, v3
    v_lshrrev_b32 v4, 11, v4
    v_mul_u32_u24 v5, 10, v4
    v_sub_u32 v5, v3, v5
    v_mul_u32_u24 v100, 0x500, v4
    v_lshl_add_u32 v100, v5, 4, v100
    v_mul_u32_u24 v116, 0xa0, v4
    v_lshl_add_u32 v116, v5, 4, v116
    v_add_u32 v3, 320, v1
    v_mul_u32_u24 v4, 0xcd, v3
    v_lshrrev_b32 v4, 11, v4
    v_mul_u32_u24 v5, 10, v4
    v_sub_u32 v5, v3, v5
    v_mul_u32_u24 v101, 0x500, v4
    v_lshl_add_u32 v101, v5, 4, v101
    v_mul_u32_u24 v117, 0xa0, v4
    v_lshl_add_u32 v117, v5, 4, v117
    v_add_u32 v3, 384, v1
    v_mul_u32_u24 v4, 0xcd, v3
    v_lshrrev_b32 v4, 11, v4
    v_mul_u32_u24 v5, 10, v4
    v_sub_u32 v5, v3, v5
    v_mul_u32_u24 v102, 0x500, v4
    v_lshl_add_u32 v102, v5, 4, v102
    v_mul_u32_u24 v118, 0xa0, v4
    v_lshl_add_u32 v118, v5, 4, v118
    v_add_u32 v3, 448, v1
    v_mul_u32_u24 v4, 0xcd, v3
    v_lshrrev_b32 v4, 11, v4
    v_mul_u32_u24 v5, 10, v4
    v_sub_u32 v5, v3, v5
    v_mul_u32_u24 v103, 0x500, v4
    v_lshl_add_u32 v103, v5, 4, v103
    v_mul_u32_u24 v119, 0xa0, v4
    v_lshl_add_u32 v119, v5, 4, v119
    v_add_u32 v3, 512, v1
    v_mul_u32_u24 v4, 0xcd, v3
    v_lshrrev_b32 v4, 11, v4
    v_mul_u32_u24 v5, 10, v4
    v_sub_u32 v5, v3, v5
    v_mul_u32_u24 v104, 0x500, v4
    v_lshl_add_u32 v104, v5, 4, v104
    v_mul_u32_u24 v120, 0xa0, v4
    v_lshl_add_u32 v120, v5, 4, v120
    v_add_u32 v3, 576, v1
    v_mul_u32_u24 v4, 0xcd, v3
    v_lshrrev_b32 v4, 11, v4
    v_mul_u32_u24 v5, 10, v4
    v_sub_u32 v5, v3, v5
    v_mul_u32_u24 v105, 0x500, v4
    v_lshl_add_u32 v105, v5, 4, v105
    v_mul_u32_u24 v121, 0xa0, v4
    v_lshl_add_u32 v121, v5, 4, v121
    v_add_u32 v3, 640, v1
    v_mul_u32_u24 v4, 0xcd, v3
    v_lshrrev_b32 v4, 11, v4
    v_mul_u32_u24 v5, 10, v4
    v_sub_u32 v5, v3, v5
    v_mul_u32_u24 v106, 0x500, v4
    v_lshl_add_u32 v106, v5, 4, v106
    v_mul_u32_u24 v122, 0xa0, v4
    v_lshl_add_u32 v122, v5, 4, v122
    v_add_u32 v3, 704, v1
    v_mul_u32_u24 v4, 0xcd, v3
    v_lshrrev_b32 v4, 11, v4
    v_mul_u32_u24 v5, 10, v4
    v_sub_u32 v5, v3, v5
    v_mul_u32_u24 v107, 0x500, v4
    v_lshl_add_u32 v107, v5, 4, v107
    v_mul_u32_u24 v123, 0xa0, v4
    v_lshl_add_u32 v123, v5, 4, v123
    v_add_u32 v3, 768, v1
    v_mul_u32_u24 v4, 0xcd, v3
    v_lshrrev_b32 v4, 11, v4
    v_mul_u32_u24 v5, 10, v4
    v_sub_u32 v5, v3, v5
    v_mul_u32_u24 v108, 0x500, v4
    v_lshl_add_u32 v108, v5, 4, v108
    v_mul_u32_u24 v124, 0xa0, v4
    v_lshl_add_u32 v124, v5, 4, v124
    v_add_u32 v3, 832, v1
    v_mul_u32_u24 v4, 0xcd, v3
    v_lshrrev_b32 v4, 11, v4
    v_mul_u32_u24 v5, 10, v4
    v_sub_u32 v5, v3, v5
    v_mul_u32_u24 v109, 0x500, v4
    v_lshl_add_u32 v109, v5, 4, v109
    v_mul_u32_u24 v125, 0xa0, v4
    v_lshl_add_u32 v125, v5, 4, v125
    v_add_u32 v3, 896, v1
    v_mul_u32_u24 v4, 0xcd, v3
    v_lshrrev_b32 v4, 11, v4
    v_mul_u32_u24 v5, 10, v4
    v_sub_u32 v5, v3, v5
    v_mul_u32_u24 v110, 0x500, v4
    v_lshl_add_u32 v110, v5, 4, v110
    v_mul_u32_u24 v126, 0xa0, v4
    v_lshl_add_u32 v126, v5, 4, v126
    s_mul_i32 s26, s20, 15360
    v_add_u32 v112, s26, v112
    v_add_u32 v113, s26, v113
    v_add_u32 v114, s26, v114
    v_add_u32 v115, s26, v115
    v_add_u32 v116, s26, v116
    v_add_u32 v117, s26, v117
    v_add_u32 v118, s26, v118
    v_add_u32 v119, s26, v119
    v_add_u32 v120, s26, v120
    v_add_u32 v121, s26, v121
    v_add_u32 v122, s26, v122
    v_add_u32 v123, s26, v123
    v_add_u32 v124, s26, v124
    v_add_u32 v125, s26, v125
    v_add_u32 v126, s26, v126
    v_and_b32 v3, 15, v1
    v_lshrrev_b32 v4, 4, v1
    v_lshrrev_b32 v5, 2, v3
    v_lshrrev_b32 v6, 1, v4
    v_mul_u32_u24 v6, 0x18, v6
    v_add_u32 v6, v6, v5
    v_and_b32 v7, 1, v4
    v_lshl_add_u32 v6, v7, 2, v6
    v_mul_u32_u24 v10, 0xa0, v6
    v_mul_u32_u24 v6, 0x18, v4
    v_add_u32 v6, v6, v5
    v_add_u32 v6, 16, v6
    v_mul_u32_u24 v11, 0xa0, v6
    v_and_b32 v3, 3, v3
    v_lshlrev_b32 v3, 3, v3
    v_add_u32 v3, s26, v3
    v_add_u32 v10, v3, v10
    v_add_u32 v11, v3, v11
    s_mul_i32 s25, s20, 491520
    s_mul_i32 s26, s21, 160
    s_add_u32 s25, s25, s26
    buffer_load_dwordx4 v[24:27], v96, s[8:11], s25 offen
    buffer_load_dwordx4 v[28:31], v97, s[8:11], s25 offen
    buffer_load_dwordx4 v[32:35], v98, s[8:11], s25 offen
    buffer_load_dwordx4 v[36:39], v99, s[8:11], s25 offen
    buffer_load_dwordx4 v[40:43], v100, s[8:11], s25 offen
    buffer_load_dwordx4 v[44:47], v101, s[8:11], s25 offen
    buffer_load_dwordx4 v[48:51], v102, s[8:11], s25 offen
    buffer_load_dwordx4 v[52:55], v103, s[8:11], s25 offen
    buffer_load_dwordx4 v[56:59], v104, s[8:11], s25 offen
    buffer_load_dwordx4 v[60:63], v105, s[8:11], s25 offen
    buffer_load_dwordx4 v[64:67], v106, s[8:11], s25 offen
    buffer_load_dwordx4 v[68:71], v107, s[8:11], s25 offen
    buffer_load_dwordx4 v[72:75], v108, s[8:11], s25 offen
    buffer_load_dwordx4 v[76:79], v109, s[8:11], s25 offen
    buffer_load_dwordx4 v[80:83], v110, s[8:11], s25 offen
    s_add_u32 s25, s25, 122880
    s_waitcnt vmcnt(14)
    ds_write_b128 v112, v[24:27]
    s_waitcnt vmcnt(13)
    ds_write_b128 v113, v[28:31]
    s_waitcnt vmcnt(12)
    ds_write_b128 v114, v[32:35]
    s_waitcnt vmcnt(11)
    ds_write_b128 v115, v[36:39]
    s_waitcnt vmcnt(10)
    ds_write_b128 v116, v[40:43]
    s_waitcnt vmcnt(9)
    ds_write_b128 v117, v[44:47]
    s_waitcnt vmcnt(8)
    ds_write_b128 v118, v[48:51]
    s_waitcnt vmcnt(7)
    ds_write_b128 v119, v[52:55]
    s_waitcnt vmcnt(6)
    ds_write_b128 v120, v[56:59]
    s_waitcnt vmcnt(5)
    ds_write_b128 v121, v[60:63]
    s_waitcnt vmcnt(4)
    ds_write_b128 v122, v[64:67]
    s_waitcnt vmcnt(3)
    ds_write_b128 v123, v[68:71]
    s_waitcnt vmcnt(2)
    ds_write_b128 v124, v[72:75]
    s_waitcnt vmcnt(1)
    ds_write_b128 v125, v[76:79]
    s_waitcnt vmcnt(0)
    ds_write_b128 v126, v[80:83]
    s_waitcnt lgkmcnt(0)
    ds_read_b64_tr_b16 a[0:1], v10 offset:0
    ds_read_b64_tr_b16 a[2:3], v10 offset:1280
    ds_read_b64_tr_b16 a[48:49], v10 offset:32
    ds_read_b64_tr_b16 a[50:51], v10 offset:1312
    ds_read_b64_tr_b16 a[96:97], v10 offset:64
    ds_read_b64_tr_b16 a[98:99], v10 offset:1344
    ds_read_b64_tr_b16 a[144:145], v10 offset:96
    ds_read_b64_tr_b16 a[146:147], v10 offset:1376
    ds_read_b64_tr_b16 a[192:193], v10 offset:128
    ds_read_b64_tr_b16 a[194:195], v10 offset:1408
    ds_read_b64_tr_b16 a[4:5], v10 offset:7680
    ds_read_b64_tr_b16 a[6:7], v10 offset:8960
    ds_read_b64_tr_b16 a[52:53], v10 offset:7712
    ds_read_b64_tr_b16 a[54:55], v10 offset:8992
    ds_read_b64_tr_b16 a[100:101], v10 offset:7744
    ds_read_b64_tr_b16 a[102:103], v10 offset:9024
    ds_read_b64_tr_b16 a[148:149], v10 offset:7776
    ds_read_b64_tr_b16 a[150:151], v10 offset:9056
    ds_read_b64_tr_b16 a[196:197], v10 offset:7808
    ds_read_b64_tr_b16 a[198:199], v10 offset:9088
    ds_read_b64_tr_b16 a[8:9], v11 offset:0
    ds_read_b64_tr_b16 a[10:11], v11 offset:640
    ds_read_b64_tr_b16 a[56:57], v11 offset:32
    ds_read_b64_tr_b16 a[58:59], v11 offset:672
    ds_read_b64_tr_b16 a[104:105], v11 offset:64
    ds_read_b64_tr_b16 a[106:107], v11 offset:704
    ds_read_b64_tr_b16 a[152:153], v11 offset:96
    ds_read_b64_tr_b16 a[154:155], v11 offset:736
    ds_read_b64_tr_b16 a[200:201], v11 offset:128
    ds_read_b64_tr_b16 a[202:203], v11 offset:768
    s_waitcnt lgkmcnt(0)
    buffer_load_dwordx4 v[24:27], v96, s[8:11], s25 offen
    buffer_load_dwordx4 v[28:31], v97, s[8:11], s25 offen
    buffer_load_dwordx4 v[32:35], v98, s[8:11], s25 offen
    buffer_load_dwordx4 v[36:39], v99, s[8:11], s25 offen
    buffer_load_dwordx4 v[40:43], v100, s[8:11], s25 offen
    buffer_load_dwordx4 v[44:47], v101, s[8:11], s25 offen
    buffer_load_dwordx4 v[48:51], v102, s[8:11], s25 offen
    buffer_load_dwordx4 v[52:55], v103, s[8:11], s25 offen
    buffer_load_dwordx4 v[56:59], v104, s[8:11], s25 offen
    buffer_load_dwordx4 v[60:63], v105, s[8:11], s25 offen
    buffer_load_dwordx4 v[64:67], v106, s[8:11], s25 offen
    buffer_load_dwordx4 v[68:71], v107, s[8:11], s25 offen
    buffer_load_dwordx4 v[72:75], v108, s[8:11], s25 offen
    buffer_load_dwordx4 v[76:79], v109, s[8:11], s25 offen
    buffer_load_dwordx4 v[80:83], v110, s[8:11], s25 offen
    s_add_u32 s25, s25, 122880
    s_waitcnt vmcnt(14)
    ds_write_b128 v112, v[24:27]
    s_waitcnt vmcnt(13)
    ds_write_b128 v113, v[28:31]
    s_waitcnt vmcnt(12)
    ds_write_b128 v114, v[32:35]
    s_waitcnt vmcnt(11)
    ds_write_b128 v115, v[36:39]
    s_waitcnt vmcnt(10)
    ds_write_b128 v116, v[40:43]
    s_waitcnt vmcnt(9)
    ds_write_b128 v117, v[44:47]
    s_waitcnt vmcnt(8)
    ds_write_b128 v118, v[48:51]
    s_waitcnt vmcnt(7)
    ds_write_b128 v119, v[52:55]
    s_waitcnt vmcnt(6)
    ds_write_b128 v120, v[56:59]
    s_waitcnt vmcnt(5)
    ds_write_b128 v121, v[60:63]
    s_waitcnt vmcnt(4)
    ds_write_b128 v122, v[64:67]
    s_waitcnt vmcnt(3)
    ds_write_b128 v123, v[68:71]
    s_waitcnt vmcnt(2)
    ds_write_b128 v124, v[72:75]
    s_waitcnt vmcnt(1)
    ds_write_b128 v125, v[76:79]
    s_waitcnt vmcnt(0)
    ds_write_b128 v126, v[80:83]
    s_waitcnt lgkmcnt(0)
    ds_read_b64_tr_b16 a[12:13], v10 offset:0
    ds_read_b64_tr_b16 a[14:15], v10 offset:1280
    ds_read_b64_tr_b16 a[60:61], v10 offset:32
    ds_read_b64_tr_b16 a[62:63], v10 offset:1312
    ds_read_b64_tr_b16 a[108:109], v10 offset:64
    ds_read_b64_tr_b16 a[110:111], v10 offset:1344
    ds_read_b64_tr_b16 a[156:157], v10 offset:96
    ds_read_b64_tr_b16 a[158:159], v10 offset:1376
    ds_read_b64_tr_b16 a[204:205], v10 offset:128
    ds_read_b64_tr_b16 a[206:207], v10 offset:1408
    ds_read_b64_tr_b16 a[16:17], v10 offset:7680
    ds_read_b64_tr_b16 a[18:19], v10 offset:8960
    ds_read_b64_tr_b16 a[64:65], v10 offset:7712
    ds_read_b64_tr_b16 a[66:67], v10 offset:8992
    ds_read_b64_tr_b16 a[112:113], v10 offset:7744
    ds_read_b64_tr_b16 a[114:115], v10 offset:9024
    ds_read_b64_tr_b16 a[160:161], v10 offset:7776
    ds_read_b64_tr_b16 a[162:163], v10 offset:9056
    ds_read_b64_tr_b16 a[208:209], v10 offset:7808
    ds_read_b64_tr_b16 a[210:211], v10 offset:9088
    ds_read_b64_tr_b16 a[20:21], v11 offset:0
    ds_read_b64_tr_b16 a[22:23], v11 offset:640
    ds_read_b64_tr_b16 a[68:69], v11 offset:32
    ds_read_b64_tr_b16 a[70:71], v11 offset:672
    ds_read_b64_tr_b16 a[116:117], v11 offset:64
    ds_read_b64_tr_b16 a[118:119], v11 offset:704
    ds_read_b64_tr_b16 a[164:165], v11 offset:96
    ds_read_b64_tr_b16 a[166:167], v11 offset:736
    ds_read_b64_tr_b16 a[212:213], v11 offset:128
    ds_read_b64_tr_b16 a[214:215], v11 offset:768
    s_waitcnt lgkmcnt(0)
    buffer_load_dwordx4 v[24:27], v96, s[8:11], s25 offen
    buffer_load_dwordx4 v[28:31], v97, s[8:11], s25 offen
    buffer_load_dwordx4 v[32:35], v98, s[8:11], s25 offen
    buffer_load_dwordx4 v[36:39], v99, s[8:11], s25 offen
    buffer_load_dwordx4 v[40:43], v100, s[8:11], s25 offen
    buffer_load_dwordx4 v[44:47], v101, s[8:11], s25 offen
    buffer_load_dwordx4 v[48:51], v102, s[8:11], s25 offen
    buffer_load_dwordx4 v[52:55], v103, s[8:11], s25 offen
    buffer_load_dwordx4 v[56:59], v104, s[8:11], s25 offen
    buffer_load_dwordx4 v[60:63], v105, s[8:11], s25 offen
    buffer_load_dwordx4 v[64:67], v106, s[8:11], s25 offen
    buffer_load_dwordx4 v[68:71], v107, s[8:11], s25 offen
    buffer_load_dwordx4 v[72:75], v108, s[8:11], s25 offen
    buffer_load_dwordx4 v[76:79], v109, s[8:11], s25 offen
    buffer_load_dwordx4 v[80:83], v110, s[8:11], s25 offen
    s_add_u32 s25, s25, 122880
    s_waitcnt vmcnt(14)
    ds_write_b128 v112, v[24:27]
    s_waitcnt vmcnt(13)
    ds_write_b128 v113, v[28:31]
    s_waitcnt vmcnt(12)
    ds_write_b128 v114, v[32:35]
    s_waitcnt vmcnt(11)
    ds_write_b128 v115, v[36:39]
    s_waitcnt vmcnt(10)
    ds_write_b128 v116, v[40:43]
    s_waitcnt vmcnt(9)
    ds_write_b128 v117, v[44:47]
    s_waitcnt vmcnt(8)
    ds_write_b128 v118, v[48:51]
    s_waitcnt vmcnt(7)
    ds_write_b128 v119, v[52:55]
    s_waitcnt vmcnt(6)
    ds_write_b128 v120, v[56:59]
    s_waitcnt vmcnt(5)
    ds_write_b128 v121, v[60:63]
    s_waitcnt vmcnt(4)
    ds_write_b128 v122, v[64:67]
    s_waitcnt vmcnt(3)
    ds_write_b128 v123, v[68:71]
    s_waitcnt vmcnt(2)
    ds_write_b128 v124, v[72:75]
    s_waitcnt vmcnt(1)
    ds_write_b128 v125, v[76:79]
    s_waitcnt vmcnt(0)
    ds_write_b128 v126, v[80:83]
    s_waitcnt lgkmcnt(0)
    ds_read_b64_tr_b16 a[24:25], v10 offset:0
    ds_read_b64_tr_b16 a[26:27], v10 offset:1280
    ds_read_b64_tr_b16 a[72:73], v10 offset:32
    ds_read_b64_tr_b16 a[74:75], v10 offset:1312
    ds_read_b64_tr_b16 a[120:121], v10 offset:64
    ds_read_b64_tr_b16 a[122:123], v10 offset:1344
    ds_read_b64_tr_b16 a[168:169], v10 offset:96
    ds_read_b64_tr_b16 a[170:171], v10 offset:1376
    ds_read_b64_tr_b16 a[216:217], v10 offset:128
    ds_read_b64_tr_b16 a[218:219], v10 offset:1408
    ds_read_b64_tr_b16 a[28:29], v10 offset:7680
    ds_read_b64_tr_b16 a[30:31], v10 offset:8960
    ds_read_b64_tr_b16 a[76:77], v10 offset:7712
    ds_read_b64_tr_b16 a[78:79], v10 offset:8992
    ds_read_b64_tr_b16 a[124:125], v10 offset:7744
    ds_read_b64_tr_b16 a[126:127], v10 offset:9024
    ds_read_b64_tr_b16 a[172:173], v10 offset:7776
    ds_read_b64_tr_b16 a[174:175], v10 offset:9056
    ds_read_b64_tr_b16 a[220:221], v10 offset:7808
    ds_read_b64_tr_b16 a[222:223], v10 offset:9088
    ds_read_b64_tr_b16 a[32:33], v11 offset:0
    ds_read_b64_tr_b16 a[34:35], v11 offset:640
    ds_read_b64_tr_b16 a[80:81], v11 offset:32
    ds_read_b64_tr_b16 a[82:83], v11 offset:672
    ds_read_b64_tr_b16 a[128:129], v11 offset:64
    ds_read_b64_tr_b16 a[130:131], v11 offset:704
    ds_read_b64_tr_b16 a[176:177], v11 offset:96
    ds_read_b64_tr_b16 a[178:179], v11 offset:736
    ds_read_b64_tr_b16 a[224:225], v11 offset:128
    ds_read_b64_tr_b16 a[226:227], v11 offset:768
    s_waitcnt lgkmcnt(0)
    buffer_load_dwordx4 v[24:27], v96, s[8:11], s25 offen
    buffer_load_dwordx4 v[28:31], v97, s[8:11], s25 offen
    buffer_load_dwordx4 v[32:35], v98, s[8:11], s25 offen
    buffer_load_dwordx4 v[36:39], v99, s[8:11], s25 offen
    buffer_load_dwordx4 v[40:43], v100, s[8:11], s25 offen
    buffer_load_dwordx4 v[44:47], v101, s[8:11], s25 offen
    buffer_load_dwordx4 v[48:51], v102, s[8:11], s25 offen
    buffer_load_dwordx4 v[52:55], v103, s[8:11], s25 offen
    buffer_load_dwordx4 v[56:59], v104, s[8:11], s25 offen
    buffer_load_dwordx4 v[60:63], v105, s[8:11], s25 offen
    buffer_load_dwordx4 v[64:67], v106, s[8:11], s25 offen
    buffer_load_dwordx4 v[68:71], v107, s[8:11], s25 offen
    buffer_load_dwordx4 v[72:75], v108, s[8:11], s25 offen
    buffer_load_dwordx4 v[76:79], v109, s[8:11], s25 offen
    buffer_load_dwordx4 v[80:83], v110, s[8:11], s25 offen
    s_add_u32 s25, s25, 122880
    s_waitcnt vmcnt(14)
    ds_write_b128 v112, v[24:27]
    s_waitcnt vmcnt(13)
    ds_write_b128 v113, v[28:31]
    s_waitcnt vmcnt(12)
    ds_write_b128 v114, v[32:35]
    s_waitcnt vmcnt(11)
    ds_write_b128 v115, v[36:39]
    s_waitcnt vmcnt(10)
    ds_write_b128 v116, v[40:43]
    s_waitcnt vmcnt(9)
    ds_write_b128 v117, v[44:47]
    s_waitcnt vmcnt(8)
    ds_write_b128 v118, v[48:51]
    s_waitcnt vmcnt(7)
    ds_write_b128 v119, v[52:55]
    s_waitcnt vmcnt(6)
    ds_write_b128 v120, v[56:59]
    s_waitcnt vmcnt(5)
    ds_write_b128 v121, v[60:63]
    s_waitcnt vmcnt(4)
    ds_write_b128 v122, v[64:67]
    s_waitcnt vmcnt(3)
    ds_write_b128 v123, v[68:71]
    s_waitcnt vmcnt(2)
    ds_write_b128 v124, v[72:75]
    s_waitcnt vmcnt(1)
    ds_write_b128 v125, v[76:79]
    s_waitcnt vmcnt(0)
    ds_write_b128 v126, v[80:83]
    s_waitcnt lgkmcnt(0)
    ds_read_b64_tr_b16 a[36:37], v10 offset:0
    ds_read_b64_tr_b16 a[38:39], v10 offset:1280
    ds_read_b64_tr_b16 a[84:85], v10 offset:32
    ds_read_b64_tr_b16 a[86:87], v10 offset:1312
    ds_read_b64_tr_b16 a[132:133], v10 offset:64
    ds_read_b64_tr_b16 a[134:135], v10 offset:1344
    ds_read_b64_tr_b16 a[180:181], v10 offset:96
    ds_read_b64_tr_b16 a[182:183], v10 offset:1376
    ds_read_b64_tr_b16 a[228:229], v10 offset:128
    ds_read_b64_tr_b16 a[230:231], v10 offset:1408
    ds_read_b64_tr_b16 a[40:41], v10 offset:7680
    ds_read_b64_tr_b16 a[42:43], v10 offset:8960
    ds_read_b64_tr_b16 a[88:89], v10 offset:7712
    ds_read_b64_tr_b16 a[90:91], v10 offset:8992
    ds_read_b64_tr_b16 a[136:137], v10 offset:7744
    ds_read_b64_tr_b16 a[138:139], v10 offset:9024
    ds_read_b64_tr_b16 a[184:185], v10 offset:7776
    ds_read_b64_tr_b16 a[186:187], v10 offset:9056
    ds_read_b64_tr_b16 a[232:233], v10 offset:7808
    ds_read_b64_tr_b16 a[234:235], v10 offset:9088
    ds_read_b64_tr_b16 a[44:45], v11 offset:0
    ds_read_b64_tr_b16 a[46:47], v11 offset:640
    ds_read_b64_tr_b16 a[92:93], v11 offset:32
    ds_read_b64_tr_b16 a[94:95], v11 offset:672
    ds_read_b64_tr_b16 a[140:141], v11 offset:64
    ds_read_b64_tr_b16 a[142:143], v11 offset:704
    ds_read_b64_tr_b16 a[188:189], v11 offset:96
    ds_read_b64_tr_b16 a[190:191], v11 offset:736
    ds_read_b64_tr_b16 a[236:237], v11 offset:128
    ds_read_b64_tr_b16 a[238:239], v11 offset:768
    s_waitcnt lgkmcnt(0)
    s_barrier
    s_load_dwordx2 s[16:17], s[0:1], 88
    s_waitcnt lgkmcnt(0)
    s_mov_b32 s18, 0x280000
    s_mov_b32 s19, 0x20000
    v_and_b32 v3, 3, v1
    s_lshl_b32 s26, s20, 2
    v_add_u32 v3, s26, v3
    v_lshlrev_b32 v3, 7, v3
    s_lshl_b32 s26, s22, 11
    s_add_u32 s26, s26, 32768
    v_add_u32 v152, s26, v3
    s_mul_i32 s26, s20, 10240
    v_add_u32 v153, s26, v2
    v_and_b32 v3, 15, v1
    v_lshrrev_b32 v4, 4, v1
    v_mul_u32_u24 v155, 0x500, v3
    v_lshl_add_u32 v155, v4, 3, v155
    s_lshr_b32 s40, s20, 1
    s_and_b32 s41, s20, 1
    s_cmp_eq_u32 s41, 0
    s_cselect_b32 s42, 0, 3
    s_cmp_eq_u32 s41, 0
    s_cselect_b32 s43, 1, 4
    s_cmp_eq_u32 s41, 0
    s_cselect_b32 s44, 2, 4
    s_mov_b32 s24, s22
    s_mov_b32 s46, 0
Lf2_loop:
    s_cmp_lg_u32 s46, 0
    s_cbranch_scc1 Lf2_warm
    s_add_u32 s28, s24, 1
Lw_73:
    buffer_load_dword v156, v152, s[4:7], 0 offen sc1
    s_waitcnt vmcnt(0)
    v_cmp_gt_u32 vcc, s28, v156
    s_cbranch_vccz Lwd_74
    s_sub_u32 s101, s101, 1
    s_cbranch_scc1 L_abort
    s_sleep 1
    s_branch Lw_73
Lwd_74:
    s_mul_i32 s30, s24, 98304
    s_mul_i32 s26, s20, 12288
    s_add_u32 s30, s30, s26
    s_add_u32 s30, s30, 0x1400000
    s_add_u32 s31, s30, 49152
    buffer_load_dwordx4 v[8:11], v2, s[4:7], s30 offen offset:0 sc1
    buffer_load_dwordx4 v[12:15], v2, s[4:7], s31 offen offset:0 sc1
    buffer_load_dwordx4 v[16:19], v2, s[4:7], s30 offen offset:1024 sc1
    buffer_load_dwordx4 v[20:23], v2, s[4:7], s31 offen offset:1024 sc1
    buffer_load_dwordx4 v[24:27], v2, s[4:7], s30 offen offset:2048 sc1
    buffer_load_dwordx4 v[28:31], v2, s[4:7], s31 offen offset:2048 sc1
    buffer_load_dwordx4 v[32:35], v2, s[4:7], s30 offen offset:3072 sc1
    buffer_load_dwordx4 v[36:39], v2, s[4:7], s31 offen offset:3072 sc1
    s_add_u32 s30, s30, 4096
    s_add_u32 s31, s31, 4096
    buffer_load_dwordx4 v[40:43], v2, s[4:7], s30 offen offset:0 sc1
    buffer_load_dwordx4 v[44:47], v2, s[4:7], s31 offen offset:0 sc1
    buffer_load_dwordx4 v[48:51], v2, s[4:7], s30 offen offset:1024 sc1
    buffer_load_dwordx4 v[52:55], v2, s[4:7], s31 offen offset:1024 sc1
    buffer_load_dwordx4 v[56:59], v2, s[4:7], s30 offen offset:2048 sc1
    buffer_load_dwordx4 v[60:63], v2, s[4:7], s31 offen offset:2048 sc1
    buffer_load_dwordx4 v[64:67], v2, s[4:7], s30 offen offset:3072 sc1
    buffer_load_dwordx4 v[68:71], v2, s[4:7], s31 offen offset:3072 sc1
    s_add_u32 s30, s30, 4096
    s_add_u32 s31, s31, 4096
    buffer_load_dwordx4 v[72:75], v2, s[4:7], s30 offen offset:0 sc1
    buffer_load_dwordx4 v[76:79], v2, s[4:7], s31 offen offset:0 sc1
    buffer_load_dwordx4 v[80:83], v2, s[4:7], s30 offen offset:1024 sc1
    buffer_load_dwordx4 v[84:87], v2, s[4:7], s31 offen offset:1024 sc1
    buffer_load_dwordx4 v[88:91], v2, s[4:7], s30 offen offset:2048 sc1
    buffer_load_dwordx4 v[92:95], v2, s[4:7], s31 offen offset:2048 sc1
    buffer_load_dwordx4 v[96:99], v2, s[4:7], s30 offen offset:3072 sc1
    buffer_load_dwordx4 v[100:103], v2, s[4:7], s31 offen offset:3072 sc1
    s_mul_i32 s32, s24, 40960
    s_mul_i32 s26, s40, 20480
    s_add_u32 s32, s32, s26
    s_add_u32 s32, s32, 0x1000000
    s_mul_i32 s33, s21, 5
    s_add_u32 s33, s33, s42
    s_lshr_b32 s34, s33, 1
    s_lshl_b32 s34, s34, 10
    s_and_b32 s33, s33, 1
    s_lshl_b32 s33, s33, 3
    s_add_u32 s34, s34, s33
    s_add_u32 s34, s34, s32
    buffer_load_dwordx2 v[144:145], v2, s[4:7], s34 offen sc1
    s_mul_i32 s33, s21, 5
    s_add_u32 s33, s33, s43
    s_lshr_b32 s34, s33, 1
    s_lshl_b32 s34, s34, 10
    s_and_b32 s33, s33, 1
    s_lshl_b32 s33, s33, 3
    s_add_u32 s34, s34, s33
    s_add_u32 s34, s34, s32
    buffer_load_dwordx2 v[146:147], v2, s[4:7], s34 offen sc1
    s_mul_i32 s33, s21, 5
    s_add_u32 s33, s33, s44
    s_lshr_b32 s34, s33, 1
    s_lshl_b32 s34, s34, 10
    s_and_b32 s33, s33, 1
    s_lshl_b32 s33, s33, 3
    s_add_u32 s34, s34, s33
    s_add_u32 s34, s34, s32
    buffer_load_dwordx2 v[148:149], v2, s[4:7], s34 offen sc1
Lf2_warm:
    s_waitcnt vmcnt(0)
    s_add_u32 s47, s24, 2
    s_add_u32 s28, s24, 3
    v_cmp_gt_u32 vcc, s28, v156
    s_cmp_eq_u64 vcc, 0
    s_cselect_b32 s46, 1, 0
    s_cmp_lt_u32 s47, 64
    s_cselect_b32 s46, s46, 0
    buffer_load_dword v156, v152, s[4:7], 0 offen sc1
    s_cmp_eq_u32 s46, 0
    s_cbranch_scc1 Lf2a_75
    s_mul_i32 s30, s47, 98304
    s_mul_i32 s26, s20, 12288
    s_add_u32 s30, s30, s26
    s_add_u32 s30, s30, 0x1400000
    s_add_u32 s31, s30, 49152
Lf2a_75:
    v_mfma_f32_16x16x32_bf16 v[104:107], a[0:3], v[8:11], 0
    v_mfma_f32_16x16x32_bf16 v[108:111], a[0:3], v[12:15], 0
    v_mfma_f32_16x16x32_bf16 v[112:115], a[48:51], v[8:11], 0
    v_mfma_f32_16x16x32_bf16 v[116:119], a[48:51], v[12:15], 0
    v_mfma_f32_16x16x32_bf16 v[120:123], a[96:99], v[8:11], 0
    v_mfma_f32_16x16x32_bf16 v[124:127], a[96:99], v[12:15], 0
    v_mfma_f32_16x16x32_bf16 v[128:131], a[144:147], v[8:11], 0
    v_mfma_f32_16x16x32_bf16 v[132:135], a[144:147], v[12:15], 0
    v_mfma_f32_16x16x32_bf16 v[136:139], a[192:195], v[8:11], 0
    v_mfma_f32_16x16x32_bf16 v[140:143], a[192:195], v[12:15], 0
    s_cmp_eq_u32 s46, 0
    s_cbranch_scc1 Lf2p_76
    buffer_load_dwordx4 v[8:11], v2, s[4:7], s30 offen offset:0 sc1
    buffer_load_dwordx4 v[12:15], v2, s[4:7], s31 offen offset:0 sc1
Lf2p_76:
    v_mfma_f32_16x16x32_bf16 v[104:107], a[4:7], v[16:19], v[104:107]
    v_mfma_f32_16x16x32_bf16 v[108:111], a[4:7], v[20:23], v[108:111]
    v_mfma_f32_16x16x32_bf16 v[112:115], a[52:55], v[16:19], v[112:115]
    v_mfma_f32_16x16x32_bf16 v[116:119], a[52:55], v[20:23], v[116:119]
    v_mfma_f32_16x16x32_bf16 v[120:123], a[100:103], v[16:19], v[120:123]
    v_mfma_f32_16x16x32_bf16 v[124:127], a[100:103], v[20:23], v[124:127]
    v_mfma_f32_16x16x32_bf16 v[128:131], a[148:151], v[16:19], v[128:131]
    v_mfma_f32_16x16x32_bf16 v[132:135], a[148:151], v[20:23], v[132:135]
    v_mfma_f32_16x16x32_bf16 v[136:139], a[196:199], v[16:19], v[136:139]
    v_mfma_f32_16x16x32_bf16 v[140:143], a[196:199], v[20:23], v[140:143]
    s_cmp_eq_u32 s46, 0
    s_cbranch_scc1 Lf2p_77
    buffer_load_dwordx4 v[16:19], v2, s[4:7], s30 offen offset:1024 sc1
    buffer_load_dwordx4 v[20:23], v2, s[4:7], s31 offen offset:1024 sc1
Lf2p_77:
    v_mfma_f32_16x16x32_bf16 v[104:107], a[8:11], v[24:27], v[104:107]
    v_mfma_f32_16x16x32_bf16 v[108:111], a[8:11], v[28:31], v[108:111]
    v_mfma_f32_16x16x32_bf16 v[112:115], a[56:59], v[24:27], v[112:115]
    v_mfma_f32_16x16x32_bf16 v[116:119], a[56:59], v[28:31], v[116:119]
    v_mfma_f32_16x16x32_bf16 v[120:123], a[104:107], v[24:27], v[120:123]
    v_mfma_f32_16x16x32_bf16 v[124:127], a[104:107], v[28:31], v[124:127]
    v_mfma_f32_16x16x32_bf16 v[128:131], a[152:155], v[24:27], v[128:131]
    v_mfma_f32_16x16x32_bf16 v[132:135], a[152:155], v[28:31], v[132:135]
    v_mfma_f32_16x16x32_bf16 v[136:139], a[200:203], v[24:27], v[136:139]
    v_mfma_f32_16x16x32_bf16 v[140:143], a[200:203], v[28:31], v[140:143]
    s_cmp_eq_u32 s46, 0
    s_cbranch_scc1 Lf2p_78
    buffer_load_dwordx4 v[24:27], v2, s[4:7], s30 offen offset:2048 sc1
    buffer_load_dwordx4 v[28:31], v2, s[4:7], s31 offen offset:2048 sc1
Lf2p_78:
    v_mfma_f32_16x16x32_bf16 v[104:107], a[12:15], v[32:35], v[104:107]
    v_mfma_f32_16x16x32_bf16 v[108:111], a[12:15], v[36:39], v[108:111]
    v_mfma_f32_16x16x32_bf16 v[112:115], a[60:63], v[32:35], v[112:115]
    v_mfma_f32_16x16x32_bf16 v[116:119], a[60:63], v[36:39], v[116:119]
    v_mfma_f32_16x16x32_bf16 v[120:123], a[108:111], v[32:35], v[120:123]
    v_mfma_f32_16x16x32_bf16 v[124:127], a[108:111], v[36:39], v[124:127]
    v_mfma_f32_16x16x32_bf16 v[128:131], a[156:159], v[32:35], v[128:131]
    v_mfma_f32_16x16x32_bf16 v[132:135], a[156:159], v[36:39], v[132:135]
    v_mfma_f32_16x16x32_bf16 v[136:139], a[204:207], v[32:35], v[136:139]
    v_mfma_f32_16x16x32_bf16 v[140:143], a[204:207], v[36:39], v[140:143]
    s_cmp_eq_u32 s46, 0
    s_cbranch_scc1 Lf2p_79
    buffer_load_dwordx4 v[32:35], v2, s[4:7], s30 offen offset:3072 sc1
    buffer_load_dwordx4 v[36:39], v2, s[4:7], s31 offen offset:3072 sc1
    s_add_u32 s30, s30, 4096
    s_add_u32 s31, s31, 4096
Lf2p_79:
    v_mfma_f32_16x16x32_bf16 v[104:107], a[16:19], v[40:43], v[104:107]
    v_mfma_f32_16x16x32_bf16 v[108:111], a[16:19], v[44:47], v[108:111]
    v_mfma_f32_16x16x32_bf16 v[112:115], a[64:67], v[40:43], v[112:115]
    v_mfma_f32_16x16x32_bf16 v[116:119], a[64:67], v[44:47], v[116:119]
    v_mfma_f32_16x16x32_bf16 v[120:123], a[112:115], v[40:43], v[120:123]
    v_mfma_f32_16x16x32_bf16 v[124:127], a[112:115], v[44:47], v[124:127]
    v_mfma_f32_16x16x32_bf16 v[128:131], a[160:163], v[40:43], v[128:131]
    v_mfma_f32_16x16x32_bf16 v[132:135], a[160:163], v[44:47], v[132:135]
    v_mfma_f32_16x16x32_bf16 v[136:139], a[208:211], v[40:43], v[136:139]
    v_mfma_f32_16x16x32_bf16 v[140:143], a[208:211], v[44:47], v[140:143]
    s_cmp_eq_u32 s46, 0
    s_cbranch_scc1 Lf2p_80
    buffer_load_dwordx4 v[40:43], v2, s[4:7], s30 offen offset:0 sc1
    buffer_load_dwordx4 v[44:47], v2, s[4:7], s31 offen offset:0 sc1
Lf2p_80:
    v_mfma_f32_16x16x32_bf16 v[104:107], a[20:23], v[48:51], v[104:107]
    v_mfma_f32_16x16x32_bf16 v[108:111], a[20:23], v[52:55], v[108:111]
    v_mfma_f32_16x16x32_bf16 v[112:115], a[68:71], v[48:51], v[112:115]
    v_mfma_f32_16x16x32_bf16 v[116:119], a[68:71], v[52:55], v[116:119]
    v_mfma_f32_16x16x32_bf16 v[120:123], a[116:119], v[48:51], v[120:123]
    v_mfma_f32_16x16x32_bf16 v[124:127], a[116:119], v[52:55], v[124:127]
    v_mfma_f32_16x16x32_bf16 v[128:131], a[164:167], v[48:51], v[128:131]
    v_mfma_f32_16x16x32_bf16 v[132:135], a[164:167], v[52:55], v[132:135]
    v_mfma_f32_16x16x32_bf16 v[136:139], a[212:215], v[48:51], v[136:139]
    v_mfma_f32_16x16x32_bf16 v[140:143], a[212:215], v[52:55], v[140:143]
    s_cmp_eq_u32 s46, 0
    s_cbranch_scc1 Lf2p_81
    buffer_load_dwordx4 v[48:51], v2, s[4:7], s30 offen offset:1024 sc1
    buffer_load_dwordx4 v[52:55], v2, s[4:7], s31 offen offset:1024 sc1
Lf2p_81:
    v_mfma_f32_16x16x32_bf16 v[104:107], a[24:27], v[56:59], v[104:107]
    v_mfma_f32_16x16x32_bf16 v[108:111], a[24:27], v[60:63], v[108:111]
    v_mfma_f32_16x16x32_bf16 v[112:115], a[72:75], v[56:59], v[112:115]
    v_mfma_f32_16x16x32_bf16 v[116:119], a[72:75], v[60:63], v[116:119]
    v_mfma_f32_16x16x32_bf16 v[120:123], a[120:123], v[56:59], v[120:123]
    v_mfma_f32_16x16x32_bf16 v[124:127], a[120:123], v[60:63], v[124:127]
    v_mfma_f32_16x16x32_bf16 v[128:131], a[168:171], v[56:59], v[128:131]
    v_mfma_f32_16x16x32_bf16 v[132:135], a[168:171], v[60:63], v[132:135]
    v_mfma_f32_16x16x32_bf16 v[136:139], a[216:219], v[56:59], v[136:139]
    v_mfma_f32_16x16x32_bf16 v[140:143], a[216:219], v[60:63], v[140:143]
    s_cmp_eq_u32 s46, 0
    s_cbranch_scc1 Lf2p_82
    buffer_load_dwordx4 v[56:59], v2, s[4:7], s30 offen offset:2048 sc1
    buffer_load_dwordx4 v[60:63], v2, s[4:7], s31 offen offset:2048 sc1
Lf2p_82:
    v_mfma_f32_16x16x32_bf16 v[104:107], a[28:31], v[64:67], v[104:107]
    v_mfma_f32_16x16x32_bf16 v[108:111], a[28:31], v[68:71], v[108:111]
    v_mfma_f32_16x16x32_bf16 v[112:115], a[76:79], v[64:67], v[112:115]
    v_mfma_f32_16x16x32_bf16 v[116:119], a[76:79], v[68:71], v[116:119]
    v_mfma_f32_16x16x32_bf16 v[120:123], a[124:127], v[64:67], v[120:123]
    v_mfma_f32_16x16x32_bf16 v[124:127], a[124:127], v[68:71], v[124:127]
    v_mfma_f32_16x16x32_bf16 v[128:131], a[172:175], v[64:67], v[128:131]
    v_mfma_f32_16x16x32_bf16 v[132:135], a[172:175], v[68:71], v[132:135]
    v_mfma_f32_16x16x32_bf16 v[136:139], a[220:223], v[64:67], v[136:139]
    v_mfma_f32_16x16x32_bf16 v[140:143], a[220:223], v[68:71], v[140:143]
    s_cmp_eq_u32 s46, 0
    s_cbranch_scc1 Lf2p_83
    buffer_load_dwordx4 v[64:67], v2, s[4:7], s30 offen offset:3072 sc1
    buffer_load_dwordx4 v[68:71], v2, s[4:7], s31 offen offset:3072 sc1
    s_add_u32 s30, s30, 4096
    s_add_u32 s31, s31, 4096
Lf2p_83:
    v_mfma_f32_16x16x32_bf16 v[104:107], a[32:35], v[72:75], v[104:107]
    v_mfma_f32_16x16x32_bf16 v[108:111], a[32:35], v[76:79], v[108:111]
    v_mfma_f32_16x16x32_bf16 v[112:115], a[80:83], v[72:75], v[112:115]
    v_mfma_f32_16x16x32_bf16 v[116:119], a[80:83], v[76:79], v[116:119]
    v_mfma_f32_16x16x32_bf16 v[120:123], a[128:131], v[72:75], v[120:123]
    v_mfma_f32_16x16x32_bf16 v[124:127], a[128:131], v[76:79], v[124:127]
    v_mfma_f32_16x16x32_bf16 v[128:131], a[176:179], v[72:75], v[128:131]
    v_mfma_f32_16x16x32_bf16 v[132:135], a[176:179], v[76:79], v[132:135]
    v_mfma_f32_16x16x32_bf16 v[136:139], a[224:227], v[72:75], v[136:139]
    v_mfma_f32_16x16x32_bf16 v[140:143], a[224:227], v[76:79], v[140:143]
    s_cmp_eq_u32 s46, 0
    s_cbranch_scc1 Lf2p_84
    buffer_load_dwordx4 v[72:75], v2, s[4:7], s30 offen offset:0 sc1
    buffer_load_dwordx4 v[76:79], v2, s[4:7], s31 offen offset:0 sc1
Lf2p_84:
    v_mfma_f32_16x16x32_bf16 v[104:107], a[36:39], v[80:83], v[104:107]
    v_mfma_f32_16x16x32_bf16 v[108:111], a[36:39], v[84:87], v[108:111]
    v_mfma_f32_16x16x32_bf16 v[112:115], a[84:87], v[80:83], v[112:115]
    v_mfma_f32_16x16x32_bf16 v[116:119], a[84:87], v[84:87], v[116:119]
    v_mfma_f32_16x16x32_bf16 v[120:123], a[132:135], v[80:83], v[120:123]
    v_mfma_f32_16x16x32_bf16 v[124:127], a[132:135], v[84:87], v[124:127]
    v_mfma_f32_16x16x32_bf16 v[128:131], a[180:183], v[80:83], v[128:131]
    v_mfma_f32_16x16x32_bf16 v[132:135], a[180:183], v[84:87], v[132:135]
    v_mfma_f32_16x16x32_bf16 v[136:139], a[228:231], v[80:83], v[136:139]
    v_mfma_f32_16x16x32_bf16 v[140:143], a[228:231], v[84:87], v[140:143]
    s_cmp_eq_u32 s46, 0
    s_cbranch_scc1 Lf2p_85
    buffer_load_dwordx4 v[80:83], v2, s[4:7], s30 offen offset:1024 sc1
    buffer_load_dwordx4 v[84:87], v2, s[4:7], s31 offen offset:1024 sc1
Lf2p_85:
    v_mfma_f32_16x16x32_bf16 v[104:107], a[40:43], v[88:91], v[104:107]
    v_mfma_f32_16x16x32_bf16 v[108:111], a[40:43], v[92:95], v[108:111]
    v_mfma_f32_16x16x32_bf16 v[112:115], a[88:91], v[88:91], v[112:115]
    v_mfma_f32_16x16x32_bf16 v[116:119], a[88:91], v[92:95], v[116:119]
    v_mfma_f32_16x16x32_bf16 v[120:123], a[136:139], v[88:91], v[120:123]
    v_mfma_f32_16x16x32_bf16 v[124:127], a[136:139], v[92:95], v[124:127]
    v_mfma_f32_16x16x32_bf16 v[128:131], a[184:187], v[88:91], v[128:131]
    v_mfma_f32_16x16x32_bf16 v[132:135], a[184:187], v[92:95], v[132:135]
    v_mfma_f32_16x16x32_bf16 v[136:139], a[232:235], v[88:91], v[136:139]
    v_mfma_f32_16x16x32_bf16 v[140:143], a[232:235], v[92:95], v[140:143]
    s_cmp_eq_u32 s46, 0
    s_cbranch_scc1 Lf2p_86
    buffer_load_dwordx4 v[88:91], v2, s[4:7], s30 offen offset:2048 sc1
    buffer_load_dwordx4 v[92:95], v2, s[4:7], s31 offen offset:2048 sc1
Lf2p_86:
    v_mfma_f32_16x16x32_bf16 v[104:107], a[44:47], v[96:99], v[104:107]
    v_mfma_f32_16x16x32_bf16 v[108:111], a[44:47], v[100:103], v[108:111]
    v_mfma_f32_16x16x32_bf16 v[112:115], a[92:95], v[96:99], v[112:115]
    v_mfma_f32_16x16x32_bf16 v[116:119], a[92:95], v[100:103], v[116:119]
    v_mfma_f32_16x16x32_bf16 v[120:123], a[140:143], v[96:99], v[120:123]
    v_mfma_f32_16x16x32_bf16 v[124:127], a[140:143], v[100:103], v[124:127]
    v_mfma_f32_16x16x32_bf16 v[128:131], a[188:191], v[96:99], v[128:131]
    v_mfma_f32_16x16x32_bf16 v[132:135], a[188:191], v[100:103], v[132:135]
    v_mfma_f32_16x16x32_bf16 v[136:139], a[236:239], v[96:99], v[136:139]
    v_mfma_f32_16x16x32_bf16 v[140:143], a[236:239], v[100:103], v[140:143]
    s_cmp_eq_u32 s46, 0
    s_cbranch_scc1 Lf2p_87
    buffer_load_dwordx4 v[96:99], v2, s[4:7], s30 offen offset:3072 sc1
    buffer_load_dwordx4 v[100:103], v2, s[4:7], s31 offen offset:3072 sc1
Lf2p_87:
    ds_write_b128 v153, v[104:107] offset:0
    ds_write_b128 v153, v[108:111] offset:1024
    ds_write_b128 v153, v[112:115] offset:2048
    ds_write_b128 v153, v[116:119] offset:3072
    ds_write_b128 v153, v[120:123] offset:4096
    ds_write_b128 v153, v[124:127] offset:5120
    ds_write_b128 v153, v[128:131] offset:6144
    ds_write_b128 v153, v[132:135] offset:7168
    ds_write_b128 v153, v[136:139] offset:8192
    ds_write_b128 v153, v[140:143] offset:9216
    s_waitcnt lgkmcnt(0)
    s_barrier
    s_lshl_b32 s32, s24, 5
    s_lshl_b32 s26, s40, 4
    s_add_u32 s32, s32, s26
    s_mul_i32 s32, s32, 1280
    s_mul_i32 s26, s21, 160
    s_add_u32 s32, s32, s26
    s_lshl_b32 s33, s42, 1
    s_add_u32 s33, s33, s40
    s_lshl_b32 s33, s33, 10
    v_add_u32 v3, s33, v2
    ds_read_b128 v[160:163], v3 offset:0
    ds_read_b128 v[164:167], v3 offset:10240
    ds_read_b128 v[168:171], v3 offset:20480
    ds_read_b128 v[172:175], v3 offset:30720
    s_lshl_b32 s33, s43, 1
    s_add_u32 s33, s33, s40
    s_lshl_b32 s33, s33, 10
    v_add_u32 v3, s33, v2
    ds_read_b128 v[176:179], v3 offset:0
    ds_read_b128 v[180:183], v3 offset:10240
    ds_read_b128 v[184:187], v3 offset:20480
    ds_read_b128 v[188:191], v3 offset:30720
    s_lshl_b32 s33, s44, 1
    s_add_u32 s33, s33, s40
    s_lshl_b32 s33, s33, 10
    v_add_u32 v3, s33, v2
    ds_read_b128 v[192:195], v3 offset:0
    ds_read_b128 v[196:199], v3 offset:10240
    ds_read_b128 v[200:203], v3 offset:20480
    ds_read_b128 v[204:207], v3 offset:30720
    s_waitcnt lgkmcnt(0)
    v_add_f32 v160, v160, v164
    v_add_f32 v168, v168, v172
    v_add_f32 v161, v161, v165
    v_add_f32 v169, v169, v173
    v_add_f32 v162, v162, v166
    v_add_f32 v170, v170, v174
    v_add_f32 v163, v163, v167
    v_add_f32 v171, v171, v175
    v_add_f32 v160, v160, v168
    v_add_f32 v161, v161, v169
    v_add_f32 v162, v162, v170
    v_add_f32 v163, v163, v171
    v_lshlrev_b32 v5, 16, v144
    v_and_b32 v6, 0xffff0000, v144
    v_add_f32 v160, v160, v5
    v_add_f32 v161, v161, v6
    v_lshlrev_b32 v5, 16, v145
    v_and_b32 v6, 0xffff0000, v145
    v_add_f32 v162, v162, v5
    v_add_f32 v163, v163, v6
    v_cvt_pk_bf16_f32 v164, v160, v161
    v_cvt_pk_bf16_f32 v165, v162, v163
    s_lshl_b32 s33, s42, 5
    s_add_u32 s33, s33, s32
    buffer_store_dwordx2 v[164:165], v155, s[16:19], s33 offen
    v_add_f32 v176, v176, v180
    v_add_f32 v184, v184, v188
    v_add_f32 v177, v177, v181
    v_add_f32 v185, v185, v189
    v_add_f32 v178, v178, v182
    v_add_f32 v186, v186, v190
    v_add_f32 v179, v179, v183
    v_add_f32 v187, v187, v191
    v_add_f32 v176, v176, v184
    v_add_f32 v177, v177, v185
    v_add_f32 v178, v178, v186
    v_add_f32 v179, v179, v187
    v_lshlrev_b32 v5, 16, v146
    v_and_b32 v6, 0xffff0000, v146
    v_add_f32 v176, v176, v5
    v_add_f32 v177, v177, v6
    v_lshlrev_b32 v5, 16, v147
    v_and_b32 v6, 0xffff0000, v147
    v_add_f32 v178, v178, v5
    v_add_f32 v179, v179, v6
    v_cvt_pk_bf16_f32 v180, v176, v177
    v_cvt_pk_bf16_f32 v181, v178, v179
    s_lshl_b32 s33, s43, 5
    s_add_u32 s33, s33, s32
    buffer_store_dwordx2 v[180:181], v155, s[16:19], s33 offen
    v_add_f32 v192, v192, v196
    v_add_f32 v200, v200, v204
    v_add_f32 v193, v193, v197
    v_add_f32 v201, v201, v205
    v_add_f32 v194, v194, v198
    v_add_f32 v202, v202, v206
    v_add_f32 v195, v195, v199
    v_add_f32 v203, v203, v207
    v_add_f32 v192, v192, v200
    v_add_f32 v193, v193, v201
    v_add_f32 v194, v194, v202
    v_add_f32 v195, v195, v203
    v_lshlrev_b32 v5, 16, v148
    v_and_b32 v6, 0xffff0000, v148
    v_add_f32 v192, v192, v5
    v_add_f32 v193, v193, v6
    v_lshlrev_b32 v5, 16, v149
    v_and_b32 v6, 0xffff0000, v149
    v_add_f32 v194, v194, v5
    v_add_f32 v195, v195, v6
    v_cvt_pk_bf16_f32 v196, v192, v193
    v_cvt_pk_bf16_f32 v197, v194, v195
    s_lshl_b32 s33, s44, 5
    s_add_u32 s33, s33, s32
    buffer_store_dwordx2 v[196:197], v155, s[16:19], s33 offen
    s_cmp_eq_u32 s46, 0
    s_cbranch_scc1 Lf2r_88
    s_mul_i32 s32, s47, 40960
    s_mul_i32 s26, s40, 20480
    s_add_u32 s32, s32, s26
    s_add_u32 s32, s32, 0x1000000
    s_mul_i32 s33, s21, 5
    s_add_u32 s33, s33, s42
    s_lshr_b32 s34, s33, 1
    s_lshl_b32 s34, s34, 10
    s_and_b32 s33, s33, 1
    s_lshl_b32 s33, s33, 3
    s_add_u32 s34, s34, s33
    s_add_u32 s34, s34, s32
    buffer_load_dwordx2 v[144:145], v2, s[4:7], s34 offen sc1
    s_mul_i32 s33, s21, 5
    s_add_u32 s33, s33, s43
    s_lshr_b32 s34, s33, 1
    s_lshl_b32 s34, s34, 10
    s_and_b32 s33, s33, 1
    s_lshl_b32 s33, s33, 3
    s_add_u32 s34, s34, s33
    s_add_u32 s34, s34, s32
    buffer_load_dwordx2 v[146:147], v2, s[4:7], s34 offen sc1
    s_mul_i32 s33, s21, 5
    s_add_u32 s33, s33, s44
    s_lshr_b32 s34, s33, 1
    s_lshl_b32 s34, s34, 10
    s_and_b32 s33, s33, 1
    s_lshl_b32 s33, s33, 3
    s_add_u32 s34, s34, s33
    s_add_u32 s34, s34, s32
    buffer_load_dwordx2 v[148:149], v2, s[4:7], s34 offen sc1
Lf2r_88:
    s_barrier
    s_add_u32 s24, s24, 2
    s_cmp_lt_u32 s24, 64
    s_cbranch_scc1 Lf2_loop
    s_waitcnt vmcnt(0)
    s_branch L_exit
Ld_u:
    s_load_dwordx2 s[8:9], s[0:1], 40
    s_waitcnt lgkmcnt(0)
    s_mov_b32 s10, 0x780000
    s_mov_b32 s11, 0x20000
    v_lshlrev_b32 v8, 4, v0
    v_add_u32 v3, 0, v0
    v_mul_u32_u24 v4, 0x667, v3
    v_lshrrev_b32 v4, 17, v4
    v_mul_u32_u24 v5, 80, v4
    v_sub_u32 v5, v3, v5
    v_mul_u32_u24 v9, 0x520, v4
    v_lshl_add_u32 v9, v5, 4, v9
    v_add_u32 v3, 256, v0
    v_mul_u32_u24 v4, 0x667, v3
    v_lshrrev_b32 v4, 17, v4
    v_mul_u32_u24 v5, 80, v4
    v_sub_u32 v5, v3, v5
    v_mul_u32_u24 v10, 0x520, v4
    v_lshl_add_u32 v10, v5, 4, v10
    v_add_u32 v3, 512, v0
    v_mul_u32_u24 v4, 0x667, v3
    v_lshrrev_b32 v4, 17, v4
    v_mul_u32_u24 v5, 80, v4
    v_sub_u32 v5, v3, v5
    v_mul_u32_u24 v11, 0x520, v4
    v_lshl_add_u32 v11, v5, 4, v11
    v_add_u32 v3, 768, v0
    v_mul_u32_u24 v4, 0x667, v3
    v_lshrrev_b32 v4, 17, v4
    v_mul_u32_u24 v5, 80, v4
    v_sub_u32 v5, v3, v5
    v_mul_u32_u24 v12, 0x520, v4
    v_lshl_add_u32 v12, v5, 4, v12
    v_add_u32 v3, 1024, v0
    v_mul_u32_u24 v4, 0x667, v3
    v_lshrrev_b32 v4, 17, v4
    v_mul_u32_u24 v5, 80, v4
    v_sub_u32 v5, v3, v5
    v_mul_u32_u24 v13, 0x520, v4
    v_lshl_add_u32 v13, v5, 4, v13
    v_and_b32 v3, 15, v1
    v_lshrrev_b32 v4, 4, v1
    v_lshrrev_b32 v5, 2, v3
    v_lshl_add_u32 v5, v4, 2, v5
    v_mul_u32_u24 v14, 0x520, v5
    v_and_b32 v3, 3, v3
    v_lshl_add_u32 v14, v3, 3, v14
    s_mul_i32 s26, s20, 320
    v_add_u32 v14, s26, v14
    s_mul_i32 s25, s21, 245760
    buffer_load_dwordx4 v[24:27], v8, s[8:11], s25 offen
    s_add_u32 s25, s25, 4096
    buffer_load_dwordx4 v[28:31], v8, s[8:11], s25 offen
    s_add_u32 s25, s25, 4096
    buffer_load_dwordx4 v[32:35], v8, s[8:11], s25 offen
    s_add_u32 s25, s25, 4096
    buffer_load_dwordx4 v[36:39], v8, s[8:11], s25 offen
    s_add_u32 s25, s25, 4096
    buffer_load_dwordx4 v[40:43], v8, s[8:11], s25 offen
    s_add_u32 s25, s25, 4096
    buffer_load_dwordx4 v[44:47], v8, s[8:11], s25 offen
    s_add_u32 s25, s25, 4096
    buffer_load_dwordx4 v[48:51], v8, s[8:11], s25 offen
    s_add_u32 s25, s25, 4096
    buffer_load_dwordx4 v[52:55], v8, s[8:11], s25 offen
    s_add_u32 s25, s25, 4096
    buffer_load_dwordx4 v[56:59], v8, s[8:11], s25 offen
    s_add_u32 s25, s25, 4096
    buffer_load_dwordx4 v[60:63], v8, s[8:11], s25 offen
    s_add_u32 s25, s25, 4096
    buffer_load_dwordx4 v[64:67], v8, s[8:11], s25 offen
    s_add_u32 s25, s25, 4096
    buffer_load_dwordx4 v[68:71], v8, s[8:11], s25 offen
    s_add_u32 s25, s25, 4096
    buffer_load_dwordx4 v[72:75], v8, s[8:11], s25 offen
    s_add_u32 s25, s25, 4096
    buffer_load_dwordx4 v[76:79], v8, s[8:11], s25 offen
    s_add_u32 s25, s25, 4096
    buffer_load_dwordx4 v[80:83], v8, s[8:11], s25 offen
    s_add_u32 s25, s25, 4096
    s_waitcnt vmcnt(10)
    ds_write_b128 v9, v[24:27] offset:0
    ds_write_b128 v10, v[28:31] offset:0
    ds_write_b128 v11, v[32:35] offset:0
    ds_write_b128 v12, v[36:39] offset:0
    ds_write_b128 v13, v[40:43] offset:0
    s_waitcnt lgkmcnt(0)
    buffer_load_dwordx4 v[24:27], v8, s[8:11], s25 offen
    s_add_u32 s25, s25, 4096
    buffer_load_dwordx4 v[28:31], v8, s[8:11], s25 offen
    s_add_u32 s25, s25, 4096
    buffer_load_dwordx4 v[32:35], v8, s[8:11], s25 offen
    s_add_u32 s25, s25, 4096
    buffer_load_dwordx4 v[36:39], v8, s[8:11], s25 offen
    s_add_u32 s25, s25, 4096
    buffer_load_dwordx4 v[40:43], v8, s[8:11], s25 offen
    s_add_u32 s25, s25, 4096
    s_barrier
    ds_read_b64_tr_b16 a[0:1], v14 offset:0
    ds_read_b64_tr_b16 a[24:25], v14 offset:32
    ds_read_b64_tr_b16 a[48:49], v14 offset:64
    ds_read_b64_tr_b16 a[72:73], v14 offset:96
    ds_read_b64_tr_b16 a[96:97], v14 offset:128
    ds_read_b64_tr_b16 a[120:121], v14 offset:160
    ds_read_b64_tr_b16 a[144:145], v14 offset:192
    ds_read_b64_tr_b16 a[168:169], v14 offset:224
    ds_read_b64_tr_b16 a[192:193], v14 offset:256
    ds_read_b64_tr_b16 a[216:217], v14 offset:288
    s_waitcnt vmcnt(10)
    ds_write_b128 v9, v[44:47] offset:20992
    ds_write_b128 v10, v[48:51] offset:20992
    ds_write_b128 v11, v[52:55] offset:20992
    ds_write_b128 v12, v[56:59] offset:20992
    ds_write_b128 v13, v[60:63] offset:20992
    s_waitcnt lgkmcnt(0)
    buffer_load_dwordx4 v[44:47], v8, s[8:11], s25 offen
    s_add_u32 s25, s25, 4096
    buffer_load_dwordx4 v[48:51], v8, s[8:11], s25 offen
    s_add_u32 s25, s25, 4096
    buffer_load_dwordx4 v[52:55], v8, s[8:11], s25 offen
    s_add_u32 s25, s25, 4096
    buffer_load_dwordx4 v[56:59], v8, s[8:11], s25 offen
    s_add_u32 s25, s25, 4096
    buffer_load_dwordx4 v[60:63], v8, s[8:11], s25 offen
    s_add_u32 s25, s25, 4096
    s_barrier
    ds_read_b64_tr_b16 a[2:3], v14 offset:20992
    ds_read_b64_tr_b16 a[26:27], v14 offset:21024
    ds_read_b64_tr_b16 a[50:51], v14 offset:21056
    ds_read_b64_tr_b16 a[74:75], v14 offset:21088
    ds_read_b64_tr_b16 a[98:99], v14 offset:21120
    ds_read_b64_tr_b16 a[122:123], v14 offset:21152
    ds_read_b64_tr_b16 a[146:147], v14 offset:21184
    ds_read_b64_tr_b16 a[170:171], v14 offset:21216
    ds_read_b64_tr_b16 a[194:195], v14 offset:21248
    ds_read_b64_tr_b16 a[218:219], v14 offset:21280
    s_waitcnt vmcnt(10)
    ds_write_b128 v9, v[64:67] offset:0
    ds_write_b128 v10, v[68:71] offset:0
    ds_write_b128 v11, v[72:75] offset:0
    ds_write_b128 v12, v[76:79] offset:0
    ds_write_b128 v13, v[80:83] offset:0
    s_waitcnt lgkmcnt(0)
    buffer_load_dwordx4 v[64:67], v8, s[8:11], s25 offen
    s_add_u32 s25, s25, 4096
    buffer_load_dwordx4 v[68:71], v8, s[8:11], s25 offen
    s_add_u32 s25, s25, 4096
    buffer_load_dwordx4 v[72:75], v8, s[8:11], s25 offen
    s_add_u32 s25, s25, 4096
    buffer_load_dwordx4 v[76:79], v8, s[8:11], s25 offen
    s_add_u32 s25, s25, 4096
    buffer_load_dwordx4 v[80:83], v8, s[8:11], s25 offen
    s_add_u32 s25, s25, 4096
    s_barrier
    ds_read_b64_tr_b16 a[16:17], v14 offset:0
    ds_read_b64_tr_b16 a[40:41], v14 offset:32
    ds_read_b64_tr_b16 a[64:65], v14 offset:64
    ds_read_b64_tr_b16 a[88:89], v14 offset:96
    ds_read_b64_tr_b16 a[112:113], v14 offset:128
    ds_read_b64_tr_b16 a[136:137], v14 offset:160
    ds_read_b64_tr_b16 a[160:161], v14 offset:192
    ds_read_b64_tr_b16 a[184:185], v14 offset:224
    ds_read_b64_tr_b16 a[208:209], v14 offset:256
    ds_read_b64_tr_b16 a[232:233], v14 offset:288
    s_waitcnt vmcnt(10)
    ds_write_b128 v9, v[24:27] offset:20992
    ds_write_b128 v10, v[28:31] offset:20992
    ds_write_b128 v11, v[32:35] offset:20992
    ds_write_b128 v12, v[36:39] offset:20992
    ds_write_b128 v13, v[40:43] offset:20992
    s_waitcnt lgkmcnt(0)
    buffer_load_dwordx4 v[24:27], v8, s[8:11], s25 offen
    s_add_u32 s25, s25, 4096
    buffer_load_dwordx4 v[28:31], v8, s[8:11], s25 offen
    s_add_u32 s25, s25, 4096
    buffer_load_dwordx4 v[32:35], v8, s[8:11], s25 offen
    s_add_u32 s25, s25, 4096
    buffer_load_dwordx4 v[36:39], v8, s[8:11], s25 offen
    s_add_u32 s25, s25, 4096
    buffer_load_dwordx4 v[40:43], v8, s[8:11], s25 offen
    s_add_u32 s25, s25, 4096
    s_barrier
    ds_read_b64_tr_b16 a[4:5], v14 offset:20992
    ds_read_b64_tr_b16 a[28:29], v14 offset:21024
    ds_read_b64_tr_b16 a[52:53], v14 offset:21056
    ds_read_b64_tr_b16 a[76:77], v14 offset:21088
    ds_read_b64_tr_b16 a[100:101], v14 offset:21120
    ds_read_b64_tr_b16 a[124:125], v14 offset:21152
    ds_read_b64_tr_b16 a[148:149], v14 offset:21184
    ds_read_b64_tr_b16 a[172:173], v14 offset:21216
    ds_read_b64_tr_b16 a[196:197], v14 offset:21248
    ds_read_b64_tr_b16 a[220:221], v14 offset:21280
    s_waitcnt vmcnt(10)
    ds_write_b128 v9, v[44:47] offset:0
    ds_write_b128 v10, v[48:51] offset:0
    ds_write_b128 v11, v[52:55] offset:0
    ds_write_b128 v12, v[56:59] offset:0
    ds_write_b128 v13, v[60:63] offset:0
    s_waitcnt lgkmcnt(0)
    buffer_load_dwordx4 v[44:47], v8, s[8:11], s25 offen
    s_add_u32 s25, s25, 4096
    buffer_load_dwordx4 v[48:51], v8, s[8:11], s25 offen
    s_add_u32 s25, s25, 4096
    buffer_load_dwordx4 v[52:55], v8, s[8:11], s25 offen
    s_add_u32 s25, s25, 4096
    buffer_load_dwordx4 v[56:59], v8, s[8:11], s25 offen
    s_add_u32 s25, s25, 4096
    buffer_load_dwordx4 v[60:63], v8, s[8:11], s25 offen
    s_add_u32 s25, s25, 4096
    s_barrier
    ds_read_b64_tr_b16 a[6:7], v14 offset:0
    ds_read_b64_tr_b16 a[30:31], v14 offset:32
    ds_read_b64_tr_b16 a[54:55], v14 offset:64
    ds_read_b64_tr_b16 a[78:79], v14 offset:96
    ds_read_b64_tr_b16 a[102:103], v14 offset:128
    ds_read_b64_tr_b16 a[126:127], v14 offset:160
    ds_read_b64_tr_b16 a[150:151], v14 offset:192
    ds_read_b64_tr_b16 a[174:175], v14 offset:224
    ds_read_b64_tr_b16 a[198:199], v14 offset:256
    ds_read_b64_tr_b16 a[222:223], v14 offset:288
    s_waitcnt vmcnt(10)
    ds_write_b128 v9, v[64:67] offset:20992
    ds_write_b128 v10, v[68:71] offset:20992
    ds_write_b128 v11, v[72:75] offset:20992
    ds_write_b128 v12, v[76:79] offset:20992
    ds_write_b128 v13, v[80:83] offset:20992
    s_waitcnt lgkmcnt(0)
    buffer_load_dwordx4 v[64:67], v8, s[8:11], s25 offen
    s_add_u32 s25, s25, 4096
    buffer_load_dwordx4 v[68:71], v8, s[8:11], s25 offen
    s_add_u32 s25, s25, 4096
    buffer_load_dwordx4 v[72:75], v8, s[8:11], s25 offen
    s_add_u32 s25, s25, 4096
    buffer_load_dwordx4 v[76:79], v8, s[8:11], s25 offen
    s_add_u32 s25, s25, 4096
    buffer_load_dwordx4 v[80:83], v8, s[8:11], s25 offen
    s_add_u32 s25, s25, 4096
    s_barrier
    ds_read_b64_tr_b16 a[18:19], v14 offset:20992
    ds_read_b64_tr_b16 a[42:43], v14 offset:21024
    ds_read_b64_tr_b16 a[66:67], v14 offset:21056
    ds_read_b64_tr_b16 a[90:91], v14 offset:21088
    ds_read_b64_tr_b16 a[114:115], v14 offset:21120
    ds_read_b64_tr_b16 a[138:139], v14 offset:21152
    ds_read_b64_tr_b16 a[162:163], v14 offset:21184
    ds_read_b64_tr_b16 a[186:187], v14 offset:21216
    ds_read_b64_tr_b16 a[210:211], v14 offset:21248
    ds_read_b64_tr_b16 a[234:235], v14 offset:21280
    s_waitcnt vmcnt(10)
    ds_write_b128 v9, v[24:27] offset:0
    ds_write_b128 v10, v[28:31] offset:0
    ds_write_b128 v11, v[32:35] offset:0
    ds_write_b128 v12, v[36:39] offset:0
    ds_write_b128 v13, v[40:43] offset:0
    s_waitcnt lgkmcnt(0)
    buffer_load_dwordx4 v[24:27], v8, s[8:11], s25 offen
    s_add_u32 s25, s25, 4096
    buffer_load_dwordx4 v[28:31], v8, s[8:11], s25 offen
    s_add_u32 s25, s25, 4096
    buffer_load_dwordx4 v[32:35], v8, s[8:11], s25 offen
    s_add_u32 s25, s25, 4096
    buffer_load_dwordx4 v[36:39], v8, s[8:11], s25 offen
    s_add_u32 s25, s25, 4096
    buffer_load_dwordx4 v[40:43], v8, s[8:11], s25 offen
    s_add_u32 s25, s25, 4096
    s_barrier
    ds_read_b64_tr_b16 a[8:9], v14 offset:0
    ds_read_b64_tr_b16 a[32:33], v14 offset:32
    ds_read_b64_tr_b16 a[56:57], v14 offset:64
    ds_read_b64_tr_b16 a[80:81], v14 offset:96
    ds_read_b64_tr_b16 a[104:105], v14 offset:128
    ds_read_b64_tr_b16 a[128:129], v14 offset:160
    ds_read_b64_tr_b16 a[152:153], v14 offset:192
    ds_read_b64_tr_b16 a[176:177], v14 offset:224
    ds_read_b64_tr_b16 a[200:201], v14 offset:256
    ds_read_b64_tr_b16 a[224:225], v14 offset:288
    s_waitcnt vmcnt(10)
    ds_write_b128 v9, v[44:47] offset:20992
    ds_write_b128 v10, v[48:51] offset:20992
    ds_write_b128 v11, v[52:55] offset:20992
    ds_write_b128 v12, v[56:59] offset:20992
    ds_write_b128 v13, v[60:63] offset:20992
    s_waitcnt lgkmcnt(0)
    buffer_load_dwordx4 v[44:47], v8, s[8:11], s25 offen
    s_add_u32 s25, s25, 4096
    buffer_load_dwordx4 v[48:51], v8, s[8:11], s25 offen
    s_add_u32 s25, s25, 4096
    buffer_load_dwordx4 v[52:55], v8, s[8:11], s25 offen
    s_add_u32 s25, s25, 4096
    buffer_load_dwordx4 v[56:59], v8, s[8:11], s25 offen
    s_add_u32 s25, s25, 4096
    buffer_load_dwordx4 v[60:63], v8, s[8:11], s25 offen
    s_add_u32 s25, s25, 4096
    s_barrier
    ds_read_b64_tr_b16 a[10:11], v14 offset:20992
    ds_read_b64_tr_b16 a[34:35], v14 offset:21024
    ds_read_b64_tr_b16 a[58:59], v14 offset:21056
    ds_read_b64_tr_b16 a[82:83], v14 offset:21088
    ds_read_b64_tr_b16 a[106:107], v14 offset:21120
    ds_read_b64_tr_b16 a[130:131], v14 offset:21152
    ds_read_b64_tr_b16 a[154:155], v14 offset:21184
    ds_read_b64_tr_b16 a[178:179], v14 offset:21216
    ds_read_b64_tr_b16 a[202:203], v14 offset:21248
    ds_read_b64_tr_b16 a[226:227], v14 offset:21280
    s_waitcnt vmcnt(10)
    ds_write_b128 v9, v[64:67] offset:0
    ds_write_b128 v10, v[68:71] offset:0
    ds_write_b128 v11, v[72:75] offset:0
    ds_write_b128 v12, v[76:79] offset:0
    ds_write_b128 v13, v[80:83] offset:0
    s_waitcnt lgkmcnt(0)
    buffer_load_dwordx4 v[64:67], v8, s[8:11], s25 offen
    s_add_u32 s25, s25, 4096
    buffer_load_dwordx4 v[68:71], v8, s[8:11], s25 offen
    s_add_u32 s25, s25, 4096
    buffer_load_dwordx4 v[72:75], v8, s[8:11], s25 offen
    s_add_u32 s25, s25, 4096
    buffer_load_dwordx4 v[76:79], v8, s[8:11], s25 offen
    s_add_u32 s25, s25, 4096
    buffer_load_dwordx4 v[80:83], v8, s[8:11], s25 offen
    s_add_u32 s25, s25, 4096
    s_barrier
    ds_read_b64_tr_b16 a[20:21], v14 offset:0
    ds_read_b64_tr_b16 a[44:45], v14 offset:32
    ds_read_b64_tr_b16 a[68:69], v14 offset:64
    ds_read_b64_tr_b16 a[92:93], v14 offset:96
    ds_read_b64_tr_b16 a[116:117], v14 offset:128
    ds_read_b64_tr_b16 a[140:141], v14 offset:160
    ds_read_b64_tr_b16 a[164:165], v14 offset:192
    ds_read_b64_tr_b16 a[188:189], v14 offset:224
    ds_read_b64_tr_b16 a[212:213], v14 offset:256
    ds_read_b64_tr_b16 a[236:237], v14 offset:288
    s_waitcnt vmcnt(10)
    ds_write_b128 v9, v[24:27] offset:20992
    ds_write_b128 v10, v[28:31] offset:20992
    ds_write_b128 v11, v[32:35] offset:20992
    ds_write_b128 v12, v[36:39] offset:20992
    ds_write_b128 v13, v[40:43] offset:20992
    s_waitcnt lgkmcnt(0)
    s_barrier
    ds_read_b64_tr_b16 a[12:13], v14 offset:20992
    ds_read_b64_tr_b16 a[36:37], v14 offset:21024
    ds_read_b64_tr_b16 a[60:61], v14 offset:21056
    ds_read_b64_tr_b16 a[84:85], v14 offset:21088
    ds_read_b64_tr_b16 a[108:109], v14 offset:21120
    ds_read_b64_tr_b16 a[132:133], v14 offset:21152
    ds_read_b64_tr_b16 a[156:157], v14 offset:21184
    ds_read_b64_tr_b16 a[180:181], v14 offset:21216
    ds_read_b64_tr_b16 a[204:205], v14 offset:21248
    ds_read_b64_tr_b16 a[228:229], v14 offset:21280
    s_waitcnt vmcnt(5)
    ds_write_b128 v9, v[44:47] offset:0
    ds_write_b128 v10, v[48:51] offset:0
    ds_write_b128 v11, v[52:55] offset:0
    ds_write_b128 v12, v[56:59] offset:0
    ds_write_b128 v13, v[60:63] offset:0
    s_waitcnt lgkmcnt(0)
    s_barrier
    ds_read_b64_tr_b16 a[14:15], v14 offset:0
    ds_read_b64_tr_b16 a[38:39], v14 offset:32
    ds_read_b64_tr_b16 a[62:63], v14 offset:64
    ds_read_b64_tr_b16 a[86:87], v14 offset:96
    ds_read_b64_tr_b16 a[110:111], v14 offset:128
    ds_read_b64_tr_b16 a[134:135], v14 offset:160
    ds_read_b64_tr_b16 a[158:159], v14 offset:192
    ds_read_b64_tr_b16 a[182:183], v14 offset:224
    ds_read_b64_tr_b16 a[206:207], v14 offset:256
    ds_read_b64_tr_b16 a[230:231], v14 offset:288
    s_waitcnt vmcnt(0)
    ds_write_b128 v9, v[64:67] offset:20992
    ds_write_b128 v10, v[68:71] offset:20992
    ds_write_b128 v11, v[72:75] offset:20992
    ds_write_b128 v12, v[76:79] offset:20992
    ds_write_b128 v13, v[80:83] offset:20992
    s_waitcnt lgkmcnt(0)
    s_barrier
    ds_read_b64_tr_b16 a[22:23], v14 offset:20992
    ds_read_b64_tr_b16 a[46:47], v14 offset:21024
    ds_read_b64_tr_b16 a[70:71], v14 offset:21056
    ds_read_b64_tr_b16 a[94:95], v14 offset:21088
    ds_read_b64_tr_b16 a[118:119], v14 offset:21120
    ds_read_b64_tr_b16 a[142:143], v14 offset:21152
    ds_read_b64_tr_b16 a[166:167], v14 offset:21184
    ds_read_b64_tr_b16 a[190:191], v14 offset:21216
    ds_read_b64_tr_b16 a[214:215], v14 offset:21248
    ds_read_b64_tr_b16 a[238:239], v14 offset:21280
    s_waitcnt lgkmcnt(0)
    s_barrier
    v_mov_b32 v193, 0
    s_lshl_b32 s31, s21, 7
    s_add_u32 s33, s31, 4096
    s_add_u32 s31, s31, 8192
    s_mov_b32 s38, s33
    s_mul_i32 s34, s21, 12288
    s_mul_i32 s33, s20, 3072
    s_add_u32 s34, s34, s33
    s_add_u32 s34, s34, 0x5b00000
    s_mul_i32 s39, s20, 3072
    s_mul_i32 s30, s21, 40960
    s_mul_i32 s33, s20, 10240
    s_add_u32 s30, s30, s33
    s_add_u32 s30, s30, 0x7400000
    v_mov_b32 v4, 4
Lwi_89:
    buffer_load_dword v5, v4, s[88:91], 0 offen sc1
    s_waitcnt vmcnt(0)
    v_cmp_gt_u32 vcc, 224, v5
    s_cbranch_vccz Lwid_90
    s_sub_u32 s101, s101, 1
    s_cbranch_scc1 L_abort
    s_sleep 8
    s_branch Lwi_89
Lwid_90:
    s_mov_b32 s33, 1
Lw_91:
    buffer_load_dword v195, v193, s[4:7], s38 offen sc1
    s_waitcnt vmcnt(0)
    v_cmp_gt_u32 vcc, s33, v195
    s_cbranch_vccz Lwd_92
    s_sub_u32 s101, s101, 1
    s_cbranch_scc1 L_abort
    s_sleep 4
    s_branch Lw_91
Lwd_92:
    s_mov_b32 m0, s39
    s_nop 0
    buffer_load_dwordx4 v2, s[4:7], s34 offen offset:0 sc1 lds
    buffer_load_dwordx4 v2, s[4:7], s34 offen offset:1024 sc1 lds
    buffer_load_dwordx4 v2, s[4:7], s34 offen offset:2048 sc1 lds
    s_mov_b32 s24, 0
    v_mov_b32 v195, 0
    s_waitcnt vmcnt(0)
Lu_loop:
    s_cmp_lt_u32 s24, 4
    s_cbranch_scc1 Lts_93
    s_waitcnt vmcnt(10)
    s_sub_u32 s32, s24, 1
    s_branch Lts_94
Lts_93:
    s_waitcnt vmcnt(0)
    s_mov_b32 s32, s24
Lts_94:
    s_barrier
    s_cmp_lg_u32 s20, 0
    s_cbranch_scc1 Lts_95
    v_mov_b32 v194, s32
    s_mov_b64 exec, 1
    buffer_store_dword v194, v193, s[4:7], s31 offen sc1
    s_mov_b64 exec, -1
Lts_95:
    s_add_u32 s32, s24, 2
    s_min_u32 s33, s32, 64
    v_readfirstlane_b32 s35, v195
    s_cmp_ge_u32 s35, s33
    s_cbranch_scc1 Lu_ok_96
Lw_97:
    buffer_load_dword v195, v193, s[4:7], s38 offen sc1
    s_waitcnt vmcnt(0)
    v_cmp_gt_u32 vcc, s33, v195
    s_cbranch_vccz Lwd_98
    s_sub_u32 s101, s101, 1
    s_cbranch_scc1 L_abort
    s_sleep 4
    s_branch Lw_97
Lwd_98:
Lu_ok_96:
    buffer_load_dword v195, v193, s[4:7], s38 offen sc1
    s_add_u32 s32, s24, 1
    s_min_u32 s33, s32, 63
    s_mul_i32 s35, s33, 393216
    s_add_u32 s35, s35, s34
    s_and_b32 s32, s32, 1
    s_mul_i32 s37, s32, 12288
    s_add_u32 s37, s37, s39
    s_mov_b32 m0, s37
    s_nop 0
    buffer_load_dwordx4 v2, s[4:7], s35 offen offset:0 sc1 lds
    buffer_load_dwordx4 v2, s[4:7], s35 offen offset:1024 sc1 lds
    buffer_load_dwordx4 v2, s[4:7], s35 offen offset:2048 sc1 lds
    s_and_b32 s32, s24, 1
    s_mul_i32 s32, s32, 12288
    v_add_u32 v192, s32, v2
    ds_read_b128 v[24:27], v192 offset:0
    ds_read_b128 v[48:51], v192 offset:1024
    ds_read_b128 v[28:31], v192 offset:3072
    ds_read_b128 v[52:55], v192 offset:4096
    ds_read_b128 v[32:35], v192 offset:6144
    ds_read_b128 v[56:59], v192 offset:7168
    ds_read_b128 v[36:39], v192 offset:9216
    ds_read_b128 v[60:63], v192 offset:10240
    ds_read_b64 v[40:41], v192 offset:2048
    ds_read_b64 v[42:43], v192 offset:5120
    ds_read_b64 v[64:65], v192 offset:2056
    ds_read_b64 v[66:67], v192 offset:5128
    ds_read_b64 v[44:45], v192 offset:8192
    ds_read_b64 v[46:47], v192 offset:11264
    ds_read_b64 v[68:69], v192 offset:8200
    ds_read_b64 v[70:71], v192 offset:11272
    s_mul_i32 s32, s24, 1310720
    s_add_u32 s32, s32, s30
    s_add_u32 s35, s32, 4096
    s_add_u32 s36, s32, 8192
    s_waitcnt lgkmcnt(14)
    v_mfma_f32_16x16x32_bf16 v[72:75], v[24:27], a[0:3], 0
    v_mfma_f32_16x16x32_bf16 v[92:95], v[48:51], a[0:3], 0
    v_mfma_f32_16x16x32_bf16 v[76:79], v[24:27], a[24:27], 0
    v_mfma_f32_16x16x32_bf16 v[96:99], v[48:51], a[24:27], 0
    v_mfma_f32_16x16x32_bf16 v[80:83], v[24:27], a[48:51], 0
    v_mfma_f32_16x16x32_bf16 v[100:103], v[48:51], a[48:51], 0
    v_mfma_f32_16x16x32_bf16 v[84:87], v[24:27], a[72:75], 0
    v_mfma_f32_16x16x32_bf16 v[104:107], v[48:51], a[72:75], 0
    v_mfma_f32_16x16x32_bf16 v[88:91], v[24:27], a[96:99], 0
    v_mfma_f32_16x16x32_bf16 v[108:111], v[48:51], a[96:99], 0
    s_waitcnt lgkmcnt(12)
    v_mfma_f32_16x16x32_bf16 v[72:75], v[28:31], a[4:7], v[72:75]
    v_mfma_f32_16x16x32_bf16 v[92:95], v[52:55], a[4:7], v[92:95]
    v_mfma_f32_16x16x32_bf16 v[76:79], v[28:31], a[28:31], v[76:79]
    v_mfma_f32_16x16x32_bf16 v[96:99], v[52:55], a[28:31], v[96:99]
    v_mfma_f32_16x16x32_bf16 v[80:83], v[28:31], a[52:55], v[80:83]
    v_mfma_f32_16x16x32_bf16 v[100:103], v[52:55], a[52:55], v[100:103]
    v_mfma_f32_16x16x32_bf16 v[84:87], v[28:31], a[76:79], v[84:87]
    v_mfma_f32_16x16x32_bf16 v[104:107], v[52:55], a[76:79], v[104:107]
    v_mfma_f32_16x16x32_bf16 v[88:91], v[28:31], a[100:103], v[88:91]
    v_mfma_f32_16x16x32_bf16 v[108:111], v[52:55], a[100:103], v[108:111]
    s_waitcnt lgkmcnt(10)
    v_mfma_f32_16x16x32_bf16 v[72:75], v[32:35], a[8:11], v[72:75]
    v_mfma_f32_16x16x32_bf16 v[92:95], v[56:59], a[8:11], v[92:95]
    v_mfma_f32_16x16x32_bf16 v[76:79], v[32:35], a[32:35], v[76:79]
    v_mfma_f32_16x16x32_bf16 v[96:99], v[56:59], a[32:35], v[96:99]
    v_mfma_f32_16x16x32_bf16 v[80:83], v[32:35], a[56:59], v[80:83]
    v_mfma_f32_16x16x32_bf16 v[100:103], v[56:59], a[56:59], v[100:103]
    v_mfma_f32_16x16x32_bf16 v[84:87], v[32:35], a[80:83], v[84:87]
    v_mfma_f32_16x16x32_bf16 v[104:107], v[56:59], a[80:83], v[104:107]
    v_mfma_f32_16x16x32_bf16 v[88:91], v[32:35], a[104:107], v[88:91]
    v_mfma_f32_16x16x32_bf16 v[108:111], v[56:59], a[104:107], v[108:111]
    s_waitcnt lgkmcnt(8)
    v_mfma_f32_16x16x32_bf16 v[72:75], v[36:39], a[12:15], v[72:75]
    v_mfma_f32_16x16x32_bf16 v[92:95], v[60:63], a[12:15], v[92:95]
    v_mfma_f32_16x16x32_bf16 v[76:79], v[36:39], a[36:39], v[76:79]
    v_mfma_f32_16x16x32_bf16 v[96:99], v[60:63], a[36:39], v[96:99]
    v_mfma_f32_16x16x32_bf16 v[80:83], v[36:39], a[60:63], v[80:83]
    v_mfma_f32_16x16x32_bf16 v[100:103], v[60:63], a[60:63], v[100:103]
    v_mfma_f32_16x16x32_bf16 v[84:87], v[36:39], a[84:87], v[84:87]
    v_mfma_f32_16x16x32_bf16 v[104:107], v[60:63], a[84:87], v[104:107]
    v_mfma_f32_16x16x32_bf16 v[88:91], v[36:39], a[108:111], v[88:91]
    v_mfma_f32_16x16x32_bf16 v[108:111], v[60:63], a[108:111], v[108:111]
    s_waitcnt lgkmcnt(4)
    v_mfma_f32_16x16x32_bf16 v[72:75], v[40:43], a[16:19], v[72:75]
    v_mfma_f32_16x16x32_bf16 v[92:95], v[64:67], a[16:19], v[92:95]
    v_mfma_f32_16x16x32_bf16 v[76:79], v[40:43], a[40:43], v[76:79]
    v_mfma_f32_16x16x32_bf16 v[96:99], v[64:67], a[40:43], v[96:99]
    v_mfma_f32_16x16x32_bf16 v[80:83], v[40:43], a[64:67], v[80:83]
    v_mfma_f32_16x16x32_bf16 v[100:103], v[64:67], a[64:67], v[100:103]
    v_mfma_f32_16x16x32_bf16 v[84:87], v[40:43], a[88:91], v[84:87]
    v_mfma_f32_16x16x32_bf16 v[104:107], v[64:67], a[88:91], v[104:107]
    v_mfma_f32_16x16x32_bf16 v[88:91], v[40:43], a[112:115], v[88:91]
    v_mfma_f32_16x16x32_bf16 v[108:111], v[64:67], a[112:115], v[108:111]
    s_waitcnt lgkmcnt(0)
    v_mfma_f32_16x16x32_bf16 v[72:75], v[44:47], a[20:23], v[72:75]
    v_mfma_f32_16x16x32_bf16 v[92:95], v[68:71], a[20:23], v[92:95]
    v_mfma_f32_16x16x32_bf16 v[76:79], v[44:47], a[44:47], v[76:79]
    v_mfma_f32_16x16x32_bf16 v[96:99], v[68:71], a[44:47], v[96:99]
    v_mfma_f32_16x16x32_bf16 v[80:83], v[44:47], a[68:71], v[80:83]
    v_mfma_f32_16x16x32_bf16 v[100:103], v[68:71], a[68:71], v[100:103]
    v_mfma_f32_16x16x32_bf16 v[84:87], v[44:47], a[92:95], v[84:87]
    v_mfma_f32_16x16x32_bf16 v[104:107], v[68:71], a[92:95], v[104:107]
    v_mfma_f32_16x16x32_bf16 v[88:91], v[44:47], a[116:119], v[88:91]
    v_mfma_f32_16x16x32_bf16 v[108:111], v[68:71], a[116:119], v[108:111]
    v_mfma_f32_16x16x32_bf16 v[112:115], v[24:27], a[120:123], 0
    v_mfma_f32_16x16x32_bf16 v[132:135], v[48:51], a[120:123], 0
    v_mfma_f32_16x16x32_bf16 v[116:119], v[24:27], a[144:147], 0
    v_mfma_f32_16x16x32_bf16 v[136:139], v[48:51], a[144:147], 0
    v_mfma_f32_16x16x32_bf16 v[120:123], v[24:27], a[168:171], 0
    v_mfma_f32_16x16x32_bf16 v[140:143], v[48:51], a[168:171], 0
    v_mfma_f32_16x16x32_bf16 v[124:127], v[24:27], a[192:195], 0
    v_mfma_f32_16x16x32_bf16 v[144:147], v[48:51], a[192:195], 0
    v_mfma_f32_16x16x32_bf16 v[128:131], v[24:27], a[216:219], 0
    v_mfma_f32_16x16x32_bf16 v[148:151], v[48:51], a[216:219], 0
    v_mfma_f32_16x16x32_bf16 v[112:115], v[28:31], a[124:127], v[112:115]
    v_mfma_f32_16x16x32_bf16 v[132:135], v[52:55], a[124:127], v[132:135]
    v_mfma_f32_16x16x32_bf16 v[116:119], v[28:31], a[148:151], v[116:119]
    v_mfma_f32_16x16x32_bf16 v[136:139], v[52:55], a[148:151], v[136:139]
    v_mfma_f32_16x16x32_bf16 v[120:123], v[28:31], a[172:175], v[120:123]
    v_mfma_f32_16x16x32_bf16 v[140:143], v[52:55], a[172:175], v[140:143]
    v_mfma_f32_16x16x32_bf16 v[124:127], v[28:31], a[196:199], v[124:127]
    v_mfma_f32_16x16x32_bf16 v[144:147], v[52:55], a[196:199], v[144:147]
    v_mfma_f32_16x16x32_bf16 v[128:131], v[28:31], a[220:223], v[128:131]
    v_mfma_f32_16x16x32_bf16 v[148:151], v[52:55], a[220:223], v[148:151]
    v_cvt_pk_bf16_f32 v152, v72, v73
    v_cvt_pk_bf16_f32 v153, v92, v93
    v_cvt_pk_bf16_f32 v154, v74, v75
    v_cvt_pk_bf16_f32 v155, v94, v95
    buffer_store_dwordx4 v[152:155], v2, s[4:7], s32 offen offset:0 sc1
    v_mfma_f32_16x16x32_bf16 v[112:115], v[32:35], a[128:131], v[112:115]
    v_mfma_f32_16x16x32_bf16 v[132:135], v[56:59], a[128:131], v[132:135]
    v_mfma_f32_16x16x32_bf16 v[116:119], v[32:35], a[152:155], v[116:119]
    v_mfma_f32_16x16x32_bf16 v[136:139], v[56:59], a[152:155], v[136:139]
    v_mfma_f32_16x16x32_bf16 v[120:123], v[32:35], a[176:179], v[120:123]
    v_mfma_f32_16x16x32_bf16 v[140:143], v[56:59], a[176:179], v[140:143]
    v_mfma_f32_16x16x32_bf16 v[124:127], v[32:35], a[200:203], v[124:127]
    v_mfma_f32_16x16x32_bf16 v[144:147], v[56:59], a[200:203], v[144:147]
    v_mfma_f32_16x16x32_bf16 v[128:131], v[32:35], a[224:227], v[128:131]
    v_mfma_f32_16x16x32_bf16 v[148:151], v[56:59], a[224:227], v[148:151]
    v_cvt_pk_bf16_f32 v156, v76, v77
    v_cvt_pk_bf16_f32 v157, v96, v97
    v_cvt_pk_bf16_f32 v158, v78, v79
    v_cvt_pk_bf16_f32 v159, v98, v99
    buffer_store_dwordx4 v[156:159], v2, s[4:7], s32 offen offset:1024 sc1
    v_mfma_f32_16x16x32_bf16 v[112:115], v[36:39], a[132:135], v[112:115]
    v_mfma_f32_16x16x32_bf16 v[132:135], v[60:63], a[132:135], v[132:135]
    v_mfma_f32_16x16x32_bf16 v[116:119], v[36:39], a[156:159], v[116:119]
    v_mfma_f32_16x16x32_bf16 v[136:139], v[60:63], a[156:159], v[136:139]
    v_mfma_f32_16x16x32_bf16 v[120:123], v[36:39], a[180:183], v[120:123]
    v_mfma_f32_16x16x32_bf16 v[140:143], v[60:63], a[180:183], v[140:143]
    v_mfma_f32_16x16x32_bf16 v[124:127], v[36:39], a[204:207], v[124:127]
    v_mfma_f32_16x16x32_bf16 v[144:147], v[60:63], a[204:207], v[144:147]
    v_mfma_f32_16x16x32_bf16 v[128:131], v[36:39], a[228:231], v[128:131]
    v_mfma_f32_16x16x32_bf16 v[148:151], v[60:63], a[228:231], v[148:151]
    v_cvt_pk_bf16_f32 v160, v80, v81
    v_cvt_pk_bf16_f32 v161, v100, v101
    v_cvt_pk_bf16_f32 v162, v82, v83
    v_cvt_pk_bf16_f32 v163, v102, v103
    buffer_store_dwordx4 v[160:163], v2, s[4:7], s32 offen offset:2048 sc1
    v_mfma_f32_16x16x32_bf16 v[112:115], v[40:43], a[136:139], v[112:115]
    v_mfma_f32_16x16x32_bf16 v[132:135], v[64:67], a[136:139], v[132:135]
    v_mfma_f32_16x16x32_bf16 v[116:119], v[40:43], a[160:163], v[116:119]
    v_mfma_f32_16x16x32_bf16 v[136:139], v[64:67], a[160:163], v[136:139]
    v_mfma_f32_16x16x32_bf16 v[120:123], v[40:43], a[184:187], v[120:123]
    v_mfma_f32_16x16x32_bf16 v[140:143], v[64:67], a[184:187], v[140:143]
    v_mfma_f32_16x16x32_bf16 v[124:127], v[40:43], a[208:211], v[124:127]
    v_mfma_f32_16x16x32_bf16 v[144:147], v[64:67], a[208:211], v[144:147]
    v_mfma_f32_16x16x32_bf16 v[128:131], v[40:43], a[232:235], v[128:131]
    v_mfma_f32_16x16x32_bf16 v[148:151], v[64:67], a[232:235], v[148:151]
    v_cvt_pk_bf16_f32 v164, v84, v85
    v_cvt_pk_bf16_f32 v165, v104, v105
    v_cvt_pk_bf16_f32 v166, v86, v87
    v_cvt_pk_bf16_f32 v167, v106, v107
    buffer_store_dwordx4 v[164:167], v2, s[4:7], s32 offen offset:3072 sc1
    v_mfma_f32_16x16x32_bf16 v[112:115], v[44:47], a[140:143], v[112:115]
    v_mfma_f32_16x16x32_bf16 v[132:135], v[68:71], a[140:143], v[132:135]
    v_mfma_f32_16x16x32_bf16 v[116:119], v[44:47], a[164:167], v[116:119]
    v_mfma_f32_16x16x32_bf16 v[136:139], v[68:71], a[164:167], v[136:139]
    v_mfma_f32_16x16x32_bf16 v[120:123], v[44:47], a[188:191], v[120:123]
    v_mfma_f32_16x16x32_bf16 v[140:143], v[68:71], a[188:191], v[140:143]
    v_mfma_f32_16x16x32_bf16 v[124:127], v[44:47], a[212:215], v[124:127]
    v_mfma_f32_16x16x32_bf16 v[144:147], v[68:71], a[212:215], v[144:147]
    v_mfma_f32_16x16x32_bf16 v[128:131], v[44:47], a[236:239], v[128:131]
    v_mfma_f32_16x16x32_bf16 v[148:151], v[68:71], a[236:239], v[148:151]
    v_cvt_pk_bf16_f32 v168, v88, v89
    v_cvt_pk_bf16_f32 v169, v108, v109
    v_cvt_pk_bf16_f32 v170, v90, v91
    v_cvt_pk_bf16_f32 v171, v110, v111
    buffer_store_dwordx4 v[168:171], v2, s[4:7], s35 offen offset:0 sc1
    v_cvt_pk_bf16_f32 v172, v112, v113
    v_cvt_pk_bf16_f32 v173, v132, v133
    v_cvt_pk_bf16_f32 v174, v114, v115
    v_cvt_pk_bf16_f32 v175, v134, v135
    buffer_store_dwordx4 v[172:175], v2, s[4:7], s35 offen offset:1024 sc1
    v_cvt_pk_bf16_f32 v176, v116, v117
    v_cvt_pk_bf16_f32 v177, v136, v137
    v_cvt_pk_bf16_f32 v178, v118, v119
    v_cvt_pk_bf16_f32 v179, v138, v139
    buffer_store_dwordx4 v[176:179], v2, s[4:7], s35 offen offset:2048 sc1
    v_cvt_pk_bf16_f32 v180, v120, v121
    v_cvt_pk_bf16_f32 v181, v140, v141
    v_cvt_pk_bf16_f32 v182, v122, v123
    v_cvt_pk_bf16_f32 v183, v142, v143
    buffer_store_dwordx4 v[180:183], v2, s[4:7], s35 offen offset:3072 sc1
    v_cvt_pk_bf16_f32 v184, v124, v125
    v_cvt_pk_bf16_f32 v185, v144, v145
    v_cvt_pk_bf16_f32 v186, v126, v127
    v_cvt_pk_bf16_f32 v187, v146, v147
    buffer_store_dwordx4 v[184:187], v2, s[4:7], s36 offen offset:0 sc1
    v_cvt_pk_bf16_f32 v188, v128, v129
    v_cvt_pk_bf16_f32 v189, v148, v149
    v_cvt_pk_bf16_f32 v190, v130, v131
    v_cvt_pk_bf16_f32 v191, v150, v151
    buffer_store_dwordx4 v[188:191], v2, s[4:7], s36 offen offset:1024 sc1
    s_add_u32 s24, s24, 1
    s_cmp_lt_u32 s24, 64
    s_cbranch_scc1 Lu_loop
    s_waitcnt vmcnt(0)
    s_barrier
    s_cmp_lg_u32 s20, 0
    s_cbranch_scc1 Lff_99
    v_mov_b32 v194, 64
    s_mov_b64 exec, 1
    buffer_store_dword v194, v193, s[4:7], s31 offen sc1
    s_mov_b64 exec, -1
Lff_99:
    s_branch Ld_after_u
Ld_after_u:
    s_add_u32 s21, s21, 32
Ld_bx:
    s_load_dwordx2 s[16:17], s[0:1], 0
    s_waitcnt lgkmcnt(0)
    s_mov_b32 s18, 0x280000
    s_mov_b32 s19, 0x20000
    v_mov_b32 v194, 0
    v_and_b32 v3, 7, v1
    s_lshl_b32 s26, s20, 3
    v_add_u32 v3, s26, v3
    v_lshlrev_b32 v3, 7, v3
    v_add_u32 v189, 12288, v3
    v_add_u32 v188, 8192, v3
    s_lshl_b32 s26, s20, 12
    v_add_u32 v191, s26, v2
    v_and_b32 v3, 15, v1
    v_lshrrev_b32 v4, 4, v1
    v_mul_u32_u24 v192, 0x500, v3
    v_lshl_add_u32 v192, v4, 3, v192
    v_lshlrev_b32 v193, 3, v3
    s_mov_b32 s25, s21
Lbx_loop:
    s_cmp_ge_u32 s25, 1280
    s_cbranch_scc1 L_exit
    s_mul_hi_u32 s24, s25, 0xccccccd
    s_mul_i32 s26, s24, 20
    s_sub_u32 s27, s25, s26
    s_add_u32 s28, s24, 1
    s_mul_i32 s26, s20, 20
    s_add_u32 s26, s26, s27
    s_lshl_b32 s26, s26, 7
    s_add_u32 s26, s26, 20480
    v_mov_b32 v5, s26
    v_cmp_gt_u32 vcc, 8, v1
    s_nop 1
    v_cndmask_b32 v5, v5, v188, vcc
Lw_100:
    buffer_load_dword v6, v5, s[4:7], 0 offen sc1
    s_waitcnt vmcnt(0)
    v_cmp_gt_u32 vcc, s28, v6
    s_cbranch_vccz Lwd_101
    s_sub_u32 s101, s101, 1
    s_cbranch_scc1 L_abort
    s_sleep 2
    s_branch Lw_100
Lwd_101:
    s_mul_i32 s30, s24, 1310720
    s_mul_i32 s26, s20, 327680
    s_add_u32 s30, s30, s26
    s_lshl_b32 s26, s27, 11
    s_add_u32 s30, s30, s26
    s_add_u32 s30, s30, 0x7400000
    buffer_load_dwordx4 v[8:11], v2, s[4:7], s30 offen offset:0 sc1
    buffer_load_dwordx4 v[12:15], v2, s[4:7], s30 offen offset:1024 sc1
    s_add_u32 s30, s30, 40960
    buffer_load_dwordx4 v[16:19], v2, s[4:7], s30 offen offset:0 sc1
    buffer_load_dwordx4 v[20:23], v2, s[4:7], s30 offen offset:1024 sc1
    s_add_u32 s30, s30, 40960
    buffer_load_dwordx4 v[24:27], v2, s[4:7], s30 offen offset:0 sc1
    buffer_load_dwordx4 v[28:31], v2, s[4:7], s30 offen offset:1024 sc1
    s_add_u32 s30, s30, 40960
    buffer_load_dwordx4 v[32:35], v2, s[4:7], s30 offen offset:0 sc1
    buffer_load_dwordx4 v[36:39], v2, s[4:7], s30 offen offset:1024 sc1
    s_add_u32 s30, s30, 40960
    buffer_load_dwordx4 v[40:43], v2, s[4:7], s30 offen offset:0 sc1
    buffer_load_dwordx4 v[44:47], v2, s[4:7], s30 offen offset:1024 sc1
    s_add_u32 s30, s30, 40960
    buffer_load_dwordx4 v[48:51], v2, s[4:7], s30 offen offset:0 sc1
    buffer_load_dwordx4 v[52:55], v2, s[4:7], s30 offen offset:1024 sc1
    s_add_u32 s30, s30, 40960
    buffer_load_dwordx4 v[56:59], v2, s[4:7], s30 offen offset:0 sc1
    buffer_load_dwordx4 v[60:63], v2, s[4:7], s30 offen offset:1024 sc1
    s_add_u32 s30, s30, 40960
    buffer_load_dwordx4 v[64:67], v2, s[4:7], s30 offen offset:0 sc1
    buffer_load_dwordx4 v[68:71], v2, s[4:7], s30 offen offset:1024 sc1
    s_add_u32 s30, s30, 40960
    s_mul_i32 s30, s24, 327680
    s_mul_i32 s26, s20, 81920
    s_add_u32 s30, s30, s26
    s_lshl_b32 s26, s27, 11
    s_add_u32 s30, s30, s26
    s_add_u32 s30, s30, 0x2d00000
    buffer_load_dwordx4 v[72:75], v2, s[4:7], s30 offen offset:0 sc1
    buffer_load_dwordx4 v[76:79], v2, s[4:7], s30 offen offset:1024 sc1
    s_add_u32 s30, s30, 40960
    buffer_load_dwordx4 v[80:83], v2, s[4:7], s30 offen offset:0 sc1
    buffer_load_dwordx4 v[84:87], v2, s[4:7], s30 offen offset:1024 sc1
    s_add_u32 s30, s30, 40960
    s_lshl_b32 s30, s24, 5
    s_and_b32 s26, s20, 1
    s_lshl_b32 s26, s26, 4
    s_add_u32 s30, s30, s26
    s_mul_i32 s30, s30, 1280
    s_lshl_b32 s26, s27, 6
    s_add_u32 s30, s30, s26
    buffer_load_dwordx2 v[184:185], v192, s[16:19], s30 offen offset:0
    buffer_load_dwordx2 v[186:187], v192, s[16:19], s30 offen offset:32
Lw_102:
    buffer_load_dword v6, v189, s[4:7], 0 offen sc1
    s_waitcnt vmcnt(0)
    v_cmp_gt_u32 vcc, s28, v6
    s_cbranch_vccz Lwd_103
    s_sub_u32 s101, s101, 1
    s_cbranch_scc1 L_abort
    s_sleep 1
    s_branch Lw_102
Lwd_103:
    s_mul_i32 s30, s24, 65536
    s_lshl_b32 s26, s20, 14
    s_add_u32 s30, s30, s26
    s_add_u32 s30, s30, 0x1b00000
    buffer_load_dwordx4 v[88:91], v2, s[4:7], s30 offen offset:0 sc1
    buffer_load_dwordx4 v[92:95], v2, s[4:7], s30 offen offset:1024 sc1
    buffer_load_dwordx4 v[96:99], v2, s[4:7], s30 offen offset:2048 sc1
    buffer_load_dwordx4 v[100:103], v2, s[4:7], s30 offen offset:3072 sc1
    s_add_u32 s30, s30, 4096
    buffer_load_dwordx4 v[104:107], v2, s[4:7], s30 offen offset:0 sc1
    buffer_load_dwordx4 v[108:111], v2, s[4:7], s30 offen offset:1024 sc1
    buffer_load_dwordx4 v[112:115], v2, s[4:7], s30 offen offset:2048 sc1
    buffer_load_dwordx4 v[116:119], v2, s[4:7], s30 offen offset:3072 sc1
    s_add_u32 s30, s30, 4096
    buffer_load_dwordx4 v[120:123], v2, s[4:7], s30 offen offset:0 sc1
    buffer_load_dwordx4 v[124:127], v2, s[4:7], s30 offen offset:1024 sc1
    buffer_load_dwordx4 v[128:131], v2, s[4:7], s30 offen offset:2048 sc1
    buffer_load_dwordx4 v[132:135], v2, s[4:7], s30 offen offset:3072 sc1
    s_add_u32 s30, s30, 4096
    buffer_load_dwordx4 v[136:139], v2, s[4:7], s30 offen offset:0 sc1
    buffer_load_dwordx4 v[140:143], v2, s[4:7], s30 offen offset:1024 sc1
    buffer_load_dwordx4 v[144:147], v2, s[4:7], s30 offen offset:2048 sc1
    buffer_load_dwordx4 v[148:151], v2, s[4:7], s30 offen offset:3072 sc1
    s_add_u32 s30, s30, 4096
    s_mul_i32 s30, s24, 16384
    s_lshl_b32 s26, s20, 11
    s_add_u32 s30, s30, s26
    s_add_u32 s30, s30, 0x1f00000
    s_add_u32 s31, s30, 8192
    buffer_load_dwordx4 v[152:155], v2, s[4:7], s30 offen offset:0 sc1
    buffer_load_dwordx4 v[156:159], v2, s[4:7], s31 offen offset:0 sc1
    buffer_load_dwordx4 v[160:163], v2, s[4:7], s30 offen offset:1024 sc1
    buffer_load_dwordx4 v[164:167], v2, s[4:7], s31 offen offset:1024 sc1
    s_waitcnt vmcnt(18)
    v_mfma_f32_16x16x32_bf16 v[168:171], v[8:11], v[88:91], 0
    v_mfma_f32_16x16x32_bf16 v[172:175], v[8:11], v[92:95], 0
    v_mfma_f32_16x16x32_bf16 v[176:179], v[12:15], v[88:91], 0
    v_mfma_f32_16x16x32_bf16 v[180:183], v[12:15], v[92:95], 0
    s_waitcnt vmcnt(16)
    v_mfma_f32_16x16x32_bf16 v[168:171], v[16:19], v[96:99], v[168:171]
    v_mfma_f32_16x16x32_bf16 v[172:175], v[16:19], v[100:103], v[172:175]
    v_mfma_f32_16x16x32_bf16 v[176:179], v[20:23], v[96:99], v[176:179]
    v_mfma_f32_16x16x32_bf16 v[180:183], v[20:23], v[100:103], v[180:183]
    s_waitcnt vmcnt(14)
    v_mfma_f32_16x16x32_bf16 v[168:171], v[24:27], v[104:107], v[168:171]
    v_mfma_f32_16x16x32_bf16 v[172:175], v[24:27], v[108:111], v[172:175]
    v_mfma_f32_16x16x32_bf16 v[176:179], v[28:31], v[104:107], v[176:179]
    v_mfma_f32_16x16x32_bf16 v[180:183], v[28:31], v[108:111], v[180:183]
    s_waitcnt vmcnt(12)
    v_mfma_f32_16x16x32_bf16 v[168:171], v[32:35], v[112:115], v[168:171]
    v_mfma_f32_16x16x32_bf16 v[172:175], v[32:35], v[116:119], v[172:175]
    v_mfma_f32_16x16x32_bf16 v[176:179], v[36:39], v[112:115], v[176:179]
    v_mfma_f32_16x16x32_bf16 v[180:183], v[36:39], v[116:119], v[180:183]
    s_waitcnt vmcnt(10)
    v_mfma_f32_16x16x32_bf16 v[168:171], v[40:43], v[120:123], v[168:171]
    v_mfma_f32_16x16x32_bf16 v[172:175], v[40:43], v[124:127], v[172:175]
    v_mfma_f32_16x16x32_bf16 v[176:179], v[44:47], v[120:123], v[176:179]
    v_mfma_f32_16x16x32_bf16 v[180:183], v[44:47], v[124:127], v[180:183]
    s_waitcnt vmcnt(8)
    v_mfma_f32_16x16x32_bf16 v[168:171], v[48:51], v[128:131], v[168:171]
    v_mfma_f32_16x16x32_bf16 v[172:175], v[48:51], v[132:135], v[172:175]
    v_mfma_f32_16x16x32_bf16 v[176:179], v[52:55], v[128:131], v[176:179]
    v_mfma_f32_16x16x32_bf16 v[180:183], v[52:55], v[132:135], v[180:183]
    s_waitcnt vmcnt(6)
    v_mfma_f32_16x16x32_bf16 v[168:171], v[56:59], v[136:139], v[168:171]
    v_mfma_f32_16x16x32_bf16 v[172:175], v[56:59], v[140:143], v[172:175]
    v_mfma_f32_16x16x32_bf16 v[176:179], v[60:63], v[136:139], v[176:179]
    v_mfma_f32_16x16x32_bf16 v[180:183], v[60:63], v[140:143], v[180:183]
    s_waitcnt vmcnt(4)
    v_mfma_f32_16x16x32_bf16 v[168:171], v[64:67], v[144:147], v[168:171]
    v_mfma_f32_16x16x32_bf16 v[172:175], v[64:67], v[148:151], v[172:175]
    v_mfma_f32_16x16x32_bf16 v[176:179], v[68:71], v[144:147], v[176:179]
    v_mfma_f32_16x16x32_bf16 v[180:183], v[68:71], v[148:151], v[180:183]
    s_waitcnt vmcnt(0)
    v_mfma_f32_16x16x32_bf16 v[168:171], v[72:75], v[152:155], v[168:171]
    v_mfma_f32_16x16x32_bf16 v[172:175], v[72:75], v[156:159], v[172:175]
    v_mfma_f32_16x16x32_bf16 v[176:179], v[76:79], v[152:155], v[176:179]
    v_mfma_f32_16x16x32_bf16 v[180:183], v[76:79], v[156:159], v[180:183]
    v_mfma_f32_16x16x32_bf16 v[168:171], v[80:83], v[160:163], v[168:171]
    v_mfma_f32_16x16x32_bf16 v[172:175], v[80:83], v[164:167], v[172:175]
    v_mfma_f32_16x16x32_bf16 v[176:179], v[84:87], v[160:163], v[176:179]
    v_mfma_f32_16x16x32_bf16 v[180:183], v[84:87], v[164:167], v[180:183]
    s_nop 4
    ds_write_b128 v191, v[168:171] offset:0
    ds_write_b128 v191, v[172:175] offset:1024
    ds_write_b128 v191, v[176:179] offset:2048
    ds_write_b128 v191, v[180:183] offset:3072
    s_waitcnt lgkmcnt(0)
    s_barrier
    s_cmp_ge_u32 s20, 2
    s_cbranch_scc1 Lbx_fin
    s_lshl_b32 s26, s20, 10
    v_add_u32 v3, s26, v2
    ds_read_b128 v[8:11], v3 offset:0
    ds_read_b128 v[12:15], v3 offset:4096
    ds_read_b128 v[16:19], v3 offset:8192
    ds_read_b128 v[20:23], v3 offset:12288
    ds_read_b128 v[24:27], v3 offset:2048
    ds_read_b128 v[28:31], v3 offset:6144
    ds_read_b128 v[32:35], v3 offset:10240
    ds_read_b128 v[36:39], v3 offset:14336
    s_waitcnt lgkmcnt(0)
    v_add_f32 v8, v8, v12
    v_add_f32 v16, v16, v20
    v_add_f32 v9, v9, v13
    v_add_f32 v17, v17, v21
    v_add_f32 v10, v10, v14
    v_add_f32 v18, v18, v22
    v_add_f32 v11, v11, v15
    v_add_f32 v19, v19, v23
    v_add_f32 v8, v8, v16
    v_add_f32 v9, v9, v17
    v_add_f32 v10, v10, v18
    v_add_f32 v11, v11, v19
    v_lshlrev_b32 v5, 16, v184
    v_and_b32 v6, 0xffff0000, v184
    v_add_f32 v8, v8, v5
    v_add_f32 v9, v9, v6
    v_lshlrev_b32 v5, 16, v185
    v_and_b32 v6, 0xffff0000, v185
    v_add_f32 v10, v10, v5
    v_add_f32 v11, v11, v6
    v_add_f32 v24, v24, v28
    v_add_f32 v32, v32, v36
    v_add_f32 v25, v25, v29
    v_add_f32 v33, v33, v37
    v_add_f32 v26, v26, v30
    v_add_f32 v34, v34, v38
    v_add_f32 v27, v27, v31
    v_add_f32 v35, v35, v39
    v_add_f32 v24, v24, v32
    v_add_f32 v25, v25, v33
    v_add_f32 v26, v26, v34
    v_add_f32 v27, v27, v35
    v_lshlrev_b32 v5, 16, v186
    v_and_b32 v6, 0xffff0000, v186
    v_add_f32 v24, v24, v5
    v_add_f32 v25, v25, v6
    v_lshlrev_b32 v5, 16, v187
    v_and_b32 v6, 0xffff0000, v187
    v_add_f32 v26, v26, v5
    v_add_f32 v27, v27, v6
    v_cvt_pk_bf16_f32 v56, v8, v9
    v_cvt_pk_bf16_f32 v57, v10, v11
    v_cvt_pk_bf16_f32 v58, v24, v25
    v_cvt_pk_bf16_f32 v59, v26, v27
    s_mul_i32 s30, s24, 40960
    s_mul_i32 s26, s20, 20480
    s_add_u32 s30, s30, s26
    s_lshl_b32 s26, s27, 10
    s_add_u32 s30, s30, s26
    s_add_u32 s30, s30, 0x1000000
    buffer_store_dwordx4 v[56:59], v2, s[4:7], s30 offen sc1
    v_lshlrev_b32 v48, 16, v56
    v_and_b32 v49, 0xffff0000, v56
    v_lshlrev_b32 v50, 16, v57
    v_and_b32 v51, 0xffff0000, v57
    v_lshlrev_b32 v52, 16, v58
    v_and_b32 v53, 0xffff0000, v58
    v_lshlrev_b32 v54, 16, v59
    v_and_b32 v55, 0xffff0000, v59
    v_add_f32 v60, v48, v49
    v_mul_f32 v61, v48, v48
    v_add_f32 v60, v60, v50
    v_add_f32 v60, v60, v51
    v_add_f32 v60, v60, v52
    v_add_f32 v60, v60, v53
    v_add_f32 v60, v60, v54
    v_add_f32 v60, v60, v55
    v_fmac_f32 v61, v49, v49
    v_fmac_f32 v61, v50, v50
    v_fmac_f32 v61, v51, v51
    v_fmac_f32 v61, v52, v52
    v_fmac_f32 v61, v53, v53
    v_fmac_f32 v61, v54, v54
    v_fmac_f32 v61, v55, v55
    v_mov_b32 v62, v60
    s_nop 1
    v_permlane16_swap_b32 v60, v62
    v_add_f32 v60, v60, v62
    v_mov_b32 v62, v60
    s_nop 1
    v_permlane32_swap_b32 v60, v62
    v_add_f32 v60, v60, v62
    v_mov_b32 v62, v61
    s_nop 1
    v_permlane16_swap_b32 v61, v62
    v_add_f32 v61, v61, v62
    v_mov_b32 v62, v61
    s_nop 1
    v_permlane32_swap_b32 v61, v62
    v_add_f32 v61, v61, v62
    s_mul_i32 s30, s24, 5120
    s_mul_i32 s26, s20, 2560
    s_add_u32 s30, s30, s26
    s_lshl_b32 s26, s27, 7
    s_add_u32 s30, s30, s26
    s_add_u32 s30, s30, 0x1300000
    s_mov_b64 exec, 0xffff
    buffer_store_dwordx2 v[60:61], v193, s[4:7], s30 offen sc1
    s_mov_b64 exec, -1
    s_waitcnt vmcnt(0)
Lbx_fin:
    s_barrier
    s_cmp_lg_u32 s20, 0
    s_cbranch_scc1 Lbx_nf_104
    s_lshl_b32 s30, s24, 7
    s_lshl_b32 s26, s27, 2
    s_add_u32 s30, s30, s26
    s_add_u32 s30, s30, 36864
    v_mov_b32 v6, 1
    s_mov_b64 exec, 1
    buffer_store_dword v6, v194, s[4:7], s30 offen sc1
    s_mov_b64 exec, -1
Lbx_nf_104:
    s_add_u32 s25, s25, 64
    s_branch Lbx_loop
Ld_qa:
    s_load_dwordx2 s[8:9], s[0:1], 16
    s_waitcnt lgkmcnt(0)
    s_mov_b32 s10, 0x780000
    s_mov_b32 s11, 0x20000
    v_add_u32 v3, 0, v0
    v_mul_u32_u24 v4, 0x2ab, v3
    v_lshrrev_b32 v4, 14, v4
    v_mul_u32_u24 v5, 24, v4
    v_sub_u32 v5, v3, v5
    v_mul_u32_u24 v8, 0x3000, v4
    v_lshl_add_u32 v8, v5, 4, v8
    v_mul_u32_u24 v14, 0x1a0, v4
    v_lshl_add_u32 v14, v5, 4, v14
    v_add_u32 v3, 256, v0
    v_mul_u32_u24 v4, 0x2ab, v3
    v_lshrrev_b32 v4, 14, v4
    v_mul_u32_u24 v5, 24, v4
    v_sub_u32 v5, v3, v5
    v_mul_u32_u24 v9, 0x3000, v4
    v_lshl_add_u32 v9, v5, 4, v9
    v_mul_u32_u24 v15, 0x1a0, v4
    v_lshl_add_u32 v15, v5, 4, v15
    v_add_u32 v3, 512, v0
    v_mul_u32_u24 v4, 0x2ab, v3
    v_lshrrev_b32 v4, 14, v4
    v_mul_u32_u24 v5, 24, v4
    v_sub_u32 v5, v3, v5
    v_mul_u32_u24 v10, 0x3000, v4
    v_lshl_add_u32 v10, v5, 4, v10
    v_mul_u32_u24 v16, 0x1a0, v4
    v_lshl_add_u32 v16, v5, 4, v16
    v_add_u32 v3, 768, v0
    v_mul_u32_u24 v4, 0x2ab, v3
    v_lshrrev_b32 v4, 14, v4
    v_mul_u32_u24 v5, 24, v4
    v_sub_u32 v5, v3, v5
    v_mul_u32_u24 v11, 0x3000, v4
    v_lshl_add_u32 v11, v5, 4, v11
    v_mul_u32_u24 v17, 0x1a0, v4
    v_lshl_add_u32 v17, v5, 4, v17
    v_add_u32 v3, 1024, v0
    v_mul_u32_u24 v4, 0x2ab, v3
    v_lshrrev_b32 v4, 14, v4
    v_mul_u32_u24 v5, 24, v4
    v_sub_u32 v5, v3, v5
    v_mul_u32_u24 v12, 0x3000, v4
    v_lshl_add_u32 v12, v5, 4, v12
    v_mul_u32_u24 v18, 0x1a0, v4
    v_lshl_add_u32 v18, v5, 4, v18
    v_add_u32 v3, 1280, v0
    v_mul_u32_u24 v4, 0x2ab, v3
    v_lshrrev_b32 v4, 14, v4
    v_mul_u32_u24 v5, 24, v4
    v_sub_u32 v5, v3, v5
    v_mul_u32_u24 v13, 0x3000, v4
    v_lshl_add_u32 v13, v5, 4, v13
    v_mul_u32_u24 v19, 0x1a0, v4
    v_lshl_add_u32 v19, v5, 4, v19
    s_mul_i32 s25, s21, 384
    v_and_b32 v3, 15, v1
    v_lshrrev_b32 v4, 4, v1
    v_lshrrev_b32 v5, 2, v3
    v_lshl_add_u32 v5, v4, 3, v5
    v_mul_u32_u24 v20, 0x1a0, v5
    v_and_b32 v3, 3, v3
    v_lshl_add_u32 v20, v3, 3, v20
    s_mul_i32 s26, s20, 96
    v_add_u32 v20, s26, v20
    buffer_load_dwordx4 v[24:27], v8, s[8:11], s25 offen
    buffer_load_dwordx4 v[28:31], v9, s[8:11], s25 offen
    buffer_load_dwordx4 v[32:35], v10, s[8:11], s25 offen
    buffer_load_dwordx4 v[36:39], v11, s[8:11], s25 offen
    buffer_load_dwordx4 v[40:43], v12, s[8:11], s25 offen
    buffer_load_dwordx4 v[44:47], v13, s[8:11], s25 offen
    s_add_u32 s25, s25, 0xc0000
    buffer_load_dwordx4 v[48:51], v8, s[8:11], s25 offen
    buffer_load_dwordx4 v[52:55], v9, s[8:11], s25 offen
    buffer_load_dwordx4 v[56:59], v10, s[8:11], s25 offen
    buffer_load_dwordx4 v[60:63], v11, s[8:11], s25 offen
    buffer_load_dwordx4 v[64:67], v12, s[8:11], s25 offen
    buffer_load_dwordx4 v[68:71], v13, s[8:11], s25 offen
    s_add_u32 s25, s25, 0xc0000
    buffer_load_dwordx4 v[72:75], v8, s[8:11], s25 offen
    buffer_load_dwordx4 v[76:79], v9, s[8:11], s25 offen
    buffer_load_dwordx4 v[80:83], v10, s[8:11], s25 offen
    buffer_load_dwordx4 v[84:87], v11, s[8:11], s25 offen
    buffer_load_dwordx4 v[88:91], v12, s[8:11], s25 offen
    buffer_load_dwordx4 v[92:95], v13, s[8:11], s25 offen
    s_add_u32 s25, s25, 0xc0000
    s_waitcnt vmcnt(12)
    ds_write_b128 v14, v[24:27] offset:0
    ds_write_b128 v15, v[28:31] offset:0
    ds_write_b128 v16, v[32:35] offset:0
    ds_write_b128 v17, v[36:39] offset:0
    ds_write_b128 v18, v[40:43] offset:0
    ds_write_b128 v19, v[44:47] offset:0
    s_waitcnt lgkmcnt(0)
    buffer_load_dwordx4 v[24:27], v8, s[8:11], s25 offen
    buffer_load_dwordx4 v[28:31], v9, s[8:11], s25 offen
    buffer_load_dwordx4 v[32:35], v10, s[8:11], s25 offen
    buffer_load_dwordx4 v[36:39], v11, s[8:11], s25 offen
    buffer_load_dwordx4 v[40:43], v12, s[8:11], s25 offen
    buffer_load_dwordx4 v[44:47], v13, s[8:11], s25 offen
    s_add_u32 s25, s25, 0xc0000
    s_barrier
    ds_read_b64_tr_b16 a[0:1], v20 offset:0
    ds_read_b64_tr_b16 a[2:3], v20 offset:1664
    ds_read_b64_tr_b16 a[80:81], v20 offset:32
    ds_read_b64_tr_b16 a[82:83], v20 offset:1696
    ds_read_b64_tr_b16 a[160:161], v20 offset:64
    ds_read_b64_tr_b16 a[162:163], v20 offset:1728
    ds_read_b64_tr_b16 a[4:5], v20 offset:13312
    ds_read_b64_tr_b16 a[6:7], v20 offset:14976
    ds_read_b64_tr_b16 a[84:85], v20 offset:13344
    ds_read_b64_tr_b16 a[86:87], v20 offset:15008
    ds_read_b64_tr_b16 a[164:165], v20 offset:13376
    ds_read_b64_tr_b16 a[166:167], v20 offset:15040
    s_waitcnt vmcnt(12)
    ds_write_b128 v14, v[48:51] offset:26624
    ds_write_b128 v15, v[52:55] offset:26624
    ds_write_b128 v16, v[56:59] offset:26624
    ds_write_b128 v17, v[60:63] offset:26624
    ds_write_b128 v18, v[64:67] offset:26624
    ds_write_b128 v19, v[68:71] offset:26624
    s_waitcnt lgkmcnt(0)
    buffer_load_dwordx4 v[48:51], v8, s[8:11], s25 offen
    buffer_load_dwordx4 v[52:55], v9, s[8:11], s25 offen
    buffer_load_dwordx4 v[56:59], v10, s[8:11], s25 offen
    buffer_load_dwordx4 v[60:63], v11, s[8:11], s25 offen
    buffer_load_dwordx4 v[64:67], v12, s[8:11], s25 offen
    buffer_load_dwordx4 v[68:71], v13, s[8:11], s25 offen
    s_add_u32 s25, s25, 0xc0000
    s_barrier
    ds_read_b64_tr_b16 a[8:9], v20 offset:26624
    ds_read_b64_tr_b16 a[10:11], v20 offset:28288
    ds_read_b64_tr_b16 a[88:89], v20 offset:26656
    ds_read_b64_tr_b16 a[90:91], v20 offset:28320
    ds_read_b64_tr_b16 a[168:169], v20 offset:26688
    ds_read_b64_tr_b16 a[170:171], v20 offset:28352
    ds_read_b64_tr_b16 a[12:13], v20 offset:39936
    ds_read_b64_tr_b16 a[14:15], v20 offset:41600
    ds_read_b64_tr_b16 a[92:93], v20 offset:39968
    ds_read_b64_tr_b16 a[94:95], v20 offset:41632
    ds_read_b64_tr_b16 a[172:173], v20 offset:40000
    ds_read_b64_tr_b16 a[174:175], v20 offset:41664
    s_waitcnt vmcnt(12)
    ds_write_b128 v14, v[72:75] offset:0
    ds_write_b128 v15, v[76:79] offset:0
    ds_write_b128 v16, v[80:83] offset:0
    ds_write_b128 v17, v[84:87] offset:0
    ds_write_b128 v18, v[88:91] offset:0
    ds_write_b128 v19, v[92:95] offset:0
    s_waitcnt lgkmcnt(0)
    buffer_load_dwordx4 v[72:75], v8, s[8:11], s25 offen
    buffer_load_dwordx4 v[76:79], v9, s[8:11], s25 offen
    buffer_load_dwordx4 v[80:83], v10, s[8:11], s25 offen
    buffer_load_dwordx4 v[84:87], v11, s[8:11], s25 offen
    buffer_load_dwordx4 v[88:91], v12, s[8:11], s25 offen
    buffer_load_dwordx4 v[92:95], v13, s[8:11], s25 offen
    s_add_u32 s25, s25, 0xc0000
    s_barrier
    ds_read_b64_tr_b16 a[16:17], v20 offset:0
    ds_read_b64_tr_b16 a[18:19], v20 offset:1664
    ds_read_b64_tr_b16 a[96:97], v20 offset:32
    ds_read_b64_tr_b16 a[98:99], v20 offset:1696
    ds_read_b64_tr_b16 a[176:177], v20 offset:64
    ds_read_b64_tr_b16 a[178:179], v20 offset:1728
    ds_read_b64_tr_b16 a[20:21], v20 offset:13312
    ds_read_b64_tr_b16 a[22:23], v20 offset:14976
    ds_read_b64_tr_b16 a[100:101], v20 offset:13344
    ds_read_b64_tr_b16 a[102:103], v20 offset:15008
    ds_read_b64_tr_b16 a[180:181], v20 offset:13376
    ds_read_b64_tr_b16 a[182:183], v20 offset:15040
    s_waitcnt vmcnt(12)
    ds_write_b128 v14, v[24:27] offset:26624
    ds_write_b128 v15, v[28:31] offset:26624
    ds_write_b128 v16, v[32:35] offset:26624
    ds_write_b128 v17, v[36:39] offset:26624
    ds_write_b128 v18, v[40:43] offset:26624
    ds_write_b128 v19, v[44:47] offset:26624
    s_waitcnt lgkmcnt(0)
    buffer_load_dwordx4 v[24:27], v8, s[8:11], s25 offen
    buffer_load_dwordx4 v[28:31], v9, s[8:11], s25 offen
    buffer_load_dwordx4 v[32:35], v10, s[8:11], s25 offen
    buffer_load_dwordx4 v[36:39], v11, s[8:11], s25 offen
    buffer_load_dwordx4 v[40:43], v12, s[8:11], s25 offen
    buffer_load_dwordx4 v[44:47], v13, s[8:11], s25 offen
    s_add_u32 s25, s25, 0xc0000
    s_barrier
    ds_read_b64_tr_b16 a[24:25], v20 offset:26624
    ds_read_b64_tr_b16 a[26:27], v20 offset:28288
    ds_read_b64_tr_b16 a[104:105], v20 offset:26656
    ds_read_b64_tr_b16 a[106:107], v20 offset:28320
    ds_read_b64_tr_b16 a[184:185], v20 offset:26688
    ds_read_b64_tr_b16 a[186:187], v20 offset:28352
    ds_read_b64_tr_b16 a[28:29], v20 offset:39936
    ds_read_b64_tr_b16 a[30:31], v20 offset:41600
    ds_read_b64_tr_b16 a[108:109], v20 offset:39968
    ds_read_b64_tr_b16 a[110:111], v20 offset:41632
    ds_read_b64_tr_b16 a[188:189], v20 offset:40000
    ds_read_b64_tr_b16 a[190:191], v20 offset:41664
    s_waitcnt vmcnt(12)
    ds_write_b128 v14, v[48:51] offset:0
    ds_write_b128 v15, v[52:55] offset:0
    ds_write_b128 v16, v[56:59] offset:0
    ds_write_b128 v17, v[60:63] offset:0
    ds_write_b128 v18, v[64:67] offset:0
    ds_write_b128 v19, v[68:71] offset:0
    s_waitcnt lgkmcnt(0)
    buffer_load_dwordx4 v[48:51], v8, s[8:11], s25 offen
    buffer_load_dwordx4 v[52:55], v9, s[8:11], s25 offen
    buffer_load_dwordx4 v[56:59], v10, s[8:11], s25 offen
    buffer_load_dwordx4 v[60:63], v11, s[8:11], s25 offen
    buffer_load_dwordx4 v[64:67], v12, s[8:11], s25 offen
    buffer_load_dwordx4 v[68:71], v13, s[8:11], s25 offen
    s_add_u32 s25, s25, 0xc0000
    s_barrier
    ds_read_b64_tr_b16 a[32:33], v20 offset:0
    ds_read_b64_tr_b16 a[34:35], v20 offset:1664
    ds_read_b64_tr_b16 a[112:113], v20 offset:32
    ds_read_b64_tr_b16 a[114:115], v20 offset:1696
    ds_read_b64_tr_b16 a[192:193], v20 offset:64
    ds_read_b64_tr_b16 a[194:195], v20 offset:1728
    ds_read_b64_tr_b16 a[36:37], v20 offset:13312
    ds_read_b64_tr_b16 a[38:39], v20 offset:14976
    ds_read_b64_tr_b16 a[116:117], v20 offset:13344
    ds_read_b64_tr_b16 a[118:119], v20 offset:15008
    ds_read_b64_tr_b16 a[196:197], v20 offset:13376
    ds_read_b64_tr_b16 a[198:199], v20 offset:15040
    s_waitcnt vmcnt(12)
    ds_write_b128 v14, v[72:75] offset:26624
    ds_write_b128 v15, v[76:79] offset:26624
    ds_write_b128 v16, v[80:83] offset:26624
    ds_write_b128 v17, v[84:87] offset:26624
    ds_write_b128 v18, v[88:91] offset:26624
    ds_write_b128 v19, v[92:95] offset:26624
    s_waitcnt lgkmcnt(0)
    buffer_load_dwordx4 v[72:75], v8, s[8:11], s25 offen
    buffer_load_dwordx4 v[76:79], v9, s[8:11], s25 offen
    buffer_load_dwordx4 v[80:83], v10, s[8:11], s25 offen
    buffer_load_dwordx4 v[84:87], v11, s[8:11], s25 offen
    buffer_load_dwordx4 v[88:91], v12, s[8:11], s25 offen
    buffer_load_dwordx4 v[92:95], v13, s[8:11], s25 offen
    s_add_u32 s25, s25, 0xc0000
    s_barrier
    ds_read_b64_tr_b16 a[40:41], v20 offset:26624
    ds_read_b64_tr_b16 a[42:43], v20 offset:28288
    ds_read_b64_tr_b16 a[120:121], v20 offset:26656
    ds_read_b64_tr_b16 a[122:123], v20 offset:28320
    ds_read_b64_tr_b16 a[200:201], v20 offset:26688
    ds_read_b64_tr_b16 a[202:203], v20 offset:28352
    ds_read_b64_tr_b16 a[44:45], v20 offset:39936
    ds_read_b64_tr_b16 a[46:47], v20 offset:41600
    ds_read_b64_tr_b16 a[124:125], v20 offset:39968
    ds_read_b64_tr_b16 a[126:127], v20 offset:41632
    ds_read_b64_tr_b16 a[204:205], v20 offset:40000
    ds_read_b64_tr_b16 a[206:207], v20 offset:41664
    s_waitcnt vmcnt(12)
    ds_write_b128 v14, v[24:27] offset:0
    ds_write_b128 v15, v[28:31] offset:0
    ds_write_b128 v16, v[32:35] offset:0
    ds_write_b128 v17, v[36:39] offset:0
    ds_write_b128 v18, v[40:43] offset:0
    ds_write_b128 v19, v[44:47] offset:0
    s_waitcnt lgkmcnt(0)
    buffer_load_dwordx4 v[24:27], v8, s[8:11], s25 offen
    buffer_load_dwordx4 v[28:31], v9, s[8:11], s25 offen
    buffer_load_dwordx4 v[32:35], v10, s[8:11], s25 offen
    buffer_load_dwordx4 v[36:39], v11, s[8:11], s25 offen
    buffer_load_dwordx4 v[40:43], v12, s[8:11], s25 offen
    buffer_load_dwordx4 v[44:47], v13, s[8:11], s25 offen
    s_add_u32 s25, s25, 0xc0000
    s_barrier
    ds_read_b64_tr_b16 a[48:49], v20 offset:0
    ds_read_b64_tr_b16 a[50:51], v20 offset:1664
    ds_read_b64_tr_b16 a[128:129], v20 offset:32
    ds_read_b64_tr_b16 a[130:131], v20 offset:1696
    ds_read_b64_tr_b16 a[208:209], v20 offset:64
    ds_read_b64_tr_b16 a[210:211], v20 offset:1728
    ds_read_b64_tr_b16 a[52:53], v20 offset:13312
    ds_read_b64_tr_b16 a[54:55], v20 offset:14976
    ds_read_b64_tr_b16 a[132:133], v20 offset:13344
    ds_read_b64_tr_b16 a[134:135], v20 offset:15008
    ds_read_b64_tr_b16 a[212:213], v20 offset:13376
    ds_read_b64_tr_b16 a[214:215], v20 offset:15040
    s_waitcnt vmcnt(12)
    ds_write_b128 v14, v[48:51] offset:26624
    ds_write_b128 v15, v[52:55] offset:26624
    ds_write_b128 v16, v[56:59] offset:26624
    ds_write_b128 v17, v[60:63] offset:26624
    ds_write_b128 v18, v[64:67] offset:26624
    ds_write_b128 v19, v[68:71] offset:26624
    s_waitcnt lgkmcnt(0)
    s_barrier
    ds_read_b64_tr_b16 a[56:57], v20 offset:26624
    ds_read_b64_tr_b16 a[58:59], v20 offset:28288
    ds_read_b64_tr_b16 a[136:137], v20 offset:26656
    ds_read_b64_tr_b16 a[138:139], v20 offset:28320
    ds_read_b64_tr_b16 a[216:217], v20 offset:26688
    ds_read_b64_tr_b16 a[218:219], v20 offset:28352
    ds_read_b64_tr_b16 a[60:61], v20 offset:39936
    ds_read_b64_tr_b16 a[62:63], v20 offset:41600
    ds_read_b64_tr_b16 a[140:141], v20 offset:39968
    ds_read_b64_tr_b16 a[142:143], v20 offset:41632
    ds_read_b64_tr_b16 a[220:221], v20 offset:40000
    ds_read_b64_tr_b16 a[222:223], v20 offset:41664
    s_waitcnt vmcnt(6)
    ds_write_b128 v14, v[72:75] offset:0
    ds_write_b128 v15, v[76:79] offset:0
    ds_write_b128 v16, v[80:83] offset:0
    ds_write_b128 v17, v[84:87] offset:0
    ds_write_b128 v18, v[88:91] offset:0
    ds_write_b128 v19, v[92:95] offset:0
    s_waitcnt lgkmcnt(0)
    s_barrier
    ds_read_b64_tr_b16 a[64:65], v20 offset:0
    ds_read_b64_tr_b16 a[66:67], v20 offset:1664
    ds_read_b64_tr_b16 a[144:145], v20 offset:32
    ds_read_b64_tr_b16 a[146:147], v20 offset:1696
    ds_read_b64_tr_b16 a[224:225], v20 offset:64
    ds_read_b64_tr_b16 a[226:227], v20 offset:1728
    ds_read_b64_tr_b16 a[68:69], v20 offset:13312
    ds_read_b64_tr_b16 a[70:71], v20 offset:14976
    ds_read_b64_tr_b16 a[148:149], v20 offset:13344
    ds_read_b64_tr_b16 a[150:151], v20 offset:15008
    ds_read_b64_tr_b16 a[228:229], v20 offset:13376
    ds_read_b64_tr_b16 a[230:231], v20 offset:15040
    s_waitcnt vmcnt(0)
    ds_write_b128 v14, v[24:27] offset:26624
    ds_write_b128 v15, v[28:31] offset:26624
    ds_write_b128 v16, v[32:35] offset:26624
    ds_write_b128 v17, v[36:39] offset:26624
    ds_write_b128 v18, v[40:43] offset:26624
    ds_write_b128 v19, v[44:47] offset:26624
    s_waitcnt lgkmcnt(0)
    s_barrier
    ds_read_b64_tr_b16 a[72:73], v20 offset:26624
    ds_read_b64_tr_b16 a[74:75], v20 offset:28288
    ds_read_b64_tr_b16 a[152:153], v20 offset:26656
    ds_read_b64_tr_b16 a[154:155], v20 offset:28320
    ds_read_b64_tr_b16 a[232:233], v20 offset:26688
    ds_read_b64_tr_b16 a[234:235], v20 offset:28352
    ds_read_b64_tr_b16 a[76:77], v20 offset:39936
    ds_read_b64_tr_b16 a[78:79], v20 offset:41600
    ds_read_b64_tr_b16 a[156:157], v20 offset:39968
    ds_read_b64_tr_b16 a[158:159], v20 offset:41632
    ds_read_b64_tr_b16 a[236:237], v20 offset:40000
    ds_read_b64_tr_b16 a[238:239], v20 offset:41664
    s_waitcnt lgkmcnt(0)
    s_barrier
    v_mov_b32 v93, 0
    v_mov_b32 v94, 0
    v_mov_b32 v95, 0
    v_mov_b32 v150, 0xff800000
    v_or_b32 v3, 8, v1
    v_lshlrev_b32 v126, 4, v3
    v_lshlrev_b32 v127, 3, v3
    s_mul_i32 s26, s20, 5120
    s_add_u32 s26, s26, 81920
    v_add_u32 v148, s26, v2
    v_and_b32 v3, 15, v1
    v_lshrrev_b32 v4, 4, v1
    v_and_b32 v5, 1, v4
    v_lshlrev_b32 v5, 3, v5
    v_lshl_add_u32 v5, v3, 4, v5
    s_lshl_b32 s26, s20, 13
    s_lshl_b32 s27, s21, 8
    s_add_u32 s26, s26, s27
    s_add_u32 s26, s26, 0x1f00000
    v_add_u32 v149, s26, v5
    v_lshlrev_b32 v5, 2, v4
    v_add_u32 v6, 0, v5
    v_cmp_le_u32 s[44:45], v6, v3
    v_add_u32 v6, 1, v5
    v_cmp_le_u32 s[46:47], v6, v3
    v_add_u32 v6, 2, v5
    v_cmp_le_u32 s[48:49], v6, v3
    v_add_u32 v6, 3, v5
    v_cmp_le_u32 s[50:51], v6, v3
    s_mul_i32 s28, s21, 12288
    s_mul_i32 s26, s20, 3072
    s_add_u32 s28, s28, s26
    s_add_u32 s28, s28, 0x4200000
    s_mul_i32 s29, s21, 6144
    s_mul_i32 s26, s20, 1536
    s_add_u32 s29, s29, s26
    s_add_u32 s29, s29, 0x2000000
    s_lshl_b32 s30, s21, 11
    s_lshl_b32 s26, s20, 10
    s_add_u32 s30, s30, s26
    s_add_u32 s30, s30, 0x1b00000
    s_lshl_b32 s26, s21, 7
    s_add_u32 s31, s26, 12288
    s_add_u32 s41, s26, 0
    s_add_u32 s42, s26, 16384
    s_mov_b32 s40, 0x3dd53b95
    s_mul_i32 s34, s20, 10240
    s_add_u32 s35, s34, 0xc00000
    s_mov_b32 s37, s34
    v_mov_b32 v4, 4
Lwi_105:
    buffer_load_dword v5, v4, s[88:91], 0 offen sc1
    s_waitcnt vmcnt(0)
    v_cmp_gt_u32 vcc, 224, v5
    s_cbranch_vccz Lwid_106
    s_sub_u32 s101, s101, 1
    s_cbranch_scc1 L_abort
    s_sleep 8
    s_branch Lwi_105
Lwid_106:
    s_add_u32 m0, s37, 0
    s_add_u32 s36, s35, 0
    buffer_load_dwordx4 v2, s[4:7], s36 offen offset:0 sc1 lds
    buffer_load_dwordx4 v2, s[4:7], s36 offen offset:1024 sc1 lds
    buffer_load_dwordx4 v2, s[4:7], s36 offen offset:2048 sc1 lds
    buffer_load_dwordx4 v2, s[4:7], s36 offen offset:3072 sc1 lds
    s_add_u32 m0, s37, 4096
    s_add_u32 s36, s35, 4096
    buffer_load_dwordx4 v2, s[4:7], s36 offen offset:0 sc1 lds
    buffer_load_dwordx4 v2, s[4:7], s36 offen offset:1024 sc1 lds
    buffer_load_dwordx4 v2, s[4:7], s36 offen offset:2048 sc1 lds
    buffer_load_dwordx4 v2, s[4:7], s36 offen offset:3072 sc1 lds
    s_add_u32 m0, s37, 8192
    s_add_u32 s36, s35, 8192
    buffer_load_dwordx4 v2, s[4:7], s36 offen offset:0 sc1 lds
    buffer_load_dwordx4 v2, s[4:7], s36 offen offset:1024 sc1 lds
    s_waitcnt vmcnt(0)
    s_barrier
    s_mov_b32 s43, 1
    s_min_u32 s33, s43, 63
    s_mul_i32 s35, s33, 40960
    s_add_u32 s35, s35, s34
    s_add_u32 s35, s35, 0xc00000
    s_and_b32 s32, s43, 1
    s_mul_i32 s37, s32, 40960
    s_add_u32 s37, s37, s34
    v_mov_b32 v92, v2
    ds_read_b128 v[24:27], v92 offset:0
    ds_read_b128 v[28:31], v92 offset:20480
    ds_read_b128 v[32:35], v92 offset:1024
    ds_read_b128 v[36:39], v92 offset:21504
    ds_read_b128 v[40:43], v92 offset:2048
    ds_read_b128 v[44:47], v92 offset:22528
    ds_read_b128 v[48:51], v92 offset:3072
    ds_read_b128 v[52:55], v92 offset:23552
    s_waitcnt lgkmcnt(6)
    v_mfma_f32_16x16x32_bf16 v[64:67], a[0:3], v[24:27], 0
    v_mfma_f32_16x16x32_bf16 v[68:71], a[0:3], v[28:31], 0
    v_mfma_f32_16x16x32_bf16 v[72:75], a[80:83], v[24:27], 0
    v_mfma_f32_16x16x32_bf16 v[76:79], a[80:83], v[28:31], 0
    v_mfma_f32_16x16x32_bf16 v[80:83], a[160:163], v[24:27], 0
    v_mfma_f32_16x16x32_bf16 v[84:87], a[160:163], v[28:31], 0
    s_add_u32 m0, s37, 0
    s_add_u32 s36, s35, 0
    buffer_load_dwordx4 v2, s[4:7], s36 offen offset:0 sc1 lds
    ds_read_b128 v[24:27], v92 offset:4096
    ds_read_b128 v[28:31], v92 offset:24576
    s_waitcnt lgkmcnt(6)
    v_mfma_f32_16x16x32_bf16 v[64:67], a[4:7], v[32:35], v[64:67]
    v_mfma_f32_16x16x32_bf16 v[68:71], a[4:7], v[36:39], v[68:71]
    v_mfma_f32_16x16x32_bf16 v[72:75], a[84:87], v[32:35], v[72:75]
    v_mfma_f32_16x16x32_bf16 v[76:79], a[84:87], v[36:39], v[76:79]
    v_mfma_f32_16x16x32_bf16 v[80:83], a[164:167], v[32:35], v[80:83]
    v_mfma_f32_16x16x32_bf16 v[84:87], a[164:167], v[36:39], v[84:87]
    buffer_load_dwordx4 v2, s[4:7], s36 offen offset:1024 sc1 lds
    ds_read_b128 v[32:35], v92 offset:5120
    ds_read_b128 v[36:39], v92 offset:25600
    s_waitcnt lgkmcnt(6)
    v_mfma_f32_16x16x32_bf16 v[64:67], a[8:11], v[40:43], v[64:67]
    v_mfma_f32_16x16x32_bf16 v[68:71], a[8:11], v[44:47], v[68:71]
    v_mfma_f32_16x16x32_bf16 v[72:75], a[88:91], v[40:43], v[72:75]
    v_mfma_f32_16x16x32_bf16 v[76:79], a[88:91], v[44:47], v[76:79]
    v_mfma_f32_16x16x32_bf16 v[80:83], a[168:171], v[40:43], v[80:83]
    v_mfma_f32_16x16x32_bf16 v[84:87], a[168:171], v[44:47], v[84:87]
    buffer_load_dwordx4 v2, s[4:7], s36 offen offset:2048 sc1 lds
    ds_read_b128 v[40:43], v92 offset:6144
    ds_read_b128 v[44:47], v92 offset:26624
    s_waitcnt lgkmcnt(6)
    v_mfma_f32_16x16x32_bf16 v[64:67], a[12:15], v[48:51], v[64:67]
    v_mfma_f32_16x16x32_bf16 v[68:71], a[12:15], v[52:55], v[68:71]
    v_mfma_f32_16x16x32_bf16 v[72:75], a[92:95], v[48:51], v[72:75]
    v_mfma_f32_16x16x32_bf16 v[76:79], a[92:95], v[52:55], v[76:79]
    v_mfma_f32_16x16x32_bf16 v[80:83], a[172:175], v[48:51], v[80:83]
    v_mfma_f32_16x16x32_bf16 v[84:87], a[172:175], v[52:55], v[84:87]
    buffer_load_dwordx4 v2, s[4:7], s36 offen offset:3072 sc1 lds
    ds_read_b128 v[48:51], v92 offset:7168
    ds_read_b128 v[52:55], v92 offset:27648
    s_waitcnt lgkmcnt(6)
    v_mfma_f32_16x16x32_bf16 v[64:67], a[16:19], v[24:27], v[64:67]
    v_mfma_f32_16x16x32_bf16 v[68:71], a[16:19], v[28:31], v[68:71]
    v_mfma_f32_16x16x32_bf16 v[72:75], a[96:99], v[24:27], v[72:75]
    v_mfma_f32_16x16x32_bf16 v[76:79], a[96:99], v[28:31], v[76:79]
    v_mfma_f32_16x16x32_bf16 v[80:83], a[176:179], v[24:27], v[80:83]
    v_mfma_f32_16x16x32_bf16 v[84:87], a[176:179], v[28:31], v[84:87]
    s_add_u32 m0, s37, 4096
    s_add_u32 s36, s35, 4096
    buffer_load_dwordx4 v2, s[4:7], s36 offen offset:0 sc1 lds
    ds_read_b128 v[24:27], v92 offset:8192
    ds_read_b128 v[28:31], v92 offset:28672
    s_waitcnt lgkmcnt(6)
    v_mfma_f32_16x16x32_bf16 v[64:67], a[20:23], v[32:35], v[64:67]
    v_mfma_f32_16x16x32_bf16 v[68:71], a[20:23], v[36:39], v[68:71]
    v_mfma_f32_16x16x32_bf16 v[72:75], a[100:103], v[32:35], v[72:75]
    v_mfma_f32_16x16x32_bf16 v[76:79], a[100:103], v[36:39], v[76:79]
    v_mfma_f32_16x16x32_bf16 v[80:83], a[180:183], v[32:35], v[80:83]
    v_mfma_f32_16x16x32_bf16 v[84:87], a[180:183], v[36:39], v[84:87]
    buffer_load_dwordx4 v2, s[4:7], s36 offen offset:1024 sc1 lds
    ds_read_b128 v[32:35], v92 offset:9216
    ds_read_b128 v[36:39], v92 offset:29696
    s_waitcnt lgkmcnt(6)
    v_mfma_f32_16x16x32_bf16 v[64:67], a[24:27], v[40:43], v[64:67]
    v_mfma_f32_16x16x32_bf16 v[68:71], a[24:27], v[44:47], v[68:71]
    v_mfma_f32_16x16x32_bf16 v[72:75], a[104:107], v[40:43], v[72:75]
    v_mfma_f32_16x16x32_bf16 v[76:79], a[104:107], v[44:47], v[76:79]
    v_mfma_f32_16x16x32_bf16 v[80:83], a[184:187], v[40:43], v[80:83]
    v_mfma_f32_16x16x32_bf16 v[84:87], a[184:187], v[44:47], v[84:87]
    buffer_load_dwordx4 v2, s[4:7], s36 offen offset:2048 sc1 lds
    ds_read_b128 v[40:43], v92 offset:10240
    ds_read_b128 v[44:47], v92 offset:30720
    s_waitcnt lgkmcnt(6)
    v_mfma_f32_16x16x32_bf16 v[64:67], a[28:31], v[48:51], v[64:67]
    v_mfma_f32_16x16x32_bf16 v[68:71], a[28:31], v[52:55], v[68:71]
    v_mfma_f32_16x16x32_bf16 v[72:75], a[108:111], v[48:51], v[72:75]
    v_mfma_f32_16x16x32_bf16 v[76:79], a[108:111], v[52:55], v[76:79]
    v_mfma_f32_16x16x32_bf16 v[80:83], a[188:191], v[48:51], v[80:83]
    v_mfma_f32_16x16x32_bf16 v[84:87], a[188:191], v[52:55], v[84:87]
    buffer_load_dwordx4 v2, s[4:7], s36 offen offset:3072 sc1 lds
    ds_read_b128 v[48:51], v92 offset:11264
    ds_read_b128 v[52:55], v92 offset:31744
    s_waitcnt lgkmcnt(6)
    v_mfma_f32_16x16x32_bf16 v[64:67], a[32:35], v[24:27], v[64:67]
    v_mfma_f32_16x16x32_bf16 v[68:71], a[32:35], v[28:31], v[68:71]
    v_mfma_f32_16x16x32_bf16 v[72:75], a[112:115], v[24:27], v[72:75]
    v_mfma_f32_16x16x32_bf16 v[76:79], a[112:115], v[28:31], v[76:79]
    v_mfma_f32_16x16x32_bf16 v[80:83], a[192:195], v[24:27], v[80:83]
    v_mfma_f32_16x16x32_bf16 v[84:87], a[192:195], v[28:31], v[84:87]
    s_add_u32 m0, s37, 8192
    s_add_u32 s36, s35, 8192
    buffer_load_dwordx4 v2, s[4:7], s36 offen offset:0 sc1 lds
    ds_read_b128 v[24:27], v92 offset:12288
    ds_read_b128 v[28:31], v92 offset:32768
    s_waitcnt lgkmcnt(6)
    v_mfma_f32_16x16x32_bf16 v[64:67], a[36:39], v[32:35], v[64:67]
    v_mfma_f32_16x16x32_bf16 v[68:71], a[36:39], v[36:39], v[68:71]
    v_mfma_f32_16x16x32_bf16 v[72:75], a[116:119], v[32:35], v[72:75]
    v_mfma_f32_16x16x32_bf16 v[76:79], a[116:119], v[36:39], v[76:79]
    v_mfma_f32_16x16x32_bf16 v[80:83], a[196:199], v[32:35], v[80:83]
    v_mfma_f32_16x16x32_bf16 v[84:87], a[196:199], v[36:39], v[84:87]
    buffer_load_dwordx4 v2, s[4:7], s36 offen offset:1024 sc1 lds
    ds_read_b128 v[32:35], v92 offset:13312
    ds_read_b128 v[36:39], v92 offset:33792
    s_waitcnt lgkmcnt(6)
    v_mfma_f32_16x16x32_bf16 v[64:67], a[40:43], v[40:43], v[64:67]
    v_mfma_f32_16x16x32_bf16 v[68:71], a[40:43], v[44:47], v[68:71]
    v_mfma_f32_16x16x32_bf16 v[72:75], a[120:123], v[40:43], v[72:75]
    v_mfma_f32_16x16x32_bf16 v[76:79], a[120:123], v[44:47], v[76:79]
    v_mfma_f32_16x16x32_bf16 v[80:83], a[200:203], v[40:43], v[80:83]
    v_mfma_f32_16x16x32_bf16 v[84:87], a[200:203], v[44:47], v[84:87]
    ds_read_b128 v[40:43], v92 offset:14336
    ds_read_b128 v[44:47], v92 offset:34816
    s_waitcnt lgkmcnt(6)
    v_mfma_f32_16x16x32_bf16 v[64:67], a[44:47], v[48:51], v[64:67]
    v_mfma_f32_16x16x32_bf16 v[68:71], a[44:47], v[52:55], v[68:71]
    v_mfma_f32_16x16x32_bf16 v[72:75], a[124:127], v[48:51], v[72:75]
    v_mfma_f32_16x16x32_bf16 v[76:79], a[124:127], v[52:55], v[76:79]
    v_mfma_f32_16x16x32_bf16 v[80:83], a[204:207], v[48:51], v[80:83]
    v_mfma_f32_16x16x32_bf16 v[84:87], a[204:207], v[52:55], v[84:87]
    ds_read_b128 v[48:51], v92 offset:15360
    ds_read_b128 v[52:55], v92 offset:35840
    s_waitcnt lgkmcnt(6)
    v_mfma_f32_16x16x32_bf16 v[64:67], a[48:51], v[24:27], v[64:67]
    v_mfma_f32_16x16x32_bf16 v[68:71], a[48:51], v[28:31], v[68:71]
    v_mfma_f32_16x16x32_bf16 v[72:75], a[128:131], v[24:27], v[72:75]
    v_mfma_f32_16x16x32_bf16 v[76:79], a[128:131], v[28:31], v[76:79]
    v_mfma_f32_16x16x32_bf16 v[80:83], a[208:211], v[24:27], v[80:83]
    v_mfma_f32_16x16x32_bf16 v[84:87], a[208:211], v[28:31], v[84:87]
    ds_read_b128 v[24:27], v92 offset:16384
    ds_read_b128 v[28:31], v92 offset:36864
    s_waitcnt lgkmcnt(6)
    v_mfma_f32_16x16x32_bf16 v[64:67], a[52:55], v[32:35], v[64:67]
    v_mfma_f32_16x16x32_bf16 v[68:71], a[52:55], v[36:39], v[68:71]
    v_mfma_f32_16x16x32_bf16 v[72:75], a[132:135], v[32:35], v[72:75]
    v_mfma_f32_16x16x32_bf16 v[76:79], a[132:135], v[36:39], v[76:79]
    v_mfma_f32_16x16x32_bf16 v[80:83], a[212:215], v[32:35], v[80:83]
    v_mfma_f32_16x16x32_bf16 v[84:87], a[212:215], v[36:39], v[84:87]
    ds_read_b128 v[32:35], v92 offset:17408
    ds_read_b128 v[36:39], v92 offset:37888
    s_waitcnt lgkmcnt(6)
    v_mfma_f32_16x16x32_bf16 v[64:67], a[56:59], v[40:43], v[64:67]
    v_mfma_f32_16x16x32_bf16 v[68:71], a[56:59], v[44:47], v[68:71]
    v_mfma_f32_16x16x32_bf16 v[72:75], a[136:139], v[40:43], v[72:75]
    v_mfma_f32_16x16x32_bf16 v[76:79], a[136:139], v[44:47], v[76:79]
    v_mfma_f32_16x16x32_bf16 v[80:83], a[216:219], v[40:43], v[80:83]
    v_mfma_f32_16x16x32_bf16 v[84:87], a[216:219], v[44:47], v[84:87]
    ds_read_b128 v[40:43], v92 offset:18432
    ds_read_b128 v[44:47], v92 offset:38912
    s_waitcnt lgkmcnt(6)
    v_mfma_f32_16x16x32_bf16 v[64:67], a[60:63], v[48:51], v[64:67]
    v_mfma_f32_16x16x32_bf16 v[68:71], a[60:63], v[52:55], v[68:71]
    v_mfma_f32_16x16x32_bf16 v[72:75], a[140:143], v[48:51], v[72:75]
    v_mfma_f32_16x16x32_bf16 v[76:79], a[140:143], v[52:55], v[76:79]
    v_mfma_f32_16x16x32_bf16 v[80:83], a[220:223], v[48:51], v[80:83]
    v_mfma_f32_16x16x32_bf16 v[84:87], a[220:223], v[52:55], v[84:87]
    ds_read_b128 v[48:51], v92 offset:19456
    ds_read_b128 v[52:55], v92 offset:39936
    s_waitcnt lgkmcnt(6)
    v_mfma_f32_16x16x32_bf16 v[64:67], a[64:67], v[24:27], v[64:67]
    v_mfma_f32_16x16x32_bf16 v[68:71], a[64:67], v[28:31], v[68:71]
    v_mfma_f32_16x16x32_bf16 v[72:75], a[144:147], v[24:27], v[72:75]
    v_mfma_f32_16x16x32_bf16 v[76:79], a[144:147], v[28:31], v[76:79]
    v_mfma_f32_16x16x32_bf16 v[80:83], a[224:227], v[24:27], v[80:83]
    v_mfma_f32_16x16x32_bf16 v[84:87], a[224:227], v[28:31], v[84:87]
    s_waitcnt lgkmcnt(4)
    v_mfma_f32_16x16x32_bf16 v[64:67], a[68:71], v[32:35], v[64:67]
    v_mfma_f32_16x16x32_bf16 v[68:71], a[68:71], v[36:39], v[68:71]
    v_mfma_f32_16x16x32_bf16 v[72:75], a[148:151], v[32:35], v[72:75]
    v_mfma_f32_16x16x32_bf16 v[76:79], a[148:151], v[36:39], v[76:79]
    v_mfma_f32_16x16x32_bf16 v[80:83], a[228:231], v[32:35], v[80:83]
    v_mfma_f32_16x16x32_bf16 v[84:87], a[228:231], v[36:39], v[84:87]
    s_waitcnt lgkmcnt(2)
    v_mfma_f32_16x16x32_bf16 v[64:67], a[72:75], v[40:43], v[64:67]
    v_mfma_f32_16x16x32_bf16 v[68:71], a[72:75], v[44:47], v[68:71]
    v_mfma_f32_16x16x32_bf16 v[72:75], a[152:155], v[40:43], v[72:75]
    v_mfma_f32_16x16x32_bf16 v[76:79], a[152:155], v[44:47], v[76:79]
    v_mfma_f32_16x16x32_bf16 v[80:83], a[232:235], v[40:43], v[80:83]
    v_mfma_f32_16x16x32_bf16 v[84:87], a[232:235], v[44:47], v[84:87]
    s_waitcnt lgkmcnt(0)
    v_mfma_f32_16x16x32_bf16 v[64:67], a[76:79], v[48:51], v[64:67]
    v_mfma_f32_16x16x32_bf16 v[68:71], a[76:79], v[52:55], v[68:71]
    v_mfma_f32_16x16x32_bf16 v[72:75], a[156:159], v[48:51], v[72:75]
    v_mfma_f32_16x16x32_bf16 v[76:79], a[156:159], v[52:55], v[76:79]
    v_mfma_f32_16x16x32_bf16 v[80:83], a[236:239], v[48:51], v[80:83]
    v_mfma_f32_16x16x32_bf16 v[84:87], a[236:239], v[52:55], v[84:87]
    s_nop 2
    v_cvt_pk_bf16_f32 v96, v64, v65
    v_cvt_pk_bf16_f32 v97, v66, v67
    v_cvt_pk_bf16_f32 v98, v72, v73
    v_cvt_pk_bf16_f32 v99, v74, v75
    v_cvt_pk_bf16_f32 v100, v68, v69
    v_cvt_pk_bf16_f32 v101, v70, v71
    v_cvt_pk_bf16_f32 v102, v76, v77
    v_cvt_pk_bf16_f32 v103, v78, v79
    v_cvt_pk_bf16_f32 v104, v80, v81
    v_cvt_pk_bf16_f32 v105, v82, v83
    v_cvt_pk_bf16_f32 v106, v84, v85
    v_cvt_pk_bf16_f32 v107, v86, v87
    s_waitcnt vmcnt(0)
    s_barrier
    s_mov_b32 s24, 0
Lqa_loop:
    s_add_u32 s43, s24, 1
    v_cmp_gt_u32 vcc, s43, v94
    s_cbranch_vccz Lck_107
Lw_108:
    buffer_load_dword v94, v93, s[4:7], s41 offen sc1
    s_waitcnt vmcnt(0)
    v_cmp_gt_u32 vcc, s43, v94
    s_cbranch_vccz Lwd_109
    s_sub_u32 s101, s101, 1
    s_cbranch_scc1 L_abort
    s_sleep 2
    s_branch Lw_108
Lwd_109:
Lck_107:
    s_mul_i32 s32, s24, 393216
    s_add_u32 s32, s32, s28
    buffer_load_dwordx4 v[108:111], v2, s[4:7], s32 offen offset:0 sc1
    buffer_load_dwordx4 v[112:115], v2, s[4:7], s32 offen offset:1024 sc1
    buffer_load_dwordx4 v[116:119], v2, s[4:7], s32 offen offset:2048 sc1
    buffer_load_dword v94, v93, s[4:7], s41 offen sc1
    s_add_u32 s26, s24, 2
    s_min_u32 s33, s26, 63
    s_mul_i32 s35, s33, 40960
    s_add_u32 s35, s35, s34
    s_add_u32 s35, s35, 0xc00000
    s_and_b32 s32, s26, 1
    s_mul_i32 s37, s32, 40960
    s_add_u32 s37, s37, s34
    s_and_b32 s32, s43, 1
    s_mul_i32 s32, s32, 40960
    v_add_u32 v92, s32, v2
    s_cmp_eq_u32 s24, 63
    s_cbranch_scc1 Lqa_noq
    ds_read_b128 v[24:27], v92 offset:0
    ds_read_b128 v[28:31], v92 offset:20480
    ds_read_b128 v[32:35], v92 offset:1024
    ds_read_b128 v[36:39], v92 offset:21504
    ds_read_b128 v[40:43], v92 offset:2048
    ds_read_b128 v[44:47], v92 offset:22528
    ds_read_b128 v[48:51], v92 offset:3072
    ds_read_b128 v[52:55], v92 offset:23552
    s_waitcnt lgkmcnt(6)
    v_mfma_f32_16x16x32_bf16 v[64:67], a[0:3], v[24:27], 0
    v_mfma_f32_16x16x32_bf16 v[68:71], a[0:3], v[28:31], 0
    v_mfma_f32_16x16x32_bf16 v[72:75], a[80:83], v[24:27], 0
    v_mfma_f32_16x16x32_bf16 v[76:79], a[80:83], v[28:31], 0
    v_mfma_f32_16x16x32_bf16 v[80:83], a[160:163], v[24:27], 0
    v_mfma_f32_16x16x32_bf16 v[84:87], a[160:163], v[28:31], 0
    s_add_u32 m0, s37, 0
    s_add_u32 s36, s35, 0
    buffer_load_dwordx4 v2, s[4:7], s36 offen offset:0 sc1 lds
    ds_read_b128 v[24:27], v92 offset:4096
    ds_read_b128 v[28:31], v92 offset:24576
    s_waitcnt lgkmcnt(6)
    v_mfma_f32_16x16x32_bf16 v[64:67], a[4:7], v[32:35], v[64:67]
    v_mfma_f32_16x16x32_bf16 v[68:71], a[4:7], v[36:39], v[68:71]
    v_mfma_f32_16x16x32_bf16 v[72:75], a[84:87], v[32:35], v[72:75]
    v_mfma_f32_16x16x32_bf16 v[76:79], a[84:87], v[36:39], v[76:79]
    v_mfma_f32_16x16x32_bf16 v[80:83], a[164:167], v[32:35], v[80:83]
    v_mfma_f32_16x16x32_bf16 v[84:87], a[164:167], v[36:39], v[84:87]
    buffer_load_dwordx4 v2, s[4:7], s36 offen offset:1024 sc1 lds
    ds_read_b128 v[32:35], v92 offset:5120
    ds_read_b128 v[36:39], v92 offset:25600
    s_waitcnt lgkmcnt(6)
    v_mfma_f32_16x16x32_bf16 v[64:67], a[8:11], v[40:43], v[64:67]
    v_mfma_f32_16x16x32_bf16 v[68:71], a[8:11], v[44:47], v[68:71]
    v_mfma_f32_16x16x32_bf16 v[72:75], a[88:91], v[40:43], v[72:75]
    v_mfma_f32_16x16x32_bf16 v[76:79], a[88:91], v[44:47], v[76:79]
    v_mfma_f32_16x16x32_bf16 v[80:83], a[168:171], v[40:43], v[80:83]
    v_mfma_f32_16x16x32_bf16 v[84:87], a[168:171], v[44:47], v[84:87]
    buffer_load_dwordx4 v2, s[4:7], s36 offen offset:2048 sc1 lds
    ds_read_b128 v[40:43], v92 offset:6144
    ds_read_b128 v[44:47], v92 offset:26624
    s_waitcnt lgkmcnt(6)
    v_mfma_f32_16x16x32_bf16 v[64:67], a[12:15], v[48:51], v[64:67]
    v_mfma_f32_16x16x32_bf16 v[68:71], a[12:15], v[52:55], v[68:71]
    v_mfma_f32_16x16x32_bf16 v[72:75], a[92:95], v[48:51], v[72:75]
    v_mfma_f32_16x16x32_bf16 v[76:79], a[92:95], v[52:55], v[76:79]
    v_mfma_f32_16x16x32_bf16 v[80:83], a[172:175], v[48:51], v[80:83]
    v_mfma_f32_16x16x32_bf16 v[84:87], a[172:175], v[52:55], v[84:87]
    buffer_load_dwordx4 v2, s[4:7], s36 offen offset:3072 sc1 lds
    ds_read_b128 v[48:51], v92 offset:7168
    ds_read_b128 v[52:55], v92 offset:27648
    s_waitcnt lgkmcnt(6)
    v_mfma_f32_16x16x32_bf16 v[64:67], a[16:19], v[24:27], v[64:67]
    v_mfma_f32_16x16x32_bf16 v[68:71], a[16:19], v[28:31], v[68:71]
    v_mfma_f32_16x16x32_bf16 v[72:75], a[96:99], v[24:27], v[72:75]
    v_mfma_f32_16x16x32_bf16 v[76:79], a[96:99], v[28:31], v[76:79]
    v_mfma_f32_16x16x32_bf16 v[80:83], a[176:179], v[24:27], v[80:83]
    v_mfma_f32_16x16x32_bf16 v[84:87], a[176:179], v[28:31], v[84:87]
    s_add_u32 m0, s37, 4096
    s_add_u32 s36, s35, 4096
    buffer_load_dwordx4 v2, s[4:7], s36 offen offset:0 sc1 lds
    ds_read_b128 v[24:27], v92 offset:8192
    ds_read_b128 v[28:31], v92 offset:28672
    s_waitcnt lgkmcnt(6)
    v_mfma_f32_16x16x32_bf16 v[64:67], a[20:23], v[32:35], v[64:67]
    v_mfma_f32_16x16x32_bf16 v[68:71], a[20:23], v[36:39], v[68:71]
    v_mfma_f32_16x16x32_bf16 v[72:75], a[100:103], v[32:35], v[72:75]
    v_mfma_f32_16x16x32_bf16 v[76:79], a[100:103], v[36:39], v[76:79]
    v_mfma_f32_16x16x32_bf16 v[80:83], a[180:183], v[32:35], v[80:83]
    v_mfma_f32_16x16x32_bf16 v[84:87], a[180:183], v[36:39], v[84:87]
    buffer_load_dwordx4 v2, s[4:7], s36 offen offset:1024 sc1 lds
    ds_read_b128 v[32:35], v92 offset:9216
    ds_read_b128 v[36:39], v92 offset:29696
    s_waitcnt lgkmcnt(6)
    v_mfma_f32_16x16x32_bf16 v[64:67], a[24:27], v[40:43], v[64:67]
    v_mfma_f32_16x16x32_bf16 v[68:71], a[24:27], v[44:47], v[68:71]
    v_mfma_f32_16x16x32_bf16 v[72:75], a[104:107], v[40:43], v[72:75]
    v_mfma_f32_16x16x32_bf16 v[76:79], a[104:107], v[44:47], v[76:79]
    v_mfma_f32_16x16x32_bf16 v[80:83], a[184:187], v[40:43], v[80:83]
    v_mfma_f32_16x16x32_bf16 v[84:87], a[184:187], v[44:47], v[84:87]
    buffer_load_dwordx4 v2, s[4:7], s36 offen offset:2048 sc1 lds
    ds_read_b128 v[40:43], v92 offset:10240
    ds_read_b128 v[44:47], v92 offset:30720
    s_waitcnt lgkmcnt(6)
    v_mfma_f32_16x16x32_bf16 v[64:67], a[28:31], v[48:51], v[64:67]
    v_mfma_f32_16x16x32_bf16 v[68:71], a[28:31], v[52:55], v[68:71]
    v_mfma_f32_16x16x32_bf16 v[72:75], a[108:111], v[48:51], v[72:75]
    v_mfma_f32_16x16x32_bf16 v[76:79], a[108:111], v[52:55], v[76:79]
    v_mfma_f32_16x16x32_bf16 v[80:83], a[188:191], v[48:51], v[80:83]
    v_mfma_f32_16x16x32_bf16 v[84:87], a[188:191], v[52:55], v[84:87]
    buffer_load_dwordx4 v2, s[4:7], s36 offen offset:3072 sc1 lds
    ds_read_b128 v[48:51], v92 offset:11264
    ds_read_b128 v[52:55], v92 offset:31744
    s_waitcnt lgkmcnt(6)
    v_mfma_f32_16x16x32_bf16 v[64:67], a[32:35], v[24:27], v[64:67]
    v_mfma_f32_16x16x32_bf16 v[68:71], a[32:35], v[28:31], v[68:71]
    v_mfma_f32_16x16x32_bf16 v[72:75], a[112:115], v[24:27], v[72:75]
    v_mfma_f32_16x16x32_bf16 v[76:79], a[112:115], v[28:31], v[76:79]
    v_mfma_f32_16x16x32_bf16 v[80:83], a[192:195], v[24:27], v[80:83]
    v_mfma_f32_16x16x32_bf16 v[84:87], a[192:195], v[28:31], v[84:87]
    s_add_u32 m0, s37, 8192
    s_add_u32 s36, s35, 8192
    buffer_load_dwordx4 v2, s[4:7], s36 offen offset:0 sc1 lds
    ds_read_b128 v[24:27], v92 offset:12288
    ds_read_b128 v[28:31], v92 offset:32768
    s_waitcnt lgkmcnt(6)
    v_mfma_f32_16x16x32_bf16 v[64:67], a[36:39], v[32:35], v[64:67]
    v_mfma_f32_16x16x32_bf16 v[68:71], a[36:39], v[36:39], v[68:71]
    v_mfma_f32_16x16x32_bf16 v[72:75], a[116:119], v[32:35], v[72:75]
    v_mfma_f32_16x16x32_bf16 v[76:79], a[116:119], v[36:39], v[76:79]
    v_mfma_f32_16x16x32_bf16 v[80:83], a[196:199], v[32:35], v[80:83]
    v_mfma_f32_16x16x32_bf16 v[84:87], a[196:199], v[36:39], v[84:87]
    buffer_load_dwordx4 v2, s[4:7], s36 offen offset:1024 sc1 lds
    ds_read_b128 v[32:35], v92 offset:13312
    ds_read_b128 v[36:39], v92 offset:33792
    s_waitcnt lgkmcnt(6)
    v_mfma_f32_16x16x32_bf16 v[64:67], a[40:43], v[40:43], v[64:67]
    v_mfma_f32_16x16x32_bf16 v[68:71], a[40:43], v[44:47], v[68:71]
    v_mfma_f32_16x16x32_bf16 v[72:75], a[120:123], v[40:43], v[72:75]
    v_mfma_f32_16x16x32_bf16 v[76:79], a[120:123], v[44:47], v[76:79]
    v_mfma_f32_16x16x32_bf16 v[80:83], a[200:203], v[40:43], v[80:83]
    v_mfma_f32_16x16x32_bf16 v[84:87], a[200:203], v[44:47], v[84:87]
    ds_read_b128 v[40:43], v92 offset:14336
    ds_read_b128 v[44:47], v92 offset:34816
    s_waitcnt lgkmcnt(6)
    v_mfma_f32_16x16x32_bf16 v[64:67], a[44:47], v[48:51], v[64:67]
    v_mfma_f32_16x16x32_bf16 v[68:71], a[44:47], v[52:55], v[68:71]
    v_mfma_f32_16x16x32_bf16 v[72:75], a[124:127], v[48:51], v[72:75]
    v_mfma_f32_16x16x32_bf16 v[76:79], a[124:127], v[52:55], v[76:79]
    v_mfma_f32_16x16x32_bf16 v[80:83], a[204:207], v[48:51], v[80:83]
    v_mfma_f32_16x16x32_bf16 v[84:87], a[204:207], v[52:55], v[84:87]
    ds_read_b128 v[48:51], v92 offset:15360
    ds_read_b128 v[52:55], v92 offset:35840
    s_waitcnt lgkmcnt(6)
    v_mfma_f32_16x16x32_bf16 v[64:67], a[48:51], v[24:27], v[64:67]
    v_mfma_f32_16x16x32_bf16 v[68:71], a[48:51], v[28:31], v[68:71]
    v_mfma_f32_16x16x32_bf16 v[72:75], a[128:131], v[24:27], v[72:75]
    v_mfma_f32_16x16x32_bf16 v[76:79], a[128:131], v[28:31], v[76:79]
    v_mfma_f32_16x16x32_bf16 v[80:83], a[208:211], v[24:27], v[80:83]
    v_mfma_f32_16x16x32_bf16 v[84:87], a[208:211], v[28:31], v[84:87]
    ds_read_b128 v[24:27], v92 offset:16384
    ds_read_b128 v[28:31], v92 offset:36864
    s_waitcnt lgkmcnt(6)
    v_mfma_f32_16x16x32_bf16 v[64:67], a[52:55], v[32:35], v[64:67]
    v_mfma_f32_16x16x32_bf16 v[68:71], a[52:55], v[36:39], v[68:71]
    v_mfma_f32_16x16x32_bf16 v[72:75], a[132:135], v[32:35], v[72:75]
    v_mfma_f32_16x16x32_bf16 v[76:79], a[132:135], v[36:39], v[76:79]
    v_mfma_f32_16x16x32_bf16 v[80:83], a[212:215], v[32:35], v[80:83]
    v_mfma_f32_16x16x32_bf16 v[84:87], a[212:215], v[36:39], v[84:87]
    ds_read_b128 v[32:35], v92 offset:17408
    ds_read_b128 v[36:39], v92 offset:37888
    s_waitcnt lgkmcnt(6)
    v_mfma_f32_16x16x32_bf16 v[64:67], a[56:59], v[40:43], v[64:67]
    v_mfma_f32_16x16x32_bf16 v[68:71], a[56:59], v[44:47], v[68:71]
    v_mfma_f32_16x16x32_bf16 v[72:75], a[136:139], v[40:43], v[72:75]
    v_mfma_f32_16x16x32_bf16 v[76:79], a[136:139], v[44:47], v[76:79]
    v_mfma_f32_16x16x32_bf16 v[80:83], a[216:219], v[40:43], v[80:83]
    v_mfma_f32_16x16x32_bf16 v[84:87], a[216:219], v[44:47], v[84:87]
    ds_read_b128 v[40:43], v92 offset:18432
    ds_read_b128 v[44:47], v92 offset:38912
    s_waitcnt lgkmcnt(6)
    v_mfma_f32_16x16x32_bf16 v[64:67], a[60:63], v[48:51], v[64:67]
    v_mfma_f32_16x16x32_bf16 v[68:71], a[60:63], v[52:55], v[68:71]
    v_mfma_f32_16x16x32_bf16 v[72:75], a[140:143], v[48:51], v[72:75]
    v_mfma_f32_16x16x32_bf16 v[76:79], a[140:143], v[52:55], v[76:79]
    v_mfma_f32_16x16x32_bf16 v[80:83], a[220:223], v[48:51], v[80:83]
    v_mfma_f32_16x16x32_bf16 v[84:87], a[220:223], v[52:55], v[84:87]
    ds_read_b128 v[48:51], v92 offset:19456
    ds_read_b128 v[52:55], v92 offset:39936
    s_waitcnt lgkmcnt(6)
    v_mfma_f32_16x16x32_bf16 v[64:67], a[64:67], v[24:27], v[64:67]
    v_mfma_f32_16x16x32_bf16 v[68:71], a[64:67], v[28:31], v[68:71]
    v_mfma_f32_16x16x32_bf16 v[72:75], a[144:147], v[24:27], v[72:75]
    v_mfma_f32_16x16x32_bf16 v[76:79], a[144:147], v[28:31], v[76:79]
    v_mfma_f32_16x16x32_bf16 v[80:83], a[224:227], v[24:27], v[80:83]
    v_mfma_f32_16x16x32_bf16 v[84:87], a[224:227], v[28:31], v[84:87]
    s_waitcnt lgkmcnt(4)
    v_mfma_f32_16x16x32_bf16 v[64:67], a[68:71], v[32:35], v[64:67]
    v_mfma_f32_16x16x32_bf16 v[68:71], a[68:71], v[36:39], v[68:71]
    v_mfma_f32_16x16x32_bf16 v[72:75], a[148:151], v[32:35], v[72:75]
    v_mfma_f32_16x16x32_bf16 v[76:79], a[148:151], v[36:39], v[76:79]
    v_mfma_f32_16x16x32_bf16 v[80:83], a[228:231], v[32:35], v[80:83]
    v_mfma_f32_16x16x32_bf16 v[84:87], a[228:231], v[36:39], v[84:87]
    s_waitcnt lgkmcnt(2)
    v_mfma_f32_16x16x32_bf16 v[64:67], a[72:75], v[40:43], v[64:67]
    v_mfma_f32_16x16x32_bf16 v[68:71], a[72:75], v[44:47], v[68:71]
    v_mfma_f32_16x16x32_bf16 v[72:75], a[152:155], v[40:43], v[72:75]
    v_mfma_f32_16x16x32_bf16 v[76:79], a[152:155], v[44:47], v[76:79]
    v_mfma_f32_16x16x32_bf16 v[80:83], a[232:235], v[40:43], v[80:83]
    v_mfma_f32_16x16x32_bf16 v[84:87], a[232:235], v[44:47], v[84:87]
    s_waitcnt lgkmcnt(0)
    v_mfma_f32_16x16x32_bf16 v[64:67], a[76:79], v[48:51], v[64:67]
    v_mfma_f32_16x16x32_bf16 v[68:71], a[76:79], v[52:55], v[68:71]
    v_mfma_f32_16x16x32_bf16 v[72:75], a[156:159], v[48:51], v[72:75]
    v_mfma_f32_16x16x32_bf16 v[76:79], a[156:159], v[52:55], v[76:79]
    v_mfma_f32_16x16x32_bf16 v[80:83], a[236:239], v[48:51], v[80:83]
    v_mfma_f32_16x16x32_bf16 v[84:87], a[236:239], v[52:55], v[84:87]
    s_nop 2
    v_cvt_pk_bf16_f32 v152, v64, v65
    v_cvt_pk_bf16_f32 v153, v66, v67
    v_cvt_pk_bf16_f32 v154, v72, v73
    v_cvt_pk_bf16_f32 v155, v74, v75
    v_cvt_pk_bf16_f32 v156, v68, v69
    v_cvt_pk_bf16_f32 v157, v70, v71
    v_cvt_pk_bf16_f32 v158, v76, v77
    v_cvt_pk_bf16_f32 v159, v78, v79
    v_cvt_pk_bf16_f32 v160, v80, v81
    v_cvt_pk_bf16_f32 v161, v82, v83
    v_cvt_pk_bf16_f32 v162, v84, v85
    v_cvt_pk_bf16_f32 v163, v86, v87
Lqa_noq:
    s_waitcnt vmcnt(0)
    s_barrier
    s_cmp_lg_u32 s20, 0
    s_cbranch_scc1 Lqa_nf_110
    v_mov_b32 v6, s24
    s_mov_b64 exec, 1
    buffer_store_dword v6, v93, s[4:7], s31 offen sc1
    s_mov_b64 exec, -1
Lqa_nf_110:
    v_cmp_gt_u32 vcc, s43, v95
    s_cbranch_vccz Lck_111
Lw_112:
    buffer_load_dword v95, v93, s[4:7], s42 offen sc1
    s_waitcnt vmcnt(0)
    v_cmp_gt_u32 vcc, s43, v95
    s_cbranch_vccz Lwd_113
    s_sub_u32 s101, s101, 1
    s_cbranch_scc1 L_abort
    s_sleep 2
    s_branch Lw_112
Lwd_113:
Lck_111:
    s_mul_i32 s32, s24, 196608
    s_add_u32 s32, s32, s29
    buffer_load_dwordx4 v[120:123], v126, s[4:7], s32 offen sc1
    buffer_load_dwordx2 v[124:125], v127, s[4:7], s32 offen offset:1024 sc1
    buffer_load_dword v95, v93, s[4:7], s42 offen sc1
    v_mfma_f32_16x16x32_bf16 v[132:135], v[108:111], v[96:99], 0
    v_mfma_f32_16x16x32_bf16 v[140:143], v[108:111], v[100:103], 0
    v_mfma_f32_16x16x32_bf16 v[144:147], v[112:115], v[100:103], 0
    v_mfma_f32_16x16x16_bf16 v[132:135], v[116:117], v[104:105], v[132:135]
    v_mfma_f32_16x16x16_bf16 v[140:143], v[116:117], v[106:107], v[140:143]
    v_mfma_f32_16x16x16_bf16 v[144:147], v[118:119], v[106:107], v[144:147]
    s_waitcnt vmcnt(1)
    v_mfma_f32_16x16x32_bf16 v[128:131], v[120:123], v[96:99], 0
    v_mfma_f32_16x16x32_bf16 v[136:139], v[120:123], v[100:103], 0
    v_mfma_f32_16x16x16_bf16 v[128:131], v[124:125], v[104:105], v[128:131]
    v_mfma_f32_16x16x16_bf16 v[136:139], v[124:125], v[106:107], v[136:139]
    s_nop 0
    ds_write_b128 v148, v[132:135] offset:1024
    ds_write_b128 v148, v[140:143] offset:3072
    ds_write_b128 v148, v[144:147] offset:4096
    s_nop 2
    ds_write_b128 v148, v[128:131] offset:0
    ds_write_b128 v148, v[136:139] offset:2048
    s_waitcnt lgkmcnt(0)
    s_barrier
    s_cmp_ge_u32 s20, 2
    s_cbranch_scc1 Lqa_next
    v_add_u32 v3, 81920, v2
    s_mul_i32 s32, s24, 65536
    s_add_u32 s32, s32, s30
    s_mul_i32 s33, s24, 16384
    s_cmp_eq_u32 s20, 1
    s_cbranch_scc1 Lqa_rt1
    ds_read_b128 v[8:11], v3 offset:0
    ds_read_b128 v[12:15], v3 offset:1024
    ds_read_b128 v[16:19], v3 offset:5120
    ds_read_b128 v[20:23], v3 offset:6144
    ds_read_b128 v[24:27], v3 offset:10240
    ds_read_b128 v[28:31], v3 offset:11264
    ds_read_b128 v[32:35], v3 offset:15360
    ds_read_b128 v[36:39], v3 offset:16384
    s_waitcnt lgkmcnt(0)
    v_add_f32 v64, v8, v16
    v_add_f32 v8, v24, v32
    v_add_f32 v65, v9, v17
    v_add_f32 v9, v25, v33
    v_add_f32 v66, v10, v18
    v_add_f32 v10, v26, v34
    v_add_f32 v67, v11, v19
    v_add_f32 v11, v27, v35
    v_add_f32 v68, v12, v20
    v_add_f32 v12, v28, v36
    v_add_f32 v69, v13, v21
    v_add_f32 v13, v29, v37
    v_add_f32 v70, v14, v22
    v_add_f32 v14, v30, v38
    v_add_f32 v71, v15, v23
    v_add_f32 v15, v31, v39
    v_add_f32 v64, v64, v8
    v_add_f32 v65, v65, v9
    v_add_f32 v66, v66, v10
    v_add_f32 v67, v67, v11
    v_add_f32 v68, v68, v12
    v_add_f32 v69, v69, v13
    v_add_f32 v70, v70, v14
    v_add_f32 v71, v71, v15
    s_mov_b32 exec_lo, 0xffffffff
    s_mov_b32 exec_hi, 0x0
    v_mov_b32 v64, v150
    v_mov_b32 v65, v150
    v_mov_b32 v66, v150
    v_mov_b32 v67, v150
    s_mov_b64 exec, -1
    v_cndmask_b32 v68, v150, v68, s[44:45]
    v_cndmask_b32 v69, v150, v69, s[46:47]
    v_cndmask_b32 v70, v150, v70, s[48:49]
    v_cndmask_b32 v71, v150, v71, s[50:51]
    v_max3_f32 v80, v64, v65, v66
    v_max3_f32 v80, v80, v67, v68
    v_max3_f32 v80, v80, v69, v70
    v_max_f32 v80, v80, v71
    v_mov_b32 v81, v80
    s_nop 1
    v_permlane16_swap_b32 v80, v81
    v_max_f32 v80, v80, v81
    v_mov_b32 v81, v80
    s_nop 1
    v_permlane32_swap_b32 v80, v81
    v_max_f32 v80, v80, v81
    v_mul_f32 v80, s40, v80
    v_fma_f32 v64, v64, s40, -v80
    v_fma_f32 v65, v65, s40, -v80
    v_fma_f32 v66, v66, s40, -v80
    v_fma_f32 v67, v67, s40, -v80
    v_fma_f32 v68, v68, s40, -v80
    v_fma_f32 v69, v69, s40, -v80
    v_fma_f32 v70, v70, s40, -v80
    v_fma_f32 v71, v71, s40, -v80
    v_exp_f32 v64, v64
    v_exp_f32 v65, v65
    v_exp_f32 v66, v66
    v_exp_f32 v67, v67
    v_exp_f32 v68, v68
    v_exp_f32 v69, v69
    v_exp_f32 v70, v70
    v_exp_f32 v71, v71
    v_add_f32 v80, v64, v65
    v_add_f32 v81, v66, v67
    v_add_f32 v80, v80, v68
    v_add_f32 v81, v81, v69
    v_add_f32 v80, v80, v70
    v_add_f32 v81, v81, v71
    v_add_f32 v80, v80, v81
    v_mov_b32 v81, v80
    s_nop 1
    v_permlane16_swap_b32 v80, v81
    v_add_f32 v80, v80, v81
    v_mov_b32 v81, v80
    s_nop 1
    v_permlane32_swap_b32 v80, v81
    v_add_f32 v80, v80, v81
    v_rcp_f32 v80, v80
    s_nop 0
    v_mul_f32 v64, v64, v80
    v_mul_f32 v65, v65, v80
    v_mul_f32 v66, v66, v80
    v_mul_f32 v67, v67, v80
    v_mul_f32 v68, v68, v80
    v_mul_f32 v69, v69, v80
    v_mul_f32 v70, v70, v80
    v_mul_f32 v71, v71, v80
    v_cvt_pk_bf16_f32 v84, v68, v69
    v_cvt_pk_bf16_f32 v86, v70, v71
    v_mov_b32 v85, 0
    v_mov_b32 v87, 0
    v_cvt_pk_bf16_f32 v88, v64, v65
    v_cvt_pk_bf16_f32 v89, v66, v67
    buffer_store_dwordx4 v[84:87], v2, s[4:7], s32 offen sc1
    s_mov_b32 exec_lo, 0x0
    s_mov_b32 exec_hi, 0xffffffff
    buffer_store_dwordx2 v[88:89], v149, s[4:7], s33 offen sc1
    s_mov_b64 exec, -1
    s_branch Lqa_next
Lqa_rt1:
    ds_read_b128 v[8:11], v3 offset:2048
    ds_read_b128 v[12:15], v3 offset:3072
    ds_read_b128 v[16:19], v3 offset:4096
    ds_read_b128 v[20:23], v3 offset:7168
    ds_read_b128 v[24:27], v3 offset:8192
    ds_read_b128 v[28:31], v3 offset:9216
    ds_read_b128 v[32:35], v3 offset:12288
    ds_read_b128 v[36:39], v3 offset:13312
    ds_read_b128 v[40:43], v3 offset:14336
    ds_read_b128 v[44:47], v3 offset:17408
    ds_read_b128 v[48:51], v3 offset:18432
    ds_read_b128 v[52:55], v3 offset:19456
    s_waitcnt lgkmcnt(0)
    v_add_f32 v64, v8, v20
    v_add_f32 v8, v32, v44
    v_add_f32 v65, v9, v21
    v_add_f32 v9, v33, v45
    v_add_f32 v66, v10, v22
    v_add_f32 v10, v34, v46
    v_add_f32 v67, v11, v23
    v_add_f32 v11, v35, v47
    v_add_f32 v68, v12, v24
    v_add_f32 v12, v36, v48
    v_add_f32 v69, v13, v25
    v_add_f32 v13, v37, v49
    v_add_f32 v70, v14, v26
    v_add_f32 v14, v38, v50
    v_add_f32 v71, v15, v27
    v_add_f32 v15, v39, v51
    v_add_f32 v72, v16, v28
    v_add_f32 v16, v40, v52
    v_add_f32 v73, v17, v29
    v_add_f32 v17, v41, v53
    v_add_f32 v74, v18, v30
    v_add_f32 v18, v42, v54
    v_add_f32 v75, v19, v31
    v_add_f32 v19, v43, v55
    v_add_f32 v64, v64, v8
    v_add_f32 v65, v65, v9
    v_add_f32 v66, v66, v10
    v_add_f32 v67, v67, v11
    v_add_f32 v68, v68, v12
    v_add_f32 v69, v69, v13
    v_add_f32 v70, v70, v14
    v_add_f32 v71, v71, v15
    v_add_f32 v72, v72, v16
    v_add_f32 v73, v73, v17
    v_add_f32 v74, v74, v18
    v_add_f32 v75, v75, v19
    s_mov_b32 exec_lo, 0xffffffff
    s_mov_b32 exec_hi, 0x0
    v_mov_b32 v64, v150
    v_mov_b32 v65, v150
    v_mov_b32 v66, v150
    v_mov_b32 v67, v150
    s_mov_b64 exec, -1
    v_cndmask_b32 v72, v150, v72, s[44:45]
    v_cndmask_b32 v73, v150, v73, s[46:47]
    v_cndmask_b32 v74, v150, v74, s[48:49]
    v_cndmask_b32 v75, v150, v75, s[50:51]
    v_max3_f32 v80, v64, v65, v66
    v_max3_f32 v80, v80, v67, v68
    v_max3_f32 v80, v80, v69, v70
    v_max3_f32 v80, v80, v71, v72
    v_max3_f32 v80, v80, v73, v74
    v_max_f32 v80, v80, v75
    v_mov_b32 v81, v80
    s_nop 1
    v_permlane16_swap_b32 v80, v81
    v_max_f32 v80, v80, v81
    v_mov_b32 v81, v80
    s_nop 1
    v_permlane32_swap_b32 v80, v81
    v_max_f32 v80, v80, v81
    v_mul_f32 v80, s40, v80
    v_fma_f32 v64, v64, s40, -v80
    v_fma_f32 v65, v65, s40, -v80
    v_fma_f32 v66, v66, s40, -v80
    v_fma_f32 v67, v67, s40, -v80
    v_fma_f32 v68, v68, s40, -v80
    v_fma_f32 v69, v69, s40, -v80
    v_fma_f32 v70, v70, s40, -v80
    v_fma_f32 v71, v71, s40, -v80
    v_fma_f32 v72, v72, s40, -v80
    v_fma_f32 v73, v73, s40, -v80
    v_fma_f32 v74, v74, s40, -v80
    v_fma_f32 v75, v75, s40, -v80
    v_exp_f32 v64, v64
    v_exp_f32 v65, v65
    v_exp_f32 v66, v66
    v_exp_f32 v67, v67
    v_exp_f32 v68, v68
    v_exp_f32 v69, v69
    v_exp_f32 v70, v70
    v_exp_f32 v71, v71
    v_exp_f32 v72, v72
    v_exp_f32 v73, v73
    v_exp_f32 v74, v74
    v_exp_f32 v75, v75
    v_add_f32 v80, v64, v65
    v_add_f32 v81, v66, v67
    v_add_f32 v80, v80, v68
    v_add_f32 v81, v81, v69
    v_add_f32 v80, v80, v70
    v_add_f32 v81, v81, v71
    v_add_f32 v80, v80, v72
    v_add_f32 v81, v81, v73
    v_add_f32 v80, v80, v74
    v_add_f32 v81, v81, v75
    v_add_f32 v80, v80, v81
    v_mov_b32 v81, v80
    s_nop 1
    v_permlane16_swap_b32 v80, v81
    v_add_f32 v80, v80, v81
    v_mov_b32 v81, v80
    s_nop 1
    v_permlane32_swap_b32 v80, v81
    v_add_f32 v80, v80, v81
    v_rcp_f32 v80, v80
    s_nop 0
    v_mul_f32 v64, v64, v80
    v_mul_f32 v65, v65, v80
    v_mul_f32 v66, v66, v80
    v_mul_f32 v67, v67, v80
    v_mul_f32 v68, v68, v80
    v_mul_f32 v69, v69, v80
    v_mul_f32 v70, v70, v80
    v_mul_f32 v71, v71, v80
    v_mul_f32 v72, v72, v80
    v_mul_f32 v73, v73, v80
    v_mul_f32 v74, v74, v80
    v_mul_f32 v75, v75, v80
    v_cvt_pk_bf16_f32 v84, v68, v69
    v_cvt_pk_bf16_f32 v86, v70, v71
    v_cvt_pk_bf16_f32 v85, v72, v73
    v_cvt_pk_bf16_f32 v87, v74, v75
    v_cvt_pk_bf16_f32 v88, v64, v65
    v_cvt_pk_bf16_f32 v89, v66, v67
    buffer_store_dwordx4 v[84:87], v2, s[4:7], s32 offen sc1
    s_mov_b32 exec_lo, 0x0
    s_mov_b32 exec_hi, 0xffffffff
    buffer_store_dwordx2 v[88:89], v149, s[4:7], s33 offen sc1
    s_mov_b64 exec, -1
Lqa_next:
    v_mov_b32 v96, v152
    v_mov_b32 v97, v153
    v_mov_b32 v98, v154
    v_mov_b32 v99, v155
    v_mov_b32 v100, v156
    v_mov_b32 v101, v157
    v_mov_b32 v102, v158
    v_mov_b32 v103, v159
    v_mov_b32 v104, v160
    v_mov_b32 v105, v161
    v_mov_b32 v106, v162
    v_mov_b32 v107, v163
    s_add_u32 s24, s24, 1
    s_cmp_lt_u32 s24, 64
    s_cbranch_scc1 Lqa_loop
    s_waitcnt vmcnt(0)
    s_barrier
    s_cmp_lg_u32 s20, 0
    s_cbranch_scc1 Lff_114
    v_mov_b32 v6, 64
    s_mov_b64 exec, 1
    buffer_store_dword v6, v93, s[4:7], s31 offen sc1
    s_mov_b64 exec, -1
Lff_114:
    s_branch L_exit
Ld_f1a:
    v_mov_b32 v4, 4
Lwi_115:
    buffer_load_dword v5, v4, s[88:91], 0 offen sc1
    s_waitcnt vmcnt(0)
    v_cmp_gt_u32 vcc, 224, v5
    s_cbranch_vccz Lwid_116
    s_sub_u32 s101, s101, 1
    s_cbranch_scc1 L_abort
    s_sleep 8
    s_branch Lwi_115
Lwid_116:
    v_mov_b32 v5, 0
    s_mov_b32 s26, 16384
    s_mov_b32 s27, 2
Lw_117:
    buffer_load_dword v6, v5, s[4:7], s26 offen sc1
    s_waitcnt vmcnt(0)
    v_cmp_gt_u32 vcc, s27, v6
    s_cbranch_vccz Lwd_118
    s_sub_u32 s101, s101, 1
    s_cbranch_scc1 L_abort
    s_sleep 32
    s_branch Lw_117
Lwd_118:
    s_mov_b32 s22, 0
Ld_f1:
    s_load_dwordx2 s[8:9], s[0:1], 64
    s_waitcnt lgkmcnt(0)
    s_mov_b32 s10, 0x1e0000
    s_mov_b32 s11, 0x20000
    s_load_dwordx2 s[12:13], s[0:1], 72
    s_waitcnt lgkmcnt(0)
    s_mov_b32 s14, 0x1e0000
    s_mov_b32 s15, 0x20000
    v_add_u32 v3, 0, v0
    v_mul_u32_u24 v4, 0x2ab, v3
    v_lshrrev_b32 v4, 13, v4
    v_mul_u32_u24 v5, 12, v4
    v_sub_u32 v5, v3, v5
    v_mul_u32_u24 v8, 0xc00, v4
    v_lshl_add_u32 v8, v5, 4, v8
    v_mul_u32_u24 v14, 0x1a0, v4
    v_lshl_add_u32 v14, v5, 4, v14
    v_add_u32 v17, 192, v14
    v_add_u32 v3, 256, v0
    v_mul_u32_u24 v4, 0x2ab, v3
    v_lshrrev_b32 v4, 13, v4
    v_mul_u32_u24 v5, 12, v4
    v_sub_u32 v5, v3, v5
    v_mul_u32_u24 v9, 0xc00, v4
    v_lshl_add_u32 v9, v5, 4, v9
    v_mul_u32_u24 v15, 0x1a0, v4
    v_lshl_add_u32 v15, v5, 4, v15
    v_add_u32 v18, 192, v15
    v_add_u32 v3, 512, v0
    v_mul_u32_u24 v4, 0x2ab, v3
    v_lshrrev_b32 v4, 13, v4
    v_mul_u32_u24 v5, 12, v4
    v_sub_u32 v5, v3, v5
    v_mul_u32_u24 v10, 0xc00, v4
    v_lshl_add_u32 v10, v5, 4, v10
    v_mul_u32_u24 v16, 0x1a0, v4
    v_lshl_add_u32 v16, v5, 4, v16
    v_add_u32 v19, 192, v16
    s_mul_i32 s25, s21, 192
    v_and_b32 v3, 15, v1
    v_lshrrev_b32 v4, 4, v1
    v_lshrrev_b32 v5, 2, v3
    v_lshl_add_u32 v5, v4, 2, v5
    v_mul_u32_u24 v20, 0x1a0, v5
    v_and_b32 v3, 3, v3
    v_and_b32 v4, 1, v3
    v_lshl_add_u32 v20, v4, 3, v20
    v_lshrrev_b32 v4, 1, v3
    v_mul_u32_u24 v4, 0xc0, v4
    v_add_u32 v20, v4, v20
    s_mul_i32 s26, s20, 48
    v_add_u32 v20, s26, v20
    buffer_load_dwordx4 v[24:27], v8, s[8:11], s25 offen
    buffer_load_dwordx4 v[28:31], v9, s[8:11], s25 offen
    buffer_load_dwordx4 v[32:35], v10, s[8:11], s25 offen
    buffer_load_dwordx4 v[36:39], v8, s[12:15], s25 offen
    buffer_load_dwordx4 v[40:43], v9, s[12:15], s25 offen
    buffer_load_dwordx4 v[44:47], v10, s[12:15], s25 offen
    s_add_u32 s25, s25, 0x30000
    buffer_load_dwordx4 v[48:51], v8, s[8:11], s25 offen
    buffer_load_dwordx4 v[52:55], v9, s[8:11], s25 offen
    buffer_load_dwordx4 v[56:59], v10, s[8:11], s25 offen
    buffer_load_dwordx4 v[60:63], v8, s[12:15], s25 offen
    buffer_load_dwordx4 v[64:67], v9, s[12:15], s25 offen
    buffer_load_dwordx4 v[68:71], v10, s[12:15], s25 offen
    s_add_u32 s25, s25, 0x30000
    buffer_load_dwordx4 v[72:75], v8, s[8:11], s25 offen
    buffer_load_dwordx4 v[76:79], v9, s[8:11], s25 offen
    buffer_load_dwordx4 v[80:83], v10, s[8:11], s25 offen
    buffer_load_dwordx4 v[84:87], v8, s[12:15], s25 offen
    buffer_load_dwordx4 v[88:91], v9, s[12:15], s25 offen
    buffer_load_dwordx4 v[92:95], v10, s[12:15], s25 offen
    s_add_u32 s25, s25, 0x30000
    s_waitcnt vmcnt(12)
    ds_write_b128 v14, v[24:27] offset:0
    ds_write_b128 v15, v[28:31] offset:0
    ds_write_b128 v16, v[32:35] offset:0
    ds_write_b128 v17, v[36:39] offset:0
    ds_write_b128 v18, v[40:43] offset:0
    ds_write_b128 v19, v[44:47] offset:0
    s_waitcnt lgkmcnt(0)
    buffer_load_dwordx4 v[24:27], v8, s[8:11], s25 offen
    buffer_load_dwordx4 v[28:31], v9, s[8:11], s25 offen
    buffer_load_dwordx4 v[32:35], v10, s[8:11], s25 offen
    buffer_load_dwordx4 v[36:39], v8, s[12:15], s25 offen
    buffer_load_dwordx4 v[40:43], v9, s[12:15], s25 offen
    buffer_load_dwordx4 v[44:47], v10, s[12:15], s25 offen
    s_add_u32 s25, s25, 0x30000
    s_barrier
    ds_read_b64_tr_b16 a[0:1], v20 offset:0
    ds_read_b64_tr_b16 a[2:3], v20 offset:6656
    ds_read_b64_tr_b16 a[80:81], v20 offset:16
    ds_read_b64_tr_b16 a[82:83], v20 offset:6672
    ds_read_b64_tr_b16 a[160:161], v20 offset:32
    ds_read_b64_tr_b16 a[162:163], v20 offset:6688
    ds_read_b64_tr_b16 a[4:5], v20 offset:13312
    ds_read_b64_tr_b16 a[6:7], v20 offset:19968
    ds_read_b64_tr_b16 a[84:85], v20 offset:13328
    ds_read_b64_tr_b16 a[86:87], v20 offset:19984
    ds_read_b64_tr_b16 a[164:165], v20 offset:13344
    ds_read_b64_tr_b16 a[166:167], v20 offset:20000
    s_waitcnt vmcnt(12)
    ds_write_b128 v14, v[48:51] offset:26624
    ds_write_b128 v15, v[52:55] offset:26624
    ds_write_b128 v16, v[56:59] offset:26624
    ds_write_b128 v17, v[60:63] offset:26624
    ds_write_b128 v18, v[64:67] offset:26624
    ds_write_b128 v19, v[68:71] offset:26624
    s_waitcnt lgkmcnt(0)
    buffer_load_dwordx4 v[48:51], v8, s[8:11], s25 offen
    buffer_load_dwordx4 v[52:55], v9, s[8:11], s25 offen
    buffer_load_dwordx4 v[56:59], v10, s[8:11], s25 offen
    buffer_load_dwordx4 v[60:63], v8, s[12:15], s25 offen
    buffer_load_dwordx4 v[64:67], v9, s[12:15], s25 offen
    buffer_load_dwordx4 v[68:71], v10, s[12:15], s25 offen
    s_add_u32 s25, s25, 0x30000
    s_barrier
    ds_read_b64_tr_b16 a[8:9], v20 offset:26624
    ds_read_b64_tr_b16 a[10:11], v20 offset:33280
    ds_read_b64_tr_b16 a[88:89], v20 offset:26640
    ds_read_b64_tr_b16 a[90:91], v20 offset:33296
    ds_read_b64_tr_b16 a[168:169], v20 offset:26656
    ds_read_b64_tr_b16 a[170:171], v20 offset:33312
    ds_read_b64_tr_b16 a[12:13], v20 offset:39936
    ds_read_b64_tr_b16 a[14:15], v20 offset:46592
    ds_read_b64_tr_b16 a[92:93], v20 offset:39952
    ds_read_b64_tr_b16 a[94:95], v20 offset:46608
    ds_read_b64_tr_b16 a[172:173], v20 offset:39968
    ds_read_b64_tr_b16 a[174:175], v20 offset:46624
    s_waitcnt vmcnt(12)
    ds_write_b128 v14, v[72:75] offset:0
    ds_write_b128 v15, v[76:79] offset:0
    ds_write_b128 v16, v[80:83] offset:0
    ds_write_b128 v17, v[84:87] offset:0
    ds_write_b128 v18, v[88:91] offset:0
    ds_write_b128 v19, v[92:95] offset:0
    s_waitcnt lgkmcnt(0)
    buffer_load_dwordx4 v[72:75], v8, s[8:11], s25 offen
    buffer_load_dwordx4 v[76:79], v9, s[8:11], s25 offen
    buffer_load_dwordx4 v[80:83], v10, s[8:11], s25 offen
    buffer_load_dwordx4 v[84:87], v8, s[12:15], s25 offen
    buffer_load_dwordx4 v[88:91], v9, s[12:15], s25 offen
    buffer_load_dwordx4 v[92:95], v10, s[12:15], s25 offen
    s_add_u32 s25, s25, 0x30000
    s_barrier
    ds_read_b64_tr_b16 a[16:17], v20 offset:0
    ds_read_b64_tr_b16 a[18:19], v20 offset:6656
    ds_read_b64_tr_b16 a[96:97], v20 offset:16
    ds_read_b64_tr_b16 a[98:99], v20 offset:6672
    ds_read_b64_tr_b16 a[176:177], v20 offset:32
    ds_read_b64_tr_b16 a[178:179], v20 offset:6688
    ds_read_b64_tr_b16 a[20:21], v20 offset:13312
    ds_read_b64_tr_b16 a[22:23], v20 offset:19968
    ds_read_b64_tr_b16 a[100:101], v20 offset:13328
    ds_read_b64_tr_b16 a[102:103], v20 offset:19984
    ds_read_b64_tr_b16 a[180:181], v20 offset:13344
    ds_read_b64_tr_b16 a[182:183], v20 offset:20000
    s_waitcnt vmcnt(12)
    ds_write_b128 v14, v[24:27] offset:26624
    ds_write_b128 v15, v[28:31] offset:26624
    ds_write_b128 v16, v[32:35] offset:26624
    ds_write_b128 v17, v[36:39] offset:26624
    ds_write_b128 v18, v[40:43] offset:26624
    ds_write_b128 v19, v[44:47] offset:26624
    s_waitcnt lgkmcnt(0)
    buffer_load_dwordx4 v[24:27], v8, s[8:11], s25 offen
    buffer_load_dwordx4 v[28:31], v9, s[8:11], s25 offen
    buffer_load_dwordx4 v[32:35], v10, s[8:11], s25 offen
    buffer_load_dwordx4 v[36:39], v8, s[12:15], s25 offen
    buffer_load_dwordx4 v[40:43], v9, s[12:15], s25 offen
    buffer_load_dwordx4 v[44:47], v10, s[12:15], s25 offen
    s_add_u32 s25, s25, 0x30000
    s_barrier
    ds_read_b64_tr_b16 a[24:25], v20 offset:26624
    ds_read_b64_tr_b16 a[26:27], v20 offset:33280
    ds_read_b64_tr_b16 a[104:105], v20 offset:26640
    ds_read_b64_tr_b16 a[106:107], v20 offset:33296
    ds_read_b64_tr_b16 a[184:185], v20 offset:26656
    ds_read_b64_tr_b16 a[186:187], v20 offset:33312
    ds_read_b64_tr_b16 a[28:29], v20 offset:39936
    ds_read_b64_tr_b16 a[30:31], v20 offset:46592
    ds_read_b64_tr_b16 a[108:109], v20 offset:39952
    ds_read_b64_tr_b16 a[110:111], v20 offset:46608
    ds_read_b64_tr_b16 a[188:189], v20 offset:39968
    ds_read_b64_tr_b16 a[190:191], v20 offset:46624
    s_waitcnt vmcnt(12)
    ds_write_b128 v14, v[48:51] offset:0
    ds_write_b128 v15, v[52:55] offset:0
    ds_write_b128 v16, v[56:59] offset:0
    ds_write_b128 v17, v[60:63] offset:0
    ds_write_b128 v18, v[64:67] offset:0
    ds_write_b128 v19, v[68:71] offset:0
    s_waitcnt lgkmcnt(0)
    buffer_load_dwordx4 v[48:51], v8, s[8:11], s25 offen
    buffer_load_dwordx4 v[52:55], v9, s[8:11], s25 offen
    buffer_load_dwordx4 v[56:59], v10, s[8:11], s25 offen
    buffer_load_dwordx4 v[60:63], v8, s[12:15], s25 offen
    buffer_load_dwordx4 v[64:67], v9, s[12:15], s25 offen
    buffer_load_dwordx4 v[68:71], v10, s[12:15], s25 offen
    s_add_u32 s25, s25, 0x30000
    s_barrier
    ds_read_b64_tr_b16 a[32:33], v20 offset:0
    ds_read_b64_tr_b16 a[34:35], v20 offset:6656
    ds_read_b64_tr_b16 a[112:113], v20 offset:16
    ds_read_b64_tr_b16 a[114:115], v20 offset:6672
    ds_read_b64_tr_b16 a[192:193], v20 offset:32
    ds_read_b64_tr_b16 a[194:195], v20 offset:6688
    ds_read_b64_tr_b16 a[36:37], v20 offset:13312
    ds_read_b64_tr_b16 a[38:39], v20 offset:19968
    ds_read_b64_tr_b16 a[116:117], v20 offset:13328
    ds_read_b64_tr_b16 a[118:119], v20 offset:19984
    ds_read_b64_tr_b16 a[196:197], v20 offset:13344
    ds_read_b64_tr_b16 a[198:199], v20 offset:20000
    s_waitcnt vmcnt(12)
    ds_write_b128 v14, v[72:75] offset:26624
    ds_write_b128 v15, v[76:79] offset:26624
    ds_write_b128 v16, v[80:83] offset:26624
    ds_write_b128 v17, v[84:87] offset:26624
    ds_write_b128 v18, v[88:91] offset:26624
    ds_write_b128 v19, v[92:95] offset:26624
    s_waitcnt lgkmcnt(0)
    buffer_load_dwordx4 v[72:75], v8, s[8:11], s25 offen
    buffer_load_dwordx4 v[76:79], v9, s[8:11], s25 offen
    buffer_load_dwordx4 v[80:83], v10, s[8:11], s25 offen
    buffer_load_dwordx4 v[84:87], v8, s[12:15], s25 offen
    buffer_load_dwordx4 v[88:91], v9, s[12:15], s25 offen
    buffer_load_dwordx4 v[92:95], v10, s[12:15], s25 offen
    s_add_u32 s25, s25, 0x30000
    s_barrier
    ds_read_b64_tr_b16 a[40:41], v20 offset:26624
    ds_read_b64_tr_b16 a[42:43], v20 offset:33280
    ds_read_b64_tr_b16 a[120:121], v20 offset:26640
    ds_read_b64_tr_b16 a[122:123], v20 offset:33296
    ds_read_b64_tr_b16 a[200:201], v20 offset:26656
    ds_read_b64_tr_b16 a[202:203], v20 offset:33312
    ds_read_b64_tr_b16 a[44:45], v20 offset:39936
    ds_read_b64_tr_b16 a[46:47], v20 offset:46592
    ds_read_b64_tr_b16 a[124:125], v20 offset:39952
    ds_read_b64_tr_b16 a[126:127], v20 offset:46608
    ds_read_b64_tr_b16 a[204:205], v20 offset:39968
    ds_read_b64_tr_b16 a[206:207], v20 offset:46624
    s_waitcnt vmcnt(12)
    ds_write_b128 v14, v[24:27] offset:0
    ds_write_b128 v15, v[28:31] offset:0
    ds_write_b128 v16, v[32:35] offset:0
    ds_write_b128 v17, v[36:39] offset:0
    ds_write_b128 v18, v[40:43] offset:0
    ds_write_b128 v19, v[44:47] offset:0
    s_waitcnt lgkmcnt(0)
    buffer_load_dwordx4 v[24:27], v8, s[8:11], s25 offen
    buffer_load_dwordx4 v[28:31], v9, s[8:11], s25 offen
    buffer_load_dwordx4 v[32:35], v10, s[8:11], s25 offen
    buffer_load_dwordx4 v[36:39], v8, s[12:15], s25 offen
    buffer_load_dwordx4 v[40:43], v9, s[12:15], s25 offen
    buffer_load_dwordx4 v[44:47], v10, s[12:15], s25 offen
    s_add_u32 s25, s25, 0x30000
    s_barrier
    ds_read_b64_tr_b16 a[48:49], v20 offset:0
    ds_read_b64_tr_b16 a[50:51], v20 offset:6656
    ds_read_b64_tr_b16 a[128:129], v20 offset:16
    ds_read_b64_tr_b16 a[130:131], v20 offset:6672
    ds_read_b64_tr_b16 a[208:209], v20 offset:32
    ds_read_b64_tr_b16 a[210:211], v20 offset:6688
    ds_read_b64_tr_b16 a[52:53], v20 offset:13312
    ds_read_b64_tr_b16 a[54:55], v20 offset:19968
    ds_read_b64_tr_b16 a[132:133], v20 offset:13328
    ds_read_b64_tr_b16 a[134:135], v20 offset:19984
    ds_read_b64_tr_b16 a[212:213], v20 offset:13344
    ds_read_b64_tr_b16 a[214:215], v20 offset:20000
    s_waitcnt vmcnt(12)
    ds_write_b128 v14, v[48:51] offset:26624
    ds_write_b128 v15, v[52:55] offset:26624
    ds_write_b128 v16, v[56:59] offset:26624
    ds_write_b128 v17, v[60:63] offset:26624
    ds_write_b128 v18, v[64:67] offset:26624
    ds_write_b128 v19, v[68:71] offset:26624
    s_waitcnt lgkmcnt(0)
    s_barrier
    ds_read_b64_tr_b16 a[56:57], v20 offset:26624
    ds_read_b64_tr_b16 a[58:59], v20 offset:33280
    ds_read_b64_tr_b16 a[136:137], v20 offset:26640
    ds_read_b64_tr_b16 a[138:139], v20 offset:33296
    ds_read_b64_tr_b16 a[216:217], v20 offset:26656
    ds_read_b64_tr_b16 a[218:219], v20 offset:33312
    ds_read_b64_tr_b16 a[60:61], v20 offset:39936
    ds_read_b64_tr_b16 a[62:63], v20 offset:46592
    ds_read_b64_tr_b16 a[140:141], v20 offset:39952
    ds_read_b64_tr_b16 a[142:143], v20 offset:46608
    ds_read_b64_tr_b16 a[220:221], v20 offset:39968
    ds_read_b64_tr_b16 a[222:223], v20 offset:46624
    s_waitcnt vmcnt(6)
    ds_write_b128 v14, v[72:75] offset:0
    ds_write_b128 v15, v[76:79] offset:0
    ds_write_b128 v16, v[80:83] offset:0
    ds_write_b128 v17, v[84:87] offset:0
    ds_write_b128 v18, v[88:91] offset:0
    ds_write_b128 v19, v[92:95] offset:0
    s_waitcnt lgkmcnt(0)
    s_barrier
    ds_read_b64_tr_b16 a[64:65], v20 offset:0
    ds_read_b64_tr_b16 a[66:67], v20 offset:6656
    ds_read_b64_tr_b16 a[144:145], v20 offset:16
    ds_read_b64_tr_b16 a[146:147], v20 offset:6672
    ds_read_b64_tr_b16 a[224:225], v20 offset:32
    ds_read_b64_tr_b16 a[226:227], v20 offset:6688
    ds_read_b64_tr_b16 a[68:69], v20 offset:13312
    ds_read_b64_tr_b16 a[70:71], v20 offset:19968
    ds_read_b64_tr_b16 a[148:149], v20 offset:13328
    ds_read_b64_tr_b16 a[150:151], v20 offset:19984
    ds_read_b64_tr_b16 a[228:229], v20 offset:13344
    ds_read_b64_tr_b16 a[230:231], v20 offset:20000
    s_waitcnt vmcnt(0)
    ds_write_b128 v14, v[24:27] offset:26624
    ds_write_b128 v15, v[28:31] offset:26624
    ds_write_b128 v16, v[32:35] offset:26624
    ds_write_b128 v17, v[36:39] offset:26624
    ds_write_b128 v18, v[40:43] offset:26624
    ds_write_b128 v19, v[44:47] offset:26624
    s_waitcnt lgkmcnt(0)
    s_barrier
    ds_read_b64_tr_b16 a[72:73], v20 offset:26624
    ds_read_b64_tr_b16 a[74:75], v20 offset:33280
    ds_read_b64_tr_b16 a[152:153], v20 offset:26640
    ds_read_b64_tr_b16 a[154:155], v20 offset:33296
    ds_read_b64_tr_b16 a[232:233], v20 offset:26656
    ds_read_b64_tr_b16 a[234:235], v20 offset:33312
    ds_read_b64_tr_b16 a[76:77], v20 offset:39936
    ds_read_b64_tr_b16 a[78:79], v20 offset:46592
    ds_read_b64_tr_b16 a[156:157], v20 offset:39952
    ds_read_b64_tr_b16 a[158:159], v20 offset:46608
    ds_read_b64_tr_b16 a[236:237], v20 offset:39968
    ds_read_b64_tr_b16 a[238:239], v20 offset:46624
    s_waitcnt lgkmcnt(0)
    s_barrier
    v_mov_b32 v108, 0x3f803f80
    v_mov_b32 v109, 0x3f803f80
    v_mov_b32 v110, 0x3f803f80
    v_mov_b32 v111, 0x3f803f80
    s_nop 1
    v_mfma_f32_16x16x32_bf16 v[96:99], a[0:3], v[108:111], 0
    v_mfma_f32_16x16x32_bf16 v[96:99], a[4:7], v[108:111], v[96:99]
    v_mfma_f32_16x16x32_bf16 v[96:99], a[8:11], v[108:111], v[96:99]
    v_mfma_f32_16x16x32_bf16 v[96:99], a[12:15], v[108:111], v[96:99]
    v_mfma_f32_16x16x32_bf16 v[96:99], a[16:19], v[108:111], v[96:99]
    v_mfma_f32_16x16x32_bf16 v[96:99], a[20:23], v[108:111], v[96:99]
    v_mfma_f32_16x16x32_bf16 v[96:99], a[24:27], v[108:111], v[96:99]
    v_mfma_f32_16x16x32_bf16 v[96:99], a[28:31], v[108:111], v[96:99]
    v_mfma_f32_16x16x32_bf16 v[96:99], a[32:35], v[108:111], v[96:99]
    v_mfma_f32_16x16x32_bf16 v[96:99], a[36:39], v[108:111], v[96:99]
    v_mfma_f32_16x16x32_bf16 v[96:99], a[40:43], v[108:111], v[96:99]
    v_mfma_f32_16x16x32_bf16 v[96:99], a[44:47], v[108:111], v[96:99]
    v_mfma_f32_16x16x32_bf16 v[96:99], a[48:51], v[108:111], v[96:99]
    v_mfma_f32_16x16x32_bf16 v[96:99], a[52:55], v[108:111], v[96:99]
    v_mfma_f32_16x16x32_bf16 v[96:99], a[56:59], v[108:111], v[96:99]
    v_mfma_f32_16x16x32_bf16 v[96:99], a[60:63], v[108:111], v[96:99]
    v_mfma_f32_16x16x32_bf16 v[96:99], a[64:67], v[108:111], v[96:99]
    v_mfma_f32_16x16x32_bf16 v[96:99], a[68:71], v[108:111], v[96:99]
    v_mfma_f32_16x16x32_bf16 v[96:99], a[72:75], v[108:111], v[96:99]
    v_mfma_f32_16x16x32_bf16 v[96:99], a[76:79], v[108:111], v[96:99]
    v_mfma_f32_16x16x32_bf16 v[100:103], a[80:83], v[108:111], 0
    v_mfma_f32_16x16x32_bf16 v[100:103], a[84:87], v[108:111], v[100:103]
    v_mfma_f32_16x16x32_bf16 v[100:103], a[88:91], v[108:111], v[100:103]
    v_mfma_f32_16x16x32_bf16 v[100:103], a[92:95], v[108:111], v[100:103]
    v_mfma_f32_16x16x32_bf16 v[100:103], a[96:99], v[108:111], v[100:103]
    v_mfma_f32_16x16x32_bf16 v[100:103], a[100:103], v[108:111], v[100:103]
    v_mfma_f32_16x16x32_bf16 v[100:103], a[104:107], v[108:111], v[100:103]
    v_mfma_f32_16x16x32_bf16 v[100:103], a[108:111], v[108:111], v[100:103]
    v_mfma_f32_16x16x32_bf16 v[100:103], a[112:115], v[108:111], v[100:103]
    v_mfma_f32_16x16x32_bf16 v[100:103], a[116:119], v[108:111], v[100:103]
    v_mfma_f32_16x16x32_bf16 v[100:103], a[120:123], v[108:111], v[100:103]
    v_mfma_f32_16x16x32_bf16 v[100:103], a[124:127], v[108:111], v[100:103]
    v_mfma_f32_16x16x32_bf16 v[100:103], a[128:131], v[108:111], v[100:103]
    v_mfma_f32_16x16x32_bf16 v[100:103], a[132:135], v[108:111], v[100:103]
    v_mfma_f32_16x16x32_bf16 v[100:103], a[136:139], v[108:111], v[100:103]
    v_mfma_f32_16x16x32_bf16 v[100:103], a[140:143], v[108:111], v[100:103]
    v_mfma_f32_16x16x32_bf16 v[100:103], a[144:147], v[108:111], v[100:103]
    v_mfma_f32_16x16x32_bf16 v[100:103], a[148:151], v[108:111], v[100:103]
    v_mfma_f32_16x16x32_bf16 v[100:103], a[152:155], v[108:111], v[100:103]
    v_mfma_f32_16x16x32_bf16 v[100:103], a[156:159], v[108:111], v[100:103]
    v_mfma_f32_16x16x32_bf16 v[104:107], a[160:163], v[108:111], 0
    v_mfma_f32_16x16x32_bf16 v[104:107], a[164:167], v[108:111], v[104:107]
    v_mfma_f32_16x16x32_bf16 v[104:107], a[168:171], v[108:111], v[104:107]
    v_mfma_f32_16x16x32_bf16 v[104:107], a[172:175], v[108:111], v[104:107]
    v_mfma_f32_16x16x32_bf16 v[104:107], a[176:179], v[108:111], v[104:107]
    v_mfma_f32_16x16x32_bf16 v[104:107], a[180:183], v[108:111], v[104:107]
    v_mfma_f32_16x16x32_bf16 v[104:107], a[184:187], v[108:111], v[104:107]
    v_mfma_f32_16x16x32_bf16 v[104:107], a[188:191], v[108:111], v[104:107]
    v_mfma_f32_16x16x32_bf16 v[104:107], a[192:195], v[108:111], v[104:107]
    v_mfma_f32_16x16x32_bf16 v[104:107], a[196:199], v[108:111], v[104:107]
    v_mfma_f32_16x16x32_bf16 v[104:107], a[200:203], v[108:111], v[104:107]
    v_mfma_f32_16x16x32_bf16 v[104:107], a[204:207], v[108:111], v[104:107]
    v_mfma_f32_16x16x32_bf16 v[104:107], a[208:211], v[108:111], v[104:107]
    v_mfma_f32_16x16x32_bf16 v[104:107], a[212:215], v[108:111], v[104:107]
    v_mfma_f32_16x16x32_bf16 v[104:107], a[216:219], v[108:111], v[104:107]
    v_mfma_f32_16x16x32_bf16 v[104:107], a[220:223], v[108:111], v[104:107]
    v_mfma_f32_16x16x32_bf16 v[104:107], a[224:227], v[108:111], v[104:107]
    v_mfma_f32_16x16x32_bf16 v[104:107], a[228:231], v[108:111], v[104:107]
    v_mfma_f32_16x16x32_bf16 v[104:107], a[232:235], v[108:111], v[104:107]
    v_mfma_f32_16x16x32_bf16 v[104:107], a[236:239], v[108:111], v[104:107]
    v_mov_b32 v93, 0
    v_min_u32 v3, 19, v1
    v_lshlrev_b32 v94, 2, v3
    v_and_b32 v3, 15, v1
    v_lshrrev_b32 v4, 4, v1
    v_mul_u32_u24 v95, 0x280, v4
    v_lshl_add_u32 v95, v3, 3, v95
    v_lshrrev_b32 v5, 1, v4
    v_mul_u32_u24 v5, 0xc000, v5
    v_lshl_add_u32 v5, v3, 4, v5
    v_and_b32 v6, 1, v4
    s_mul_i32 s26, s21, 3072
    s_add_u32 s26, s26, 0x1400000
    s_lshr_b32 s27, s20, 1
    s_lshl_b32 s27, s27, 10
    s_and_b32 s28, s20, 1
    s_lshl_b32 s28, s28, 9
    s_add_u32 s27, s27, s28
    s_add_u32 s27, s27, s26
    v_lshl_add_u32 v112, v6, 8, v5
    v_add_u32 v112, s27, v112
    s_lshl_b32 s27, s20, 8
    s_add_u32 s27, s27, s26
    s_add_u32 s27, s27, 2048
    v_lshl_add_u32 v113, v6, 3, v5
    v_add_u32 v113, s27, v113
    s_lshl_b32 s31, s21, 7
    s_lshl_b32 s26, s22, 11
    s_add_u32 s31, s31, s26
    s_add_u32 s31, s31, 32768
    s_mul_i32 s34, s20, 10240
    s_mov_b32 s40, 0xbfb8aa3b
    s_mov_b32 s42, s40
    s_mov_b32 s43, s40
    s_mov_b32 s41, 1
    v_mov_b32 v119, 81920
    v_mov_b32 v4, 4
Lwi_119:
    buffer_load_dword v5, v4, s[88:91], 0 offen sc1
    s_waitcnt vmcnt(0)
    v_cmp_gt_u32 vcc, 224, v5
    s_cbranch_vccz Lwid_120
    s_sub_u32 s101, s101, 1
    s_cbranch_scc1 L_abort
    s_sleep 8
    s_branch Lwi_119
Lwid_120:
    s_mov_b32 s24, s22
Lf1_cold:
    s_lshl_b32 s32, s24, 7
    s_add_u32 s32, s32, 36864
Lw_121:
    buffer_load_dword v6, v94, s[4:7], s32 offen sc1
    s_waitcnt vmcnt(0)
    v_cmp_gt_u32 vcc, s41, v6
    s_cbranch_vccz Lwd_122
    s_sub_u32 s101, s101, 1
    s_cbranch_scc1 L_abort
    s_sleep 1
    s_branch Lw_121
Lwd_122:
    s_mul_i32 s35, s24, 40960
    s_add_u32 s35, s35, s34
    s_add_u32 s35, s35, 0x1000000
    s_bfe_u32 s37, s24, 0x10001
    s_mul_i32 s37, s37, 40960
    s_add_u32 s37, s37, s34
    s_mul_i32 s32, s24, 5120
    s_add_u32 s32, s32, 0x1300000
    s_add_u32 s33, s32, 2560
    s_add_u32 m0, s37, 0
    s_add_u32 s36, s35, 0
    buffer_load_dwordx4 v2, s[4:7], s36 offen offset:0 sc1 lds
    buffer_load_dwordx4 v2, s[4:7], s36 offen offset:1024 sc1 lds
    buffer_load_dwordx4 v2, s[4:7], s36 offen offset:2048 sc1 lds
    buffer_load_dwordx4 v2, s[4:7], s36 offen offset:3072 sc1 lds
    s_add_u32 m0, s37, 4096
    s_add_u32 s36, s35, 4096
    buffer_load_dwordx4 v2, s[4:7], s36 offen offset:0 sc1 lds
    buffer_load_dwordx4 v2, s[4:7], s36 offen offset:1024 sc1 lds
    buffer_load_dwordx4 v2, s[4:7], s36 offen offset:2048 sc1 lds
    buffer_load_dwordx4 v2, s[4:7], s36 offen offset:3072 sc1 lds
    s_add_u32 m0, s37, 8192
    s_add_u32 s36, s35, 8192
    buffer_load_dwordx4 v2, s[4:7], s36 offen offset:0 sc1 lds
    buffer_load_dwordx4 v2, s[4:7], s36 offen offset:1024 sc1 lds
    buffer_load_dwordx2 v[120:121], v95, s[4:7], s32 offen offset:0 sc1
    buffer_load_dwordx2 v[122:123], v95, s[4:7], s32 offen offset:128 sc1
    buffer_load_dwordx2 v[124:125], v95, s[4:7], s32 offen offset:256 sc1
    buffer_load_dwordx2 v[126:127], v95, s[4:7], s32 offen offset:384 sc1
    buffer_load_dwordx2 v[128:129], v95, s[4:7], s32 offen offset:512 sc1
    buffer_load_dwordx2 v[130:131], v95, s[4:7], s33 offen offset:0 sc1
    buffer_load_dwordx2 v[132:133], v95, s[4:7], s33 offen offset:128 sc1
    buffer_load_dwordx2 v[134:135], v95, s[4:7], s33 offen offset:256 sc1
    buffer_load_dwordx2 v[136:137], v95, s[4:7], s33 offen offset:384 sc1
    buffer_load_dwordx2 v[138:139], v95, s[4:7], s33 offen offset:512 sc1
    s_cmp_lg_u32 s20, 0
    s_cbranch_scc1 Lf1w_123
    s_add_u32 s44, s24, 2
    s_min_u32 s44, s44, 63
    s_lshl_b32 s44, s44, 7
    s_add_u32 s44, s44, 36864
    buffer_load_dword v118, v94, s[4:7], s44 offen sc1
Lf1w_123:
    s_waitcnt vmcnt(0)
    s_cmp_lg_u32 s20, 0
    s_cbranch_scc1 Lf1w_124
    v_cmp_gt_u32 vcc, s41, v118
    s_cmp_eq_u64 vcc, 0
    s_cselect_b32 s45, 1, 0
    s_add_u32 s44, s24, 2
    s_cmp_lt_u32 s44, 64
    s_cselect_b32 s45, s45, 0
    s_sub_u32 s44, s44, 2
    s_bfe_u32 s44, s44, 0x10001
    s_lshl_b32 s44, s44, 2
    v_mov_b32 v5, s45
    v_add_u32 v6, s44, v119
    ds_write_b32 v6, v5
Lf1w_124:
    s_waitcnt lgkmcnt(0)
    s_barrier
Lf1_loop:
    s_bfe_u32 s44, s24, 0x10001
    s_lshl_b32 s45, s44, 2
    v_add_u32 v6, s45, v119
    ds_read_b32 v5, v6
    s_mul_i32 s44, s44, 40960
    v_add_u32 v92, s44, v2
    v_pk_add_f32 v[120:121], v[120:121], v[122:123]
    v_pk_add_f32 v[120:121], v[120:121], v[124:125]
    v_pk_add_f32 v[120:121], v[120:121], v[126:127]
    v_pk_add_f32 v[120:121], v[120:121], v[128:129]
    v_mov_b32 v6, v120
    s_nop 1
    v_permlane16_swap_b32 v120, v6
    v_add_f32 v120, v120, v6
    v_mov_b32 v6, v120
    s_nop 1
    v_permlane32_swap_b32 v120, v6
    v_add_f32 v120, v120, v6
    v_mov_b32 v6, v121
    s_nop 1
    v_permlane16_swap_b32 v121, v6
    v_add_f32 v121, v121, v6
    v_mov_b32 v6, v121
    s_nop 1
    v_permlane32_swap_b32 v121, v6
    v_add_f32 v121, v121, v6
    v_mul_f32 v140, 0x3acccccd, v120
    v_mul_f32 v121, 0x3acccccd, v121
    v_fma_f32 v121, -v140, v140, v121
    v_max_f32 v121, 0, v121
    v_add_f32 v121, 0x3727c5ac, v121
    v_rsq_f32 v144, v121
    v_pk_add_f32 v[130:131], v[130:131], v[132:133]
    v_pk_add_f32 v[130:131], v[130:131], v[134:135]
    v_pk_add_f32 v[130:131], v[130:131], v[136:137]
    v_pk_add_f32 v[130:131], v[130:131], v[138:139]
    v_mov_b32 v6, v130
    s_nop 1
    v_permlane16_swap_b32 v130, v6
    v_add_f32 v130, v130, v6
    v_mov_b32 v6, v130
    s_nop 1
    v_permlane32_swap_b32 v130, v6
    v_add_f32 v130, v130, v6
    v_mov_b32 v6, v131
    s_nop 1
    v_permlane16_swap_b32 v131, v6
    v_add_f32 v131, v131, v6
    v_mov_b32 v6, v131
    s_nop 1
    v_permlane32_swap_b32 v131, v6
    v_add_f32 v131, v131, v6
    v_mul_f32 v142, 0x3acccccd, v130
    v_mul_f32 v131, 0x3acccccd, v131
    v_fma_f32 v131, -v142, v142, v131
    v_max_f32 v131, 0, v131
    v_add_f32 v131, 0x3727c5ac, v131
    v_rsq_f32 v146, v131
    s_waitcnt lgkmcnt(0)
    v_readfirstlane_b32 s46, v5
    s_add_u32 s47, s24, 2
    s_cmp_eq_u32 s46, 0
    s_cbranch_scc1 Lf1p_125
    s_mul_i32 s35, s47, 40960
    s_add_u32 s35, s35, s34
    s_add_u32 s35, s35, 0x1000000
    s_bfe_u32 s37, s47, 0x10001
    s_mul_i32 s37, s37, 40960
    s_add_u32 s37, s37, s34
    s_mul_i32 s32, s47, 5120
    s_add_u32 s32, s32, 0x1300000
    s_add_u32 s33, s32, 2560
    buffer_load_dwordx2 v[120:121], v95, s[4:7], s32 offen offset:0 sc1
    buffer_load_dwordx2 v[122:123], v95, s[4:7], s32 offen offset:128 sc1
    buffer_load_dwordx2 v[124:125], v95, s[4:7], s32 offen offset:256 sc1
    buffer_load_dwordx2 v[126:127], v95, s[4:7], s32 offen offset:384 sc1
    buffer_load_dwordx2 v[128:129], v95, s[4:7], s32 offen offset:512 sc1
    buffer_load_dwordx2 v[130:131], v95, s[4:7], s33 offen offset:0 sc1
    buffer_load_dwordx2 v[132:133], v95, s[4:7], s33 offen offset:128 sc1
    buffer_load_dwordx2 v[134:135], v95, s[4:7], s33 offen offset:256 sc1
    buffer_load_dwordx2 v[136:137], v95, s[4:7], s33 offen offset:384 sc1
    buffer_load_dwordx2 v[138:139], v95, s[4:7], s33 offen offset:512 sc1
Lf1p_125:
    ds_read_b128 v[24:27], v92 offset:0
    ds_read_b128 v[28:31], v92 offset:20480
    ds_read_b128 v[32:35], v92 offset:1024
    ds_read_b128 v[36:39], v92 offset:21504
    ds_read_b128 v[40:43], v92 offset:2048
    ds_read_b128 v[44:47], v92 offset:22528
    ds_read_b128 v[48:51], v92 offset:3072
    ds_read_b128 v[52:55], v92 offset:23552
    s_waitcnt lgkmcnt(6)
    v_mfma_f32_16x16x32_bf16 v[64:67], a[0:3], v[24:27], 0
    v_mfma_f32_16x16x32_bf16 v[68:71], a[0:3], v[28:31], 0
    v_mfma_f32_16x16x32_bf16 v[72:75], a[80:83], v[24:27], 0
    v_mfma_f32_16x16x32_bf16 v[76:79], a[80:83], v[28:31], 0
    v_mfma_f32_16x16x32_bf16 v[80:83], a[160:163], v[24:27], 0
    v_mfma_f32_16x16x32_bf16 v[84:87], a[160:163], v[28:31], 0
    s_cmp_eq_u32 s46, 0
    s_cbranch_scc1 Lf1h_126
    s_add_u32 m0, s37, 0
    s_add_u32 s36, s35, 0
    buffer_load_dwordx4 v2, s[4:7], s36 offen offset:0 sc1 lds
Lf1h_126:
    ds_read_b128 v[24:27], v92 offset:4096
    ds_read_b128 v[28:31], v92 offset:24576
    s_waitcnt lgkmcnt(6)
    v_mfma_f32_16x16x32_bf16 v[64:67], a[4:7], v[32:35], v[64:67]
    v_mfma_f32_16x16x32_bf16 v[68:71], a[4:7], v[36:39], v[68:71]
    v_mfma_f32_16x16x32_bf16 v[72:75], a[84:87], v[32:35], v[72:75]
    v_mfma_f32_16x16x32_bf16 v[76:79], a[84:87], v[36:39], v[76:79]
    v_mfma_f32_16x16x32_bf16 v[80:83], a[164:167], v[32:35], v[80:83]
    v_mfma_f32_16x16x32_bf16 v[84:87], a[164:167], v[36:39], v[84:87]
    s_cmp_eq_u32 s46, 0
    s_cbranch_scc1 Lf1h_127
    buffer_load_dwordx4 v2, s[4:7], s36 offen offset:1024 sc1 lds
Lf1h_127:
    ds_read_b128 v[32:35], v92 offset:5120
    ds_read_b128 v[36:39], v92 offset:25600
    s_waitcnt lgkmcnt(6)
    v_mfma_f32_16x16x32_bf16 v[64:67], a[8:11], v[40:43], v[64:67]
    v_mfma_f32_16x16x32_bf16 v[68:71], a[8:11], v[44:47], v[68:71]
    v_mfma_f32_16x16x32_bf16 v[72:75], a[88:91], v[40:43], v[72:75]
    v_mfma_f32_16x16x32_bf16 v[76:79], a[88:91], v[44:47], v[76:79]
    v_mfma_f32_16x16x32_bf16 v[80:83], a[168:171], v[40:43], v[80:83]
    v_mfma_f32_16x16x32_bf16 v[84:87], a[168:171], v[44:47], v[84:87]
    s_cmp_eq_u32 s46, 0
    s_cbranch_scc1 Lf1h_128
    buffer_load_dwordx4 v2, s[4:7], s36 offen offset:2048 sc1 lds
Lf1h_128:
    ds_read_b128 v[40:43], v92 offset:6144
    ds_read_b128 v[44:47], v92 offset:26624
    s_waitcnt lgkmcnt(6)
    v_mfma_f32_16x16x32_bf16 v[64:67], a[12:15], v[48:51], v[64:67]
    v_mfma_f32_16x16x32_bf16 v[68:71], a[12:15], v[52:55], v[68:71]
    v_mfma_f32_16x16x32_bf16 v[72:75], a[92:95], v[48:51], v[72:75]
    v_mfma_f32_16x16x32_bf16 v[76:79], a[92:95], v[52:55], v[76:79]
    v_mfma_f32_16x16x32_bf16 v[80:83], a[172:175], v[48:51], v[80:83]
    v_mfma_f32_16x16x32_bf16 v[84:87], a[172:175], v[52:55], v[84:87]
    s_cmp_eq_u32 s46, 0
    s_cbranch_scc1 Lf1h_129
    buffer_load_dwordx4 v2, s[4:7], s36 offen offset:3072 sc1 lds
Lf1h_129:
    ds_read_b128 v[48:51], v92 offset:7168
    ds_read_b128 v[52:55], v92 offset:27648
    s_waitcnt lgkmcnt(6)
    v_mfma_f32_16x16x32_bf16 v[64:67], a[16:19], v[24:27], v[64:67]
    v_mfma_f32_16x16x32_bf16 v[68:71], a[16:19], v[28:31], v[68:71]
    v_mfma_f32_16x16x32_bf16 v[72:75], a[96:99], v[24:27], v[72:75]
    v_mfma_f32_16x16x32_bf16 v[76:79], a[96:99], v[28:31], v[76:79]
    v_mfma_f32_16x16x32_bf16 v[80:83], a[176:179], v[24:27], v[80:83]
    v_mfma_f32_16x16x32_bf16 v[84:87], a[176:179], v[28:31], v[84:87]
    s_cmp_eq_u32 s46, 0
    s_cbranch_scc1 Lf1h_130
    s_add_u32 m0, s37, 4096
    s_add_u32 s36, s35, 4096
    buffer_load_dwordx4 v2, s[4:7], s36 offen offset:0 sc1 lds
Lf1h_130:
    ds_read_b128 v[24:27], v92 offset:8192
    ds_read_b128 v[28:31], v92 offset:28672
    s_waitcnt lgkmcnt(6)
    v_mfma_f32_16x16x32_bf16 v[64:67], a[20:23], v[32:35], v[64:67]
    v_mfma_f32_16x16x32_bf16 v[68:71], a[20:23], v[36:39], v[68:71]
    v_mfma_f32_16x16x32_bf16 v[72:75], a[100:103], v[32:35], v[72:75]
    v_mfma_f32_16x16x32_bf16 v[76:79], a[100:103], v[36:39], v[76:79]
    v_mfma_f32_16x16x32_bf16 v[80:83], a[180:183], v[32:35], v[80:83]
    v_mfma_f32_16x16x32_bf16 v[84:87], a[180:183], v[36:39], v[84:87]
    s_cmp_eq_u32 s46, 0
    s_cbranch_scc1 Lf1h_131
    buffer_load_dwordx4 v2, s[4:7], s36 offen offset:1024 sc1 lds
Lf1h_131:
    ds_read_b128 v[32:35], v92 offset:9216
    ds_read_b128 v[36:39], v92 offset:29696
    s_waitcnt lgkmcnt(6)
    v_mfma_f32_16x16x32_bf16 v[64:67], a[24:27], v[40:43], v[64:67]
    v_mfma_f32_16x16x32_bf16 v[68:71], a[24:27], v[44:47], v[68:71]
    v_mfma_f32_16x16x32_bf16 v[72:75], a[104:107], v[40:43], v[72:75]
    v_mfma_f32_16x16x32_bf16 v[76:79], a[104:107], v[44:47], v[76:79]
    v_mfma_f32_16x16x32_bf16 v[80:83], a[184:187], v[40:43], v[80:83]
    v_mfma_f32_16x16x32_bf16 v[84:87], a[184:187], v[44:47], v[84:87]
    s_cmp_eq_u32 s46, 0
    s_cbranch_scc1 Lf1h_132
    buffer_load_dwordx4 v2, s[4:7], s36 offen offset:2048 sc1 lds
Lf1h_132:
    ds_read_b128 v[40:43], v92 offset:10240
    ds_read_b128 v[44:47], v92 offset:30720
    s_waitcnt lgkmcnt(6)
    v_mfma_f32_16x16x32_bf16 v[64:67], a[28:31], v[48:51], v[64:67]
    v_mfma_f32_16x16x32_bf16 v[68:71], a[28:31], v[52:55], v[68:71]
    v_mfma_f32_16x16x32_bf16 v[72:75], a[108:111], v[48:51], v[72:75]
    v_mfma_f32_16x16x32_bf16 v[76:79], a[108:111], v[52:55], v[76:79]
    v_mfma_f32_16x16x32_bf16 v[80:83], a[188:191], v[48:51], v[80:83]
    v_mfma_f32_16x16x32_bf16 v[84:87], a[188:191], v[52:55], v[84:87]
    s_cmp_eq_u32 s46, 0
    s_cbranch_scc1 Lf1h_133
    buffer_load_dwordx4 v2, s[4:7], s36 offen offset:3072 sc1 lds
Lf1h_133:
    ds_read_b128 v[48:51], v92 offset:11264
    ds_read_b128 v[52:55], v92 offset:31744
    s_waitcnt lgkmcnt(6)
    v_mfma_f32_16x16x32_bf16 v[64:67], a[32:35], v[24:27], v[64:67]
    v_mfma_f32_16x16x32_bf16 v[68:71], a[32:35], v[28:31], v[68:71]
    v_mfma_f32_16x16x32_bf16 v[72:75], a[112:115], v[24:27], v[72:75]
    v_mfma_f32_16x16x32_bf16 v[76:79], a[112:115], v[28:31], v[76:79]
    v_mfma_f32_16x16x32_bf16 v[80:83], a[192:195], v[24:27], v[80:83]
    v_mfma_f32_16x16x32_bf16 v[84:87], a[192:195], v[28:31], v[84:87]
    s_cmp_eq_u32 s46, 0
    s_cbranch_scc1 Lf1h_134
    s_add_u32 m0, s37, 8192
    s_add_u32 s36, s35, 8192
    buffer_load_dwordx4 v2, s[4:7], s36 offen offset:0 sc1 lds
Lf1h_134:
    ds_read_b128 v[24:27], v92 offset:12288
    ds_read_b128 v[28:31], v92 offset:32768
    s_waitcnt lgkmcnt(6)
    v_mfma_f32_16x16x32_bf16 v[64:67], a[36:39], v[32:35], v[64:67]
    v_mfma_f32_16x16x32_bf16 v[68:71], a[36:39], v[36:39], v[68:71]
    v_mfma_f32_16x16x32_bf16 v[72:75], a[116:119], v[32:35], v[72:75]
    v_mfma_f32_16x16x32_bf16 v[76:79], a[116:119], v[36:39], v[76:79]
    v_mfma_f32_16x16x32_bf16 v[80:83], a[196:199], v[32:35], v[80:83]
    v_mfma_f32_16x16x32_bf16 v[84:87], a[196:199], v[36:39], v[84:87]
    s_cmp_eq_u32 s46, 0
    s_cbranch_scc1 Lf1h_135
    buffer_load_dwordx4 v2, s[4:7], s36 offen offset:1024 sc1 lds
Lf1h_135:
    ds_read_b128 v[32:35], v92 offset:13312
    ds_read_b128 v[36:39], v92 offset:33792
    s_waitcnt lgkmcnt(6)
    v_mfma_f32_16x16x32_bf16 v[64:67], a[40:43], v[40:43], v[64:67]
    v_mfma_f32_16x16x32_bf16 v[68:71], a[40:43], v[44:47], v[68:71]
    v_mfma_f32_16x16x32_bf16 v[72:75], a[120:123], v[40:43], v[72:75]
    v_mfma_f32_16x16x32_bf16 v[76:79], a[120:123], v[44:47], v[76:79]
    v_mfma_f32_16x16x32_bf16 v[80:83], a[200:203], v[40:43], v[80:83]
    v_mfma_f32_16x16x32_bf16 v[84:87], a[200:203], v[44:47], v[84:87]
    ds_read_b128 v[40:43], v92 offset:14336
    ds_read_b128 v[44:47], v92 offset:34816
    s_waitcnt lgkmcnt(6)
    v_mfma_f32_16x16x32_bf16 v[64:67], a[44:47], v[48:51], v[64:67]
    v_mfma_f32_16x16x32_bf16 v[68:71], a[44:47], v[52:55], v[68:71]
    v_mfma_f32_16x16x32_bf16 v[72:75], a[124:127], v[48:51], v[72:75]
    v_mfma_f32_16x16x32_bf16 v[76:79], a[124:127], v[52:55], v[76:79]
    v_mfma_f32_16x16x32_bf16 v[80:83], a[204:207], v[48:51], v[80:83]
    v_mfma_f32_16x16x32_bf16 v[84:87], a[204:207], v[52:55], v[84:87]
    ds_read_b128 v[48:51], v92 offset:15360
    ds_read_b128 v[52:55], v92 offset:35840
    s_waitcnt lgkmcnt(6)
    v_mfma_f32_16x16x32_bf16 v[64:67], a[48:51], v[24:27], v[64:67]
    v_mfma_f32_16x16x32_bf16 v[68:71], a[48:51], v[28:31], v[68:71]
    v_mfma_f32_16x16x32_bf16 v[72:75], a[128:131], v[24:27], v[72:75]
    v_mfma_f32_16x16x32_bf16 v[76:79], a[128:131], v[28:31], v[76:79]
    v_mfma_f32_16x16x32_bf16 v[80:83], a[208:211], v[24:27], v[80:83]
    v_mfma_f32_16x16x32_bf16 v[84:87], a[208:211], v[28:31], v[84:87]
    ds_read_b128 v[24:27], v92 offset:16384
    ds_read_b128 v[28:31], v92 offset:36864
    s_waitcnt lgkmcnt(6)
    v_mfma_f32_16x16x32_bf16 v[64:67], a[52:55], v[32:35], v[64:67]
    v_mfma_f32_16x16x32_bf16 v[68:71], a[52:55], v[36:39], v[68:71]
    v_mfma_f32_16x16x32_bf16 v[72:75], a[132:135], v[32:35], v[72:75]
    v_mfma_f32_16x16x32_bf16 v[76:79], a[132:135], v[36:39], v[76:79]
    v_mfma_f32_16x16x32_bf16 v[80:83], a[212:215], v[32:35], v[80:83]
    v_mfma_f32_16x16x32_bf16 v[84:87], a[212:215], v[36:39], v[84:87]
    ds_read_b128 v[32:35], v92 offset:17408
    ds_read_b128 v[36:39], v92 offset:37888
    s_waitcnt lgkmcnt(6)
    v_mfma_f32_16x16x32_bf16 v[64:67], a[56:59], v[40:43], v[64:67]
    v_mfma_f32_16x16x32_bf16 v[68:71], a[56:59], v[44:47], v[68:71]
    v_mfma_f32_16x16x32_bf16 v[72:75], a[136:139], v[40:43], v[72:75]
    v_mfma_f32_16x16x32_bf16 v[76:79], a[136:139], v[44:47], v[76:79]
    v_mfma_f32_16x16x32_bf16 v[80:83], a[216:219], v[40:43], v[80:83]
    v_mfma_f32_16x16x32_bf16 v[84:87], a[216:219], v[44:47], v[84:87]
    ds_read_b128 v[40:43], v92 offset:18432
    ds_read_b128 v[44:47], v92 offset:38912
    s_waitcnt lgkmcnt(6)
    v_mfma_f32_16x16x32_bf16 v[64:67], a[60:63], v[48:51], v[64:67]
    v_mfma_f32_16x16x32_bf16 v[68:71], a[60:63], v[52:55], v[68:71]
    v_mfma_f32_16x16x32_bf16 v[72:75], a[140:143], v[48:51], v[72:75]
    v_mfma_f32_16x16x32_bf16 v[76:79], a[140:143], v[52:55], v[76:79]
    v_mfma_f32_16x16x32_bf16 v[80:83], a[220:223], v[48:51], v[80:83]
    v_mfma_f32_16x16x32_bf16 v[84:87], a[220:223], v[52:55], v[84:87]
    ds_read_b128 v[48:51], v92 offset:19456
    ds_read_b128 v[52:55], v92 offset:39936
    s_waitcnt lgkmcnt(6)
    v_mfma_f32_16x16x32_bf16 v[64:67], a[64:67], v[24:27], v[64:67]
    v_mfma_f32_16x16x32_bf16 v[68:71], a[64:67], v[28:31], v[68:71]
    v_mfma_f32_16x16x32_bf16 v[72:75], a[144:147], v[24:27], v[72:75]
    v_mfma_f32_16x16x32_bf16 v[76:79], a[144:147], v[28:31], v[76:79]
    v_mfma_f32_16x16x32_bf16 v[80:83], a[224:227], v[24:27], v[80:83]
    v_mfma_f32_16x16x32_bf16 v[84:87], a[224:227], v[28:31], v[84:87]
    s_waitcnt lgkmcnt(4)
    v_mfma_f32_16x16x32_bf16 v[64:67], a[68:71], v[32:35], v[64:67]
    v_mfma_f32_16x16x32_bf16 v[68:71], a[68:71], v[36:39], v[68:71]
    v_mfma_f32_16x16x32_bf16 v[72:75], a[148:151], v[32:35], v[72:75]
    v_mfma_f32_16x16x32_bf16 v[76:79], a[148:151], v[36:39], v[76:79]
    v_mfma_f32_16x16x32_bf16 v[80:83], a[228:231], v[32:35], v[80:83]
    v_mfma_f32_16x16x32_bf16 v[84:87], a[228:231], v[36:39], v[84:87]
    s_waitcnt lgkmcnt(2)
    v_mfma_f32_16x16x32_bf16 v[64:67], a[72:75], v[40:43], v[64:67]
    v_mfma_f32_16x16x32_bf16 v[68:71], a[72:75], v[44:47], v[68:71]
    v_mfma_f32_16x16x32_bf16 v[72:75], a[152:155], v[40:43], v[72:75]
    v_mfma_f32_16x16x32_bf16 v[76:79], a[152:155], v[44:47], v[76:79]
    v_mfma_f32_16x16x32_bf16 v[80:83], a[232:235], v[40:43], v[80:83]
    v_mfma_f32_16x16x32_bf16 v[84:87], a[232:235], v[44:47], v[84:87]
    s_waitcnt lgkmcnt(0)
    v_mfma_f32_16x16x32_bf16 v[64:67], a[76:79], v[48:51], v[64:67]
    v_mfma_f32_16x16x32_bf16 v[68:71], a[76:79], v[52:55], v[68:71]
    v_mfma_f32_16x16x32_bf16 v[72:75], a[156:159], v[48:51], v[72:75]
    v_mfma_f32_16x16x32_bf16 v[76:79], a[156:159], v[52:55], v[76:79]
    v_mfma_f32_16x16x32_bf16 v[80:83], a[236:239], v[48:51], v[80:83]
    v_mfma_f32_16x16x32_bf16 v[84:87], a[236:239], v[52:55], v[84:87]
    s_cmp_eq_u32 s46, 0
    s_cbranch_scc1 Lf1s_136
    s_cmp_lg_u32 s20, 0
    s_cbranch_scc1 Lf1w_137
    s_add_u32 s44, s24, 4
    s_min_u32 s44, s44, 63
    s_lshl_b32 s44, s44, 7
    s_add_u32 s44, s44, 36864
    buffer_load_dword v118, v94, s[4:7], s44 offen sc1
Lf1w_137:
Lf1s_136:
    s_nop 0
    v_pk_fma_f32 v[64:65], v[140:141], v[96:97], v[64:65] op_sel_hi:[0,1,1] neg_lo:[1,0,0] neg_hi:[1,0,0]
    v_pk_fma_f32 v[66:67], v[140:141], v[98:99], v[66:67] op_sel_hi:[0,1,1] neg_lo:[1,0,0] neg_hi:[1,0,0]
    v_pk_mul_f32 v[64:65], v[64:65], v[144:145] op_sel_hi:[1,0]
    v_pk_mul_f32 v[66:67], v[66:67], v[144:145] op_sel_hi:[1,0]
    v_pk_fma_f32 v[68:69], v[142:143], v[96:97], v[68:69] op_sel_hi:[0,1,1] neg_lo:[1,0,0] neg_hi:[1,0,0]
    v_pk_fma_f32 v[70:71], v[142:143], v[98:99], v[70:71] op_sel_hi:[0,1,1] neg_lo:[1,0,0] neg_hi:[1,0,0]
    v_pk_mul_f32 v[68:69], v[68:69], v[146:147] op_sel_hi:[1,0]
    v_pk_mul_f32 v[70:71], v[70:71], v[146:147] op_sel_hi:[1,0]
    v_pk_fma_f32 v[72:73], v[140:141], v[100:101], v[72:73] op_sel_hi:[0,1,1] neg_lo:[1,0,0] neg_hi:[1,0,0]
    v_pk_fma_f32 v[74:75], v[140:141], v[102:103], v[74:75] op_sel_hi:[0,1,1] neg_lo:[1,0,0] neg_hi:[1,0,0]
    v_pk_mul_f32 v[72:73], v[72:73], v[144:145] op_sel_hi:[1,0]
    v_pk_mul_f32 v[74:75], v[74:75], v[144:145] op_sel_hi:[1,0]
    v_pk_fma_f32 v[76:77], v[142:143], v[100:101], v[76:77] op_sel_hi:[0,1,1] neg_lo:[1,0,0] neg_hi:[1,0,0]
    v_pk_fma_f32 v[78:79], v[142:143], v[102:103], v[78:79] op_sel_hi:[0,1,1] neg_lo:[1,0,0] neg_hi:[1,0,0]
    v_pk_mul_f32 v[76:77], v[76:77], v[146:147] op_sel_hi:[1,0]
    v_pk_mul_f32 v[78:79], v[78:79], v[146:147] op_sel_hi:[1,0]
    v_pk_fma_f32 v[80:81], v[140:141], v[104:105], v[80:81] op_sel_hi:[0,1,1] neg_lo:[1,0,0] neg_hi:[1,0,0]
    v_pk_fma_f32 v[82:83], v[140:141], v[106:107], v[82:83] op_sel_hi:[0,1,1] neg_lo:[1,0,0] neg_hi:[1,0,0]
    v_pk_mul_f32 v[80:81], v[80:81], v[144:145] op_sel_hi:[1,0]
    v_pk_mul_f32 v[82:83], v[82:83], v[144:145] op_sel_hi:[1,0]
    v_pk_fma_f32 v[84:85], v[142:143], v[104:105], v[84:85] op_sel_hi:[0,1,1] neg_lo:[1,0,0] neg_hi:[1,0,0]
    v_pk_fma_f32 v[86:87], v[142:143], v[106:107], v[86:87] op_sel_hi:[0,1,1] neg_lo:[1,0,0] neg_hi:[1,0,0]
    v_pk_mul_f32 v[84:85], v[84:85], v[146:147] op_sel_hi:[1,0]
    v_pk_mul_f32 v[86:87], v[86:87], v[146:147] op_sel_hi:[1,0]
    v_permlane32_swap_b32 v64, v68
    v_permlane32_swap_b32 v65, v69
    v_permlane32_swap_b32 v66, v70
    v_permlane32_swap_b32 v67, v71
    v_pk_mul_f32 v[40:41], v[64:65], s[42:43]
    v_pk_mul_f32 v[42:43], v[66:67], s[42:43]
    v_exp_f32 v40, v40
    v_exp_f32 v41, v41
    v_exp_f32 v42, v42
    v_exp_f32 v43, v43
    v_pk_mul_f32 v[64:65], v[64:65], v[68:69]
    v_pk_mul_f32 v[66:67], v[66:67], v[70:71]
    v_add_f32 v40, 1.0, v40
    v_add_f32 v41, 1.0, v41
    v_add_f32 v42, 1.0, v42
    v_add_f32 v43, 1.0, v43
    v_rcp_f32 v40, v40
    v_rcp_f32 v41, v41
    v_rcp_f32 v42, v42
    v_rcp_f32 v43, v43
    v_pk_mul_f32 v[64:65], v[64:65], v[40:41]
    v_pk_mul_f32 v[66:67], v[66:67], v[42:43]
    v_cvt_pk_bf16_f32 v24, v64, v65
    v_cvt_pk_bf16_f32 v25, v66, v67
    v_permlane32_swap_b32 v72, v76
    v_permlane32_swap_b32 v73, v77
    v_permlane32_swap_b32 v74, v78
    v_permlane32_swap_b32 v75, v79
    v_pk_mul_f32 v[40:41], v[72:73], s[42:43]
    v_pk_mul_f32 v[42:43], v[74:75], s[42:43]
    v_exp_f32 v40, v40
    v_exp_f32 v41, v41
    v_exp_f32 v42, v42
    v_exp_f32 v43, v43
    v_pk_mul_f32 v[72:73], v[72:73], v[76:77]
    v_pk_mul_f32 v[74:75], v[74:75], v[78:79]
    v_add_f32 v40, 1.0, v40
    v_add_f32 v41, 1.0, v41
    v_add_f32 v42, 1.0, v42
    v_add_f32 v43, 1.0, v43
    v_rcp_f32 v40, v40
    v_rcp_f32 v41, v41
    v_rcp_f32 v42, v42
    v_rcp_f32 v43, v43
    v_pk_mul_f32 v[72:73], v[72:73], v[40:41]
    v_pk_mul_f32 v[74:75], v[74:75], v[42:43]
    v_cvt_pk_bf16_f32 v26, v72, v73
    v_cvt_pk_bf16_f32 v27, v74, v75
    v_permlane32_swap_b32 v80, v84
    v_permlane32_swap_b32 v81, v85
    v_permlane32_swap_b32 v82, v86
    v_permlane32_swap_b32 v83, v87
    v_pk_mul_f32 v[40:41], v[80:81], s[42:43]
    v_pk_mul_f32 v[42:43], v[82:83], s[42:43]
    v_exp_f32 v40, v40
    v_exp_f32 v41, v41
    v_exp_f32 v42, v42
    v_exp_f32 v43, v43
    v_pk_mul_f32 v[80:81], v[80:81], v[84:85]
    v_pk_mul_f32 v[82:83], v[82:83], v[86:87]
    v_add_f32 v40, 1.0, v40
    v_add_f32 v41, 1.0, v41
    v_add_f32 v42, 1.0, v42
    v_add_f32 v43, 1.0, v43
    v_rcp_f32 v40, v40
    v_rcp_f32 v41, v41
    v_rcp_f32 v42, v42
    v_rcp_f32 v43, v43
    v_pk_mul_f32 v[80:81], v[80:81], v[40:41]
    v_pk_mul_f32 v[82:83], v[82:83], v[42:43]
    v_cvt_pk_bf16_f32 v28, v80, v81
    v_cvt_pk_bf16_f32 v29, v82, v83
    s_mul_i32 s32, s24, 98304
    buffer_store_dwordx4 v[24:27], v112, s[4:7], s32 offen sc1
    buffer_store_dwordx2 v[28:29], v113, s[4:7], s32 offen sc1
    s_cmp_eq_u32 s46, 0
    s_cbranch_scc1 Lf1_flush
    s_waitcnt vmcnt(2)
    s_cmp_lg_u32 s20, 0
    s_cbranch_scc1 Lf1w_138
    v_cmp_gt_u32 vcc, s41, v118
    s_cmp_eq_u64 vcc, 0
    s_cselect_b32 s45, 1, 0
    s_add_u32 s44, s24, 4
    s_cmp_lt_u32 s44, 64
    s_cselect_b32 s45, s45, 0
    s_sub_u32 s44, s44, 2
    s_bfe_u32 s44, s44, 0x10001
    s_lshl_b32 s44, s44, 2
    v_mov_b32 v5, s45
    v_add_u32 v6, s44, v119
    ds_write_b32 v6, v5
Lf1w_138:
    s_waitcnt lgkmcnt(0)
    s_barrier
    s_cmp_lt_u32 s24, 2
    s_cbranch_scc1 Lf1n_139
    s_sub_u32 s47, s24, 1
    s_cmp_lg_u32 s20, 0
    s_cbranch_scc1 Lf1w_140
    v_mov_b32 v6, s47
    s_mov_b64 exec, 1
    buffer_store_dword v6, v93, s[4:7], s31 offen sc1
    s_mov_b64 exec, -1
Lf1w_140:
Lf1n_139:
    s_add_u32 s24, s24, 2
    s_branch Lf1_loop
Lf1_flush:
    s_waitcnt vmcnt(0)
    s_barrier
    s_add_u32 s47, s24, 1
    s_cmp_lg_u32 s20, 0
    s_cbranch_scc1 Lf1w_141
    v_mov_b32 v6, s47
    s_mov_b64 exec, 1
    buffer_store_dword v6, v93, s[4:7], s31 offen sc1
    s_mov_b64 exec, -1
Lf1w_141:
    s_add_u32 s24, s24, 2
    s_cmp_lt_u32 s24, 64
    s_cbranch_scc1 Lf1_cold
    s_branch L_exit
L_abort:
L_exit:
    s_endpgm

.section .rodata,"a"
.p2align 6
.amdhsa_kernel sequential_preLN__memory_aug_recurrent_mem_tr__swiglu_ffn__prompt_kernel
  .amdhsa_next_free_vgpr 512
  .amdhsa_next_free_sgpr 102
  .amdhsa_accum_offset 256
  .amdhsa_group_segment_fixed_size 0
  .amdhsa_kernarg_size 112
  .amdhsa_user_sgpr_count 2
  .amdhsa_user_sgpr_kernarg_segment_ptr 1
  .amdhsa_system_sgpr_workgroup_id_x 1
  .amdhsa_float_denorm_mode_32 3
.end_amdhsa_kernel
```
